```python
import torch

def _softmax(x, axis=-1):
    return torch.softmax(x, dim=axis)
def _gelu(x):
    return torch.nn.functional.gelu(x, approximate="tanh")
def _silu(x):
    return torch.nn.functional.silu(x)
def _sigmoid(x):
    return torch.sigmoid(x)
def _layernorm(x, axis=-1, eps=1e-5):
    m = x.mean(dim=axis, keepdim=True)
    v = x.var(dim=axis, keepdim=True, unbiased=False)
    return (x - m) / torch.sqrt(v + eps)
def _scatter_add(tgt, idx, src, axis=0):
    return tgt.clone().index_add_(axis, idx, src)
def _segment_sum(src, seg, n):
    out = torch.zeros((n,) + src.shape[1:], dtype=src.dtype)
    return out.index_add_(0, seg, src)
def _pad(x, pw):
    flat = tuple(v for pair in reversed(pw) for v in pair)
    return torch.nn.functional.pad(x, flat)

kernel_name = 'sequential_preLN__softmax_full_mha__mixer_token_mlp__prompt'

def setup_inputs():

    _w = (lambda a: (lambda t: t.to(torch.bfloat16) if t.is_floating_point() else t)(torch.as_tensor(a)))
    def _A_setup():
        B, S, D = 1, 2048, 448
        return {
            "x": _w((lambda *s: torch.randn(*s, dtype=torch.bfloat16) * 0.05)(B, S, D)),
            "wqkv": _w((lambda *s: torch.randn(*s, dtype=torch.bfloat16) * 0.05)(D, 3 * D)),
            "wo": _w((lambda *s: torch.randn(*s, dtype=torch.bfloat16) * 0.05)(D, D)),
        }
    _A_in = _A_setup()

    def _B_setup():
        B, S, D, F = 1, 2048, 448, 1792
        return {
            "x": _w((lambda *s: torch.randn(*s, dtype=torch.bfloat16) * 0.05)(B, S, D)),
            "w1": _w((lambda *s: torch.randn(*s, dtype=torch.bfloat16) * 0.8)(S, F) * (S ** -0.5)),
            "b1": _w((lambda *s: torch.randn(*s, dtype=torch.bfloat16) * 12.8)(F) * 0.02),
            "w2": _w((lambda *s: torch.randn(*s, dtype=torch.bfloat16) * 0.2)(F, S) * (F ** -0.5)),
            "b2": _w((lambda *s: torch.randn(*s, dtype=torch.bfloat16) * 1.6)(S) * 0.02),
        }
    _B_in = _B_setup()

    return {
        "A_x": _A_in["x"],
        "A_wqkv": _A_in["wqkv"],
        "A_wo": _A_in["wo"],
        "B_x": _B_in["x"],
        "B_w1": _B_in["w1"],
        "B_b1": _B_in["b1"],
        "B_w2": _B_in["w2"],
        "B_b2": _B_in["b2"],
    }

def reference(A_x, A_wqkv, A_wo, B_x, B_w1, B_b1, B_w2, B_b2):
    def _A_ref(x, wqkv, wo):
        B, S, D = x.shape
        H = 16; Dh = D // H
        qkv = (lambda x, *d: x.permute(*d))((x @ wqkv).reshape(B, S, 3, H, Dh), 2, 0, 3, 1, 4)
        q, k, v = qkv[0], qkv[1], qkv[2]
        scale = Dh ** -0.5
        scores = torch.einsum("bhqd,bhkd->bhqk", q, k) * scale
        p = _softmax(scores, axis=-1)
        o = torch.einsum("bhqk,bhkd->bhqd", p, v)
        return (lambda x, *d: x.permute(*d))(o, 0, 2, 1, 3).reshape(B, S, D) @ wo

    def _B_ref(x, w1, b1, w2, b2):
        B, S, D = x.shape
        h = _layernorm(x, axis=-1)
        u = torch.einsum("bsd,sf->bdf", h, w1) + b1
        u = _gelu(u)
        y = torch.einsum("bdf,fs->bds", u, w2) + b2
        return (lambda x, *d: x.permute(*d))(y, 0, 2, 1)

    x = A_x
    h = x + _A_ref(_layernorm(x, axis=-1), A_wqkv, A_wo)
    h2 = h + _B_ref(_layernorm(h, axis=-1), B_w1, B_b1, B_w2, B_b2)
    return h2
```

```asm
; @launch grid=(256,1,1) block=(256,1,1) lds=163840
.amdgcn_target "amdgcn-amd-amdhsa--gfx950"
.text
.p2align 12
.globl sequential_preLN__softmax_full_mha__mixer_token_mlp__prompt_kernel
.p2align 8
.type sequential_preLN__softmax_full_mha__mixer_token_mlp__prompt_kernel,@function
sequential_preLN__softmax_full_mha__mixer_token_mlp__prompt_kernel:
    s_load_dwordx2 s[4:5], s[0:1], 0
    s_load_dwordx2 s[8:9], s[0:1], 8
    s_load_dwordx2 s[40:41], s[0:1], 80
    s_load_dwordx16 s[12:27], s[0:1], 16
    s_lshr_b32 s59, s2, 3
    s_cmp_ge_u32 s59, 32
    s_cbranch_scc1 L_end
    s_getpc_b64 s[44:45]
    s_mov_b32 s46, 0xaf14
    s_mov_b32 s47, 0x20000
    s_lshl_b32 s60, s59, 11
    v_lshlrev_b32 v4, 3, v0
    buffer_load_dword v3, v4, s[44:47], s60 offen
    v_readfirstlane_b32 s48, v0
    v_and_b32 v0, 63, v0
    s_and_b32 s58, s2, 7
    s_lshr_b32 s60, s58, 2
    s_lshl_b32 s60, s60, 3
    s_lshr_b32 s50, s59, 2
    s_or_b32 s50, s50, s60
    s_lshr_b32 s48, s48, 6
    s_mov_b32 s6, 0x1c0000
    s_mov_b32 s7, s47
    v_lshrrev_b32 v4, 3, v0
    v_lshrrev_b32_e64 v5, 4, v0
    v_and_b32 v13, 7, v0
    s_lshl2_add_u32 s36, s50, s48
    v_lshl_add_u32 v4, s36, 5, v4
    v_mul_u32_u24 v4, 896, v4
    v_xor_b32_e64 v14, v13, v5
    s_lshl4_add_u32 s64, s48, 32
    s_lshl_b32 s64, s64, 10
    v_lshl_add_u32 v16, v14, 4, v4
    s_mov_b32 m0, s64
    v_xor_b32 v15, 64, v16
    v_add_u32 v17, 6144, v15
    v_add_u32 v18, 12288, v16
    v_add_u32 v19, 18432, v15
    s_and_b32 s60, s58, 3
    s_and_b32 s49, s59, 3
    s_lshl2_add_u32 s49, s60, s49
    s_mov_b32 s10, 0x126000
    s_mov_b32 s11, s47
    s_mov_b32 s37, s49
    s_waitcnt lgkmcnt(0)
    buffer_load_dwordx4 v16, s[4:7], 0 offen offset:0 lds
    buffer_load_dwordx4 v17, s[4:7], 0 offen offset:1024 lds
    buffer_load_dwordx4 v18, s[4:7], 0 offen offset:2048 lds
    buffer_load_dwordx4 v19, s[4:7], 0 offen offset:3072 lds
    v_lshrrev_b32_e64 v15, 5, v0
    v_bfe_u32 v13, v0, 2, 2
    v_lshl_add_u32 v57, v15, 2, v13
    v_and_b32 v5, 1, v5
    v_and_b32 v14, 3, v0
    v_lshl_add_u32 v63, v5, 2, v14
    v_mul_u32_u24 v4, 2688, v57
    v_lshl_add_u32 v4, v63, 4, v4
    s_mul_i32 s62, s48, 43008
    s_add_u32 s60, s37, 7
    s_lshl_b32 s60, s60, 7
    s_add_u32 s59, s62, s60
    s_cmp_ge_u32 s37, 14
    s_cselect_b32 s59, 2.0, s59
    v_add_u32 v20, s59, v4
    s_lshl_b32 s65, s48, 11
    v_add_u32 v21, 20480, v20
    s_add_u32 s65, s65, 98304
    s_mov_b32 s71, 0
    s_add_u32 m0, s65, 0
    s_nop 0
    buffer_load_dwordx4 v20, s[8:11], s71 offen offset:0 lds
    buffer_load_dwordx4 v21, s[8:11], s71 offen offset:1024 lds
    s_lshl2_add_u32 s58, s2, s48
    v_lshlrev_b32 v4, 7, v0
    s_mul_i32 s59, s58, 1792
    s_mul_i32 s58, s58, 1280
    s_mov_b64 exec, 0x3f7e
    buffer_load_dword v3, v4, s[4:7], s59 offen
    s_mov_b64 exec, 0x3ff
    buffer_load_dword v3, v4, s[8:11], s58 offen
    s_mov_b64 exec, -1
    s_mov_b32 s71, 172032
    s_add_u32 m0, s65, 8192
    s_nop 0
    buffer_load_dwordx4 v20, s[8:11], s71 offen offset:0 lds
    buffer_load_dwordx4 v21, s[8:11], s71 offen offset:1024 lds
    s_mov_b32 s42, 0x1000000
    s_mov_b32 s43, s47
    v_mov_b32 v34, 0
    s_lshl4_add_u32 s72, s37, s50
    s_sub_u32 s58, s72, 240
    s_cmp_ge_u32 s58, 3
    s_cbranch_scc0 L_rare_1
L_back_2:
    v_lshlrev_b32 v4, 6, v13
    v_lshl_add_u32 v10, v14, 3, v4
    v_lshl_add_u32 v4, v5, 5, v4
    v_and_b32_e64 v13, 1, v0
    v_lshl_add_u32 v4, v13, 4, v4
    v_and_b32_e64 v13, 2, v0
    v_lshl_add_u32 v4, v13, 2, v4
    v_lshl_add_u32 v13, v15, 10, v4
    v_add_u32 v26, 98304, v13
    v_add_u32_e64 v54, s65, v13
    v_lshl_add_u32 v55, v15, 9, v4
    v_and_b32_e64 v4, 31, v0
    v_bfe_u32 v13, v0, 1, 3
    v_xor_b32_e64 v13, v13, v15
    v_lshl_add_u32 v5, v4, 7, s64
    v_lshl_add_u32 v22, v13, 4, v5
    v_xor_b32 v23, 32, v22
    v_xor_b32 v24, 64, v22
    v_xor_b32 v25, 96, v22
    s_mov_b32 s54, 0x3f803f80
    v_lshlrev_b32 v1, 4, v0
    v_mov_b32 v28, 0
    v_mov_b32 v29, 0
    v_mov_b32 v30, 0
    v_mov_b32_e64 v31, 0
    v_mul_u32_u24 v62, 7168, v15
    v_lshl_add_u32 v62, v4, 4, v62
    s_lshl_b32 s63, s48, 10
    v_mov_b32 v27, v55
    v_add_u32 v55, s63, v55
    s_mul_i32 s60, s49, 56
    s_andn2_b32 s60, s60, 15
    s_add_u32 s59, s62, s60
    v_lshrrev_b32_e64 v4, 2, v0
    v_mul_u32_u24 v4, 2688, v4
    v_lshl_add_u32 v4, v14, 4, v4
    v_add_u32_e64 v53, s59, v4
    s_lshl2_add_u32 s58, s48, 156672
    v_add_u32 v60, s58, v1
    v_and_b32 v117, 31, v0
    v_lshl_add_u32 v117, v117, 6, s64
    v_bfe_u32 v5, v0, 1, 3
    v_lshrrev_b32 v13, 5, v0
    v_lshlrev_b32 v14, 1, v13
    v_xor_b32_e64 v5, v5, v14
    v_lshl_add_u32 v112, v5, 3, v117
    v_xor_b32 v113, 8, v112
    v_xor_b32 v114, 32, v112
    v_xor_b32_e64 v115, 40, v112
    v_bfe_u32 v5, v0, 2, 2
    v_lshl_add_u32 v13, v13, 2, v5
    v_lshrrev_b32_e64 v5, 1, v13
    v_bfe_u32 v14, v0, 4, 1
    v_and_b32_e64 v117, 3, v0
    v_lshl_add_u32 v14, v14, 2, v117
    v_xor_b32_e64 v14, v14, v5
    v_lshl_add_u32 v13, v13, 6, s64
    v_lshl_add_u32 v116, v14, 3, v13
    v_xor_b32 v117, 32, v116
    v_mov_b32 v52, 0
    v_mov_b32 v35, 0
    v_mov_b32 v38, 0
    v_mov_b32 v39, 0
    v_mov_b32 v42, 0
    v_mov_b32_e64 v43, 0
    s_mov_b64 s[28:29], s[18:19]
    s_mov_b64 s[32:33], s[22:23]
    s_mov_b32 s18, 0x700000
    s_mov_b32 s19, 0x20000
    s_mov_b32 s14, 0x62000
    s_mov_b32 s15, 0x20000
    s_mov_b32 s30, 0xe00
    s_mov_b32 s31, 0x20000
    s_mov_b32 s22, 0x700000
    s_mov_b32 s23, 0x20000
    s_mov_b32 s34, 0x1000
    s_mov_b32 s35, 0x20000
    s_and_b32 s60, s2, 1
    s_bfe_u32 s51, s2, 0x30003
    s_lshr_b32 s56, s2, 6
    s_lshl2_add_u32 s56, s60, s56
    s_bfe_u32 s60, s2, 0x20001
    s_lshl3_add_u32 s52, s60, s56
    s_sub_u32 s53, s52, s60
    s_mov_b32 s3, s48
    s_mul_i32 s57, s48, 24576
    s_add_u32 s57, s57, 57344
    s_bitcmp1_b32 s3, 1
    s_cselect_b32 s61, 0, 4
    v_xor_b32_e64 v5, s61, v63
    v_mul_u32_u24 v4, 896, v57
    s_mul_i32 s61, s48, 784
    s_add_u32 s61, s61, s51
    s_lshl_b32 s61, s61, 7
    s_cmp_eq_u32 s51, 7
    s_cselect_b32 s61, 2.0, s61
    v_lshl_add_u32 v4, v5, 4, v4
    v_add_u32_e64 v220, s61, v4
    v_add_u32 v221, 6144, v220
    v_add_u32 v222, 12288, v220
    v_add_u32 v223, 18432, v220
    s_mov_b64 exec, 0
    s_cmp_eq_u32 s48, 0
    s_cbranch_scc1 L_ws0_1
    s_cmp_eq_u32 s48, 1
    s_cbranch_scc1 L_ws0_2
    s_cmp_eq_u32 s48, 2
    s_cbranch_scc1 L_ws0_3
    s_cmp_eq_u32 s48, 3
    s_cbranch_scc1 L_ws0_4
L_wr0:
    s_mov_b64 exec, -1
    s_add_u32 m0, s64, 3968
    s_nop 0
    buffer_load_dwordx4 v16, s[4:7], 0 offen offset:128 lds
    buffer_load_dwordx4 v17, s[4:7], 0 offen offset:1152 lds
    buffer_load_dwordx4 v18, s[4:7], 0 offen offset:2176 lds
    buffer_load_dwordx4 v19, s[4:7], 0 offen offset:3200 lds
    s_mov_b32 s71, 344064
    s_add_u32 m0, s65, 16384
    s_nop 0
    buffer_load_dwordx4 v20, s[8:11], s71 offen offset:0 lds
    buffer_load_dwordx4 v21, s[8:11], s71 offen offset:1024 lds
    s_waitcnt vmcnt(10)
    s_barrier
    ds_read_b128 v[120:123], v22 offset:0
    ds_read_b128 v[124:127], v23 offset:0
    ds_read_b128 v[128:131], v24 offset:0
    ds_read_b128 v[132:135], v25 offset:0
    ds_read_b64_tr_b16 v[44:45], v54 offset:0
    ds_read_b64_tr_b16 v[46:47], v54 offset:512
    ds_read_b64_tr_b16 v[48:49], v54 offset:256
    ds_read_b64_tr_b16 v[50:51], v54 offset:768
    ds_read_b64_tr_b16 a[0:1], v26 offset:0
    ds_read_b64_tr_b16 a[2:3], v26 offset:512
    ds_read_b64_tr_b16 a[4:5], v26 offset:256
    ds_read_b64_tr_b16 a[6:7], v26 offset:768
    ds_read_b64_tr_b16 a[8:9], v26 offset:2048
    ds_read_b64_tr_b16 a[10:11], v26 offset:2560
    ds_read_b64_tr_b16 a[12:13], v26 offset:2304
    ds_read_b64_tr_b16 a[14:15], v26 offset:2816
    ds_read_b64_tr_b16 a[16:17], v26 offset:4096
    ds_read_b64_tr_b16 a[18:19], v26 offset:4608
    ds_read_b64_tr_b16 a[20:21], v26 offset:4352
    ds_read_b64_tr_b16 a[22:23], v26 offset:4864
    ds_read_b64_tr_b16 a[24:25], v26 offset:6144
    ds_read_b64_tr_b16 a[26:27], v26 offset:6656
    ds_read_b64_tr_b16 a[28:29], v26 offset:6400
    ds_read_b64_tr_b16 a[30:31], v26 offset:6912
    s_add_u32 m0, s64, 7936
    s_nop 0
    buffer_load_dwordx4 v16, s[4:7], 0 offen offset:256 lds
    buffer_load_dwordx4 v17, s[4:7], 0 offen offset:1280 lds
    s_waitcnt lgkmcnt(15)
    v_dot2c_f32_bf16 v28, s54, v120
    v_dot2c_f32_bf16 v29, v120, v120
    v_dot2c_f32_bf16 v28, s54, v121
    v_dot2c_f32_bf16 v29, v121, v121
    v_dot2c_f32_bf16 v28, s54, v122
    v_dot2c_f32_bf16 v29, v122, v122
    v_dot2c_f32_bf16 v28, s54, v123
    v_dot2c_f32_bf16 v29, v123, v123
    v_dot2c_f32_bf16 v28, s54, v124
    v_dot2c_f32_bf16 v29, v124, v124
    v_dot2c_f32_bf16 v28, s54, v125
    v_dot2c_f32_bf16 v29, v125, v125
    v_dot2c_f32_bf16 v28, s54, v126
    v_dot2c_f32_bf16 v29, v126, v126
    v_dot2c_f32_bf16 v28, s54, v127
    v_dot2c_f32_bf16 v29, v127, v127
    v_dot2c_f32_bf16 v28, s54, v128
    v_dot2c_f32_bf16 v29, v128, v128
    v_dot2c_f32_bf16 v28, s54, v129
    v_dot2c_f32_bf16 v29, v129, v129
    v_dot2c_f32_bf16 v28, s54, v130
    v_dot2c_f32_bf16 v29, v130, v130
    v_dot2c_f32_bf16 v28, s54, v131
    v_dot2c_f32_bf16 v29, v131, v131
    v_dot2c_f32_bf16 v28, s54, v132
    v_dot2c_f32_bf16 v29, v132, v132
    v_dot2c_f32_bf16 v28, s54, v133
    v_dot2c_f32_bf16 v29, v133, v133
    v_dot2c_f32_bf16 v28, s54, v134
    v_dot2c_f32_bf16 v29, v134, v134
    v_dot2c_f32_bf16 v28, s54, v135
    v_dot2c_f32_bf16 v29, v135, v135
    v_dot2c_f32_bf16 v30, s54, v44
    v_dot2c_f32_bf16 v31, s54, v48
    v_dot2c_f32_bf16 v30, s54, v45
    v_dot2c_f32_bf16 v31, s54, v49
    v_dot2c_f32_bf16 v30, s54, v46
    v_dot2c_f32_bf16 v31, s54, v50
    v_dot2c_f32_bf16 v30, s54, v47
    v_dot2c_f32_bf16 v31, s54, v51
    s_mov_b64 exec, 0
    s_cmp_eq_u32 s48, 0
    s_cbranch_scc1 L_ws1_1
    s_cmp_eq_u32 s48, 1
    s_cbranch_scc1 L_ws1_2
    s_cmp_eq_u32 s48, 2
    s_cbranch_scc1 L_ws1_3
    s_cmp_eq_u32 s48, 3
    s_cbranch_scc1 L_ws1_4
L_wr1:
    s_mov_b64 exec, -1
    buffer_load_dwordx4 v18, s[4:7], 0 offen offset:2304 lds
    buffer_load_dwordx4 v19, s[4:7], 0 offen offset:3328 lds
    s_mov_b32 s71, 516096
    s_add_u32 m0, s65, 24576
    s_nop 0
    buffer_load_dwordx4 v20, s[8:11], s71 offen offset:0 lds
    buffer_load_dwordx4 v21, s[8:11], s71 offen offset:1024 lds
    s_waitcnt vmcnt(6) lgkmcnt(0)
    s_barrier
    s_sub_u32 s58, s72, 240
    s_cmp_lt_u32 s58, 3
    s_cbranch_scc1 L_rare_3
L_back_4:
    v_mfma_f32_32x32x16_bf16 v[64:79], a[0:3], v[120:123], 0
    s_add_u32 m0, s64, 11904
    ds_read_b128 v[136:139], v22 offset:4096
    ds_read_b128 v[140:143], v23 offset:4096
    ds_read_b128 v[144:147], v24 offset:4096
    v_mfma_f32_32x32x16_bf16 v[80:95], a[4:7], v[120:123], 0
    buffer_load_dwordx4 v16, s[4:7], 0 offen offset:384 lds
    ds_read_b128 v[148:151], v25 offset:4096
    ds_read_b64_tr_b16 v[96:97], v54 offset:8192
    ds_read_b64_tr_b16 v[98:99], v54 offset:8704
    ds_read_b64_tr_b16 v[100:101], v54 offset:8448
    v_mfma_f32_32x32x16_bf16 v[64:79], a[8:11], v[124:127], v[64:79]
    buffer_load_dwordx4 v17, s[4:7], 0 offen offset:1408 lds
    ds_read_b64_tr_b16 v[102:103], v54 offset:8960
    ds_read_b64_tr_b16 v[44:45], v54 offset:16384
    ds_read_b64_tr_b16 v[46:47], v54 offset:16896
    v_mfma_f32_32x32x16_bf16 v[80:95], a[12:15], v[124:127], v[80:95]
    buffer_load_dwordx4 v18, s[4:7], 0 offen offset:2432 lds
    ds_read_b64_tr_b16 v[48:49], v54 offset:16640
    ds_read_b64_tr_b16 v[50:51], v54 offset:17152
    ds_read_b64_tr_b16 a[32:33], v26 offset:8192
    ds_read_b64_tr_b16 a[34:35], v26 offset:8704
    v_mfma_f32_32x32x16_bf16 v[64:79], a[16:19], v[128:131], v[64:79]
    buffer_load_dwordx4 v19, s[4:7], 0 offen offset:3456 lds
    ds_read_b64_tr_b16 a[36:37], v26 offset:8448
    ds_read_b64_tr_b16 a[38:39], v26 offset:8960
    ds_read_b64_tr_b16 a[40:41], v26 offset:10240
    v_mfma_f32_32x32x16_bf16 v[80:95], a[20:23], v[128:131], v[80:95]
    s_mov_b32 s71, 688128
    ds_read_b64_tr_b16 a[42:43], v26 offset:10752
    ds_read_b64_tr_b16 a[44:45], v26 offset:10496
    ds_read_b64_tr_b16 a[46:47], v26 offset:11008
    ds_read_b64_tr_b16 a[48:49], v26 offset:12288
    v_mfma_f32_32x32x16_bf16 v[64:79], a[24:27], v[132:135], v[64:79]
    s_add_u32 m0, s65, 32768
    ds_read_b64_tr_b16 a[50:51], v26 offset:12800
    ds_read_b64_tr_b16 a[52:53], v26 offset:12544
    ds_read_b64_tr_b16 a[54:55], v26 offset:13056
    v_mfma_f32_32x32x16_bf16 v[80:95], a[28:31], v[132:135], v[80:95]
    buffer_load_dwordx4 v20, s[8:11], s71 offen offset:0 lds
    ds_read_b64_tr_b16 a[56:57], v26 offset:14336
    buffer_load_dwordx4 v21, s[8:11], s71 offen offset:1024 lds
    ds_read_b64_tr_b16 a[58:59], v26 offset:14848
    ds_read_b64_tr_b16 a[60:61], v26 offset:14592
    ds_read_b64_tr_b16 a[62:63], v26 offset:15104
    s_waitcnt lgkmcnt(15)
    v_dot2c_f32_bf16 v30, s54, v44
    v_dot2c_f32_bf16 v31, s54, v48
    v_dot2c_f32_bf16 v30, s54, v45
    v_dot2c_f32_bf16 v31, s54, v49
    v_dot2c_f32_bf16 v30, s54, v46
    v_dot2c_f32_bf16 v31, s54, v50
    v_dot2c_f32_bf16 v30, s54, v47
    v_dot2c_f32_bf16 v31, s54, v51
    v_dot2c_f32_bf16 v30, s54, v96
    v_dot2c_f32_bf16 v31, s54, v100
    v_dot2c_f32_bf16 v30, s54, v97
    v_dot2c_f32_bf16 v31, s54, v101
    v_dot2c_f32_bf16 v30, s54, v98
    v_dot2c_f32_bf16 v31, s54, v102
    v_dot2c_f32_bf16 v30, s54, v99
    v_dot2c_f32_bf16 v31, s54, v103
    v_dot2c_f32_bf16 v28, s54, v136
    v_dot2c_f32_bf16 v29, v136, v136
    v_dot2c_f32_bf16 v28, s54, v137
    v_dot2c_f32_bf16 v29, v137, v137
    v_dot2c_f32_bf16 v28, s54, v138
    v_dot2c_f32_bf16 v29, v138, v138
    v_dot2c_f32_bf16 v28, s54, v139
    v_dot2c_f32_bf16 v29, v139, v139
    v_dot2c_f32_bf16 v28, s54, v140
    v_dot2c_f32_bf16 v29, v140, v140
    v_dot2c_f32_bf16 v28, s54, v141
    v_dot2c_f32_bf16 v29, v141, v141
    v_dot2c_f32_bf16 v28, s54, v142
    v_dot2c_f32_bf16 v29, v142, v142
    v_dot2c_f32_bf16 v28, s54, v143
    v_dot2c_f32_bf16 v29, v143, v143
    v_dot2c_f32_bf16 v28, s54, v144
    v_dot2c_f32_bf16 v29, v144, v144
    v_dot2c_f32_bf16 v28, s54, v145
    v_dot2c_f32_bf16 v29, v145, v145
    v_dot2c_f32_bf16 v28, s54, v146
    v_dot2c_f32_bf16 v29, v146, v146
    v_dot2c_f32_bf16 v28, s54, v147
    v_dot2c_f32_bf16 v29, v147, v147
    v_dot2c_f32_bf16 v28, s54, v148
    v_dot2c_f32_bf16 v29, v148, v148
    v_dot2c_f32_bf16 v28, s54, v149
    v_dot2c_f32_bf16 v29, v149, v149
    v_dot2c_f32_bf16 v28, s54, v150
    v_dot2c_f32_bf16 v29, v150, v150
    v_dot2c_f32_bf16 v28, s54, v151
    v_dot2c_f32_bf16 v29, v151, v151
    s_waitcnt vmcnt(6) lgkmcnt(0)
    s_barrier
    v_mfma_f32_32x32x16_bf16 v[64:79], a[32:35], v[136:139], v[64:79]
    s_add_u32 m0, s64, -512
    ds_read_b128 v[152:155], v22 offset:8192
    ds_read_b128 v[156:159], v23 offset:8192
    ds_read_b128 v[160:163], v24 offset:8192
    v_mfma_f32_32x32x16_bf16 v[80:95], a[36:39], v[136:139], v[80:95]
    buffer_load_dwordx4 v16, s[4:7], 0 offen offset:512 lds
    ds_read_b128 v[164:167], v25 offset:8192
    ds_read_b64_tr_b16 v[44:45], v54 offset:24576
    ds_read_b64_tr_b16 v[46:47], v54 offset:25088
    v_mfma_f32_32x32x16_bf16 v[64:79], a[40:43], v[140:143], v[64:79]
    buffer_load_dwordx4 v17, s[4:7], 0 offen offset:1536 lds
    ds_read_b64_tr_b16 v[48:49], v54 offset:24832
    ds_read_b64_tr_b16 v[50:51], v54 offset:25344
    ds_read_b64_tr_b16 a[0:1], v26 offset:16384
    v_mfma_f32_32x32x16_bf16 v[80:95], a[44:47], v[140:143], v[80:95]
    buffer_load_dwordx4 v18, s[4:7], 0 offen offset:2560 lds
    ds_read_b64_tr_b16 a[2:3], v26 offset:16896
    ds_read_b64_tr_b16 a[4:5], v26 offset:16640
    ds_read_b64_tr_b16 a[6:7], v26 offset:17152
    v_mfma_f32_32x32x16_bf16 v[64:79], a[48:51], v[144:147], v[64:79]
    buffer_load_dwordx4 v19, s[4:7], 0 offen offset:3584 lds
    ds_read_b64_tr_b16 a[8:9], v26 offset:18432
    ds_read_b64_tr_b16 a[10:11], v26 offset:18944
    ds_read_b64_tr_b16 a[12:13], v26 offset:18688
    v_mfma_f32_32x32x16_bf16 v[80:95], a[52:55], v[144:147], v[80:95]
    s_mov_b32 s71, 860160
    ds_read_b64_tr_b16 a[14:15], v26 offset:19200
    ds_read_b64_tr_b16 a[16:17], v26 offset:20480
    ds_read_b64_tr_b16 a[18:19], v26 offset:20992
    v_mfma_f32_32x32x16_bf16 v[64:79], a[56:59], v[148:151], v[64:79]
    s_add_u32 m0, s65, 40960
    ds_read_b64_tr_b16 a[20:21], v26 offset:20736
    ds_read_b64_tr_b16 a[22:23], v26 offset:21248
    ds_read_b64_tr_b16 a[24:25], v26 offset:22528
    v_mfma_f32_32x32x16_bf16 v[80:95], a[60:63], v[148:151], v[80:95]
    buffer_load_dwordx4 v20, s[8:11], s71 offen offset:0 lds
    ds_read_b64_tr_b16 a[26:27], v26 offset:23040
    buffer_load_dwordx4 v21, s[8:11], s71 offen offset:1024 lds
    ds_read_b64_tr_b16 a[28:29], v26 offset:22784
    ds_read_b64_tr_b16 a[30:31], v26 offset:23296
    s_waitcnt lgkmcnt(15)
    v_dot2c_f32_bf16 v30, s54, v44
    v_dot2c_f32_bf16 v31, s54, v48
    v_dot2c_f32_bf16 v30, s54, v45
    v_dot2c_f32_bf16 v31, s54, v49
    v_dot2c_f32_bf16 v30, s54, v46
    v_dot2c_f32_bf16 v31, s54, v50
    v_dot2c_f32_bf16 v30, s54, v47
    v_dot2c_f32_bf16 v31, s54, v51
    v_dot2c_f32_bf16 v28, s54, v152
    v_dot2c_f32_bf16 v29, v152, v152
    v_dot2c_f32_bf16 v28, s54, v153
    v_dot2c_f32_bf16 v29, v153, v153
    v_dot2c_f32_bf16 v28, s54, v154
    v_dot2c_f32_bf16 v29, v154, v154
    v_dot2c_f32_bf16 v28, s54, v155
    v_dot2c_f32_bf16 v29, v155, v155
    v_dot2c_f32_bf16 v28, s54, v156
    v_dot2c_f32_bf16 v29, v156, v156
    v_dot2c_f32_bf16 v28, s54, v157
    v_dot2c_f32_bf16 v29, v157, v157
    v_dot2c_f32_bf16 v28, s54, v158
    v_dot2c_f32_bf16 v29, v158, v158
    v_dot2c_f32_bf16 v28, s54, v159
    v_dot2c_f32_bf16 v29, v159, v159
    v_dot2c_f32_bf16 v28, s54, v160
    v_dot2c_f32_bf16 v29, v160, v160
    v_dot2c_f32_bf16 v28, s54, v161
    v_dot2c_f32_bf16 v29, v161, v161
    v_dot2c_f32_bf16 v28, s54, v162
    v_dot2c_f32_bf16 v29, v162, v162
    v_dot2c_f32_bf16 v28, s54, v163
    v_dot2c_f32_bf16 v29, v163, v163
    v_dot2c_f32_bf16 v28, s54, v164
    v_dot2c_f32_bf16 v29, v164, v164
    v_dot2c_f32_bf16 v28, s54, v165
    v_dot2c_f32_bf16 v29, v165, v165
    v_dot2c_f32_bf16 v28, s54, v166
    v_dot2c_f32_bf16 v29, v166, v166
    v_dot2c_f32_bf16 v28, s54, v167
    v_dot2c_f32_bf16 v29, v167, v167
    s_waitcnt vmcnt(6) lgkmcnt(0)
    s_barrier
    v_mfma_f32_32x32x16_bf16 v[64:79], a[0:3], v[152:155], v[64:79]
    s_add_u32 m0, s64, 3456
    ds_read_b128 v[168:171], v22 offset:12288
    ds_read_b128 v[172:175], v23 offset:12288
    ds_read_b128 v[176:179], v24 offset:12288
    v_mfma_f32_32x32x16_bf16 v[80:95], a[4:7], v[152:155], v[80:95]
    buffer_load_dwordx4 v16, s[4:7], 0 offen offset:640 lds
    ds_read_b128 v[180:183], v25 offset:12288
    ds_read_b64_tr_b16 v[44:45], v54 offset:32768
    ds_read_b64_tr_b16 v[46:47], v54 offset:33280
    v_mfma_f32_32x32x16_bf16 v[64:79], a[8:11], v[156:159], v[64:79]
    buffer_load_dwordx4 v17, s[4:7], 0 offen offset:1664 lds
    ds_read_b64_tr_b16 v[48:49], v54 offset:33024
    ds_read_b64_tr_b16 v[50:51], v54 offset:33536
    ds_read_b64_tr_b16 a[32:33], v26 offset:24576
    v_mfma_f32_32x32x16_bf16 v[80:95], a[12:15], v[156:159], v[80:95]
    buffer_load_dwordx4 v18, s[4:7], 0 offen offset:2688 lds
    ds_read_b64_tr_b16 a[34:35], v26 offset:25088
    ds_read_b64_tr_b16 a[36:37], v26 offset:24832
    ds_read_b64_tr_b16 a[38:39], v26 offset:25344
    v_mfma_f32_32x32x16_bf16 v[64:79], a[16:19], v[160:163], v[64:79]
    buffer_load_dwordx4 v19, s[4:7], 0 offen offset:3712 lds
    ds_read_b64_tr_b16 a[40:41], v26 offset:26624
    ds_read_b64_tr_b16 a[42:43], v26 offset:27136
    ds_read_b64_tr_b16 a[44:45], v26 offset:26880
    v_mfma_f32_32x32x16_bf16 v[80:95], a[20:23], v[160:163], v[80:95]
    s_mov_b32 s71, 1032192
    ds_read_b64_tr_b16 a[46:47], v26 offset:27392
    ds_read_b64_tr_b16 a[48:49], v26 offset:28672
    ds_read_b64_tr_b16 a[50:51], v26 offset:29184
    v_mfma_f32_32x32x16_bf16 v[64:79], a[24:27], v[164:167], v[64:79]
    s_add_u32 m0, s65, 49152
    ds_read_b64_tr_b16 a[52:53], v26 offset:28928
    ds_read_b64_tr_b16 a[54:55], v26 offset:29440
    ds_read_b64_tr_b16 a[56:57], v26 offset:30720
    v_mfma_f32_32x32x16_bf16 v[80:95], a[28:31], v[164:167], v[80:95]
    buffer_load_dwordx4 v20, s[8:11], s71 offen offset:0 lds
    ds_read_b64_tr_b16 a[58:59], v26 offset:31232
    buffer_load_dwordx4 v21, s[8:11], s71 offen offset:1024 lds
    ds_read_b64_tr_b16 a[60:61], v26 offset:30976
    ds_read_b64_tr_b16 a[62:63], v26 offset:31488
    s_waitcnt lgkmcnt(15)
    v_dot2c_f32_bf16 v30, s54, v44
    v_dot2c_f32_bf16 v31, s54, v48
    v_dot2c_f32_bf16 v30, s54, v45
    v_dot2c_f32_bf16 v31, s54, v49
    v_dot2c_f32_bf16 v30, s54, v46
    v_dot2c_f32_bf16 v31, s54, v50
    v_dot2c_f32_bf16 v30, s54, v47
    v_dot2c_f32_bf16 v31, s54, v51
    v_dot2c_f32_bf16 v28, s54, v168
    v_dot2c_f32_bf16 v29, v168, v168
    v_dot2c_f32_bf16 v28, s54, v169
    v_dot2c_f32_bf16 v29, v169, v169
    v_dot2c_f32_bf16 v28, s54, v170
    v_dot2c_f32_bf16 v29, v170, v170
    v_dot2c_f32_bf16 v28, s54, v171
    v_dot2c_f32_bf16 v29, v171, v171
    v_dot2c_f32_bf16 v28, s54, v172
    v_dot2c_f32_bf16 v29, v172, v172
    v_dot2c_f32_bf16 v28, s54, v173
    v_dot2c_f32_bf16 v29, v173, v173
    v_dot2c_f32_bf16 v28, s54, v174
    v_dot2c_f32_bf16 v29, v174, v174
    v_dot2c_f32_bf16 v28, s54, v175
    v_dot2c_f32_bf16 v29, v175, v175
    v_dot2c_f32_bf16 v28, s54, v176
    v_dot2c_f32_bf16 v29, v176, v176
L_ws0_1:
    s_cbranch_execz L_wr0
    v_dot2c_f32_bf16 v28, s54, v177
    v_dot2c_f32_bf16 v29, v177, v177
    v_dot2c_f32_bf16 v28, s54, v178
    v_dot2c_f32_bf16 v29, v178, v178
    v_dot2c_f32_bf16 v28, s54, v179
    v_dot2c_f32_bf16 v29, v179, v179
    v_dot2c_f32_bf16 v28, s54, v180
    v_dot2c_f32_bf16 v29, v180, v180
    v_dot2c_f32_bf16 v28, s54, v181
    v_dot2c_f32_bf16 v29, v181, v181
    v_dot2c_f32_bf16 v28, s54, v182
    v_dot2c_f32_bf16 v29, v182, v182
    v_dot2c_f32_bf16 v28, s54, v183
    v_dot2c_f32_bf16 v29, v183, v183
    s_waitcnt vmcnt(6) lgkmcnt(0)
    s_barrier
    v_mfma_f32_32x32x16_bf16 v[64:79], a[32:35], v[168:171], v[64:79]
    s_add_u32 m0, s64, 7424
    ds_read_b128 v[184:187], v22 offset:0
    ds_read_b128 v[188:191], v23 offset:0
    ds_read_b128 v[192:195], v24 offset:0
    v_mfma_f32_32x32x16_bf16 v[80:95], a[36:39], v[168:171], v[80:95]
    buffer_load_dwordx4 v16, s[4:7], 0 offen offset:768 lds
    ds_read_b128 v[196:199], v25 offset:0
    ds_read_b64_tr_b16 v[44:45], v54 offset:40960
    ds_read_b64_tr_b16 v[46:47], v54 offset:41472
    v_mfma_f32_32x32x16_bf16 v[64:79], a[40:43], v[172:175], v[64:79]
    buffer_load_dwordx4 v17, s[4:7], 0 offen offset:1792 lds
    ds_read_b64_tr_b16 v[48:49], v54 offset:41216
    ds_read_b64_tr_b16 v[50:51], v54 offset:41728
    ds_read_b64_tr_b16 a[0:1], v26 offset:32768
    v_mfma_f32_32x32x16_bf16 v[80:95], a[44:47], v[172:175], v[80:95]
    buffer_load_dwordx4 v18, s[4:7], 0 offen offset:2816 lds
    ds_read_b64_tr_b16 a[2:3], v26 offset:33280
    ds_read_b64_tr_b16 a[4:5], v26 offset:33024
    ds_read_b64_tr_b16 a[6:7], v26 offset:33536
    v_mfma_f32_32x32x16_bf16 v[64:79], a[48:51], v[176:179], v[64:79]
    buffer_load_dwordx4 v19, s[4:7], 0 offen offset:3840 lds
    ds_read_b64_tr_b16 a[8:9], v26 offset:34816
    ds_read_b64_tr_b16 a[10:11], v26 offset:35328
    ds_read_b64_tr_b16 a[12:13], v26 offset:35072
    v_mfma_f32_32x32x16_bf16 v[80:95], a[52:55], v[176:179], v[80:95]
    s_mov_b32 s71, 0
    ds_read_b64_tr_b16 a[14:15], v26 offset:35584
    ds_read_b64_tr_b16 a[16:17], v26 offset:36864
    ds_read_b64_tr_b16 a[18:19], v26 offset:37376
    v_mfma_f32_32x32x16_bf16 v[64:79], a[56:59], v[180:183], v[64:79]
    s_add_u32 m0, s63, 0
    ds_read_b64_tr_b16 a[20:21], v26 offset:37120
    ds_read_b64_tr_b16 a[22:23], v26 offset:37632
    ds_read_b64_tr_b16 a[24:25], v26 offset:38912
    v_mfma_f32_32x32x16_bf16 v[80:95], a[60:63], v[180:183], v[80:95]
    buffer_load_dwordx4 v53, s[8:11], s71 offen lds
    ds_read_b64_tr_b16 a[26:27], v26 offset:39424
    ds_read_b64_tr_b16 a[28:29], v26 offset:39168
    ds_read_b64_tr_b16 a[30:31], v26 offset:39680
    s_waitcnt lgkmcnt(15)
    v_dot2c_f32_bf16 v30, s54, v44
    v_dot2c_f32_bf16 v31, s54, v48
    v_dot2c_f32_bf16 v30, s54, v45
    v_dot2c_f32_bf16 v31, s54, v49
    v_dot2c_f32_bf16 v30, s54, v46
    v_dot2c_f32_bf16 v31, s54, v50
    v_dot2c_f32_bf16 v30, s54, v47
    v_dot2c_f32_bf16 v31, s54, v51
    v_dot2c_f32_bf16 v28, s54, v184
    v_dot2c_f32_bf16 v29, v184, v184
    v_dot2c_f32_bf16 v28, s54, v185
    v_dot2c_f32_bf16 v29, v185, v185
    v_dot2c_f32_bf16 v28, s54, v186
    v_dot2c_f32_bf16 v29, v186, v186
    v_dot2c_f32_bf16 v28, s54, v187
    v_dot2c_f32_bf16 v29, v187, v187
    v_dot2c_f32_bf16 v28, s54, v188
    v_dot2c_f32_bf16 v29, v188, v188
    v_dot2c_f32_bf16 v28, s54, v189
    v_dot2c_f32_bf16 v29, v189, v189
    v_dot2c_f32_bf16 v28, s54, v190
    v_dot2c_f32_bf16 v29, v190, v190
    v_dot2c_f32_bf16 v28, s54, v191
    v_dot2c_f32_bf16 v29, v191, v191
    v_dot2c_f32_bf16 v28, s54, v192
    v_dot2c_f32_bf16 v29, v192, v192
    v_dot2c_f32_bf16 v28, s54, v193
    v_dot2c_f32_bf16 v29, v193, v193
    v_dot2c_f32_bf16 v28, s54, v194
    v_dot2c_f32_bf16 v29, v194, v194
    v_dot2c_f32_bf16 v28, s54, v195
    v_dot2c_f32_bf16 v29, v195, v195
    v_dot2c_f32_bf16 v28, s54, v196
    v_dot2c_f32_bf16 v29, v196, v196
    v_dot2c_f32_bf16 v28, s54, v197
    v_dot2c_f32_bf16 v29, v197, v197
    v_dot2c_f32_bf16 v28, s54, v198
    v_dot2c_f32_bf16 v29, v198, v198
    v_dot2c_f32_bf16 v28, s54, v199
    v_dot2c_f32_bf16 v29, v199, v199
    s_waitcnt vmcnt(5) lgkmcnt(0)
    s_barrier
    v_mfma_f32_32x32x16_bf16 v[64:79], a[0:3], v[184:187], v[64:79]
    s_mov_b32 s71, 172032
    ds_read_b128 v[224:227], v22 offset:4096
    ds_read_b128 v[228:231], v23 offset:4096
    ds_read_b128 v[232:235], v24 offset:4096
    v_mfma_f32_32x32x16_bf16 v[80:95], a[4:7], v[184:187], v[80:95]
    s_add_u32 m0, s63, 4096
    ds_read_b128 v[236:239], v25 offset:4096
    ds_read_b64_tr_b16 v[44:45], v54 offset:49152
    ds_read_b64_tr_b16 v[46:47], v54 offset:49664
    v_mfma_f32_32x32x16_bf16 v[64:79], a[8:11], v[188:191], v[64:79]
    buffer_load_dwordx4 v53, s[8:11], s71 offen lds
    ds_read_b64_tr_b16 v[48:49], v54 offset:49408
    ds_read_b64_tr_b16 v[50:51], v54 offset:49920
    ds_read_b64_tr_b16 a[32:33], v26 offset:40960
    v_mfma_f32_32x32x16_bf16 v[80:95], a[12:15], v[188:191], v[80:95]
    s_mov_b32 s71, 344064
    ds_read_b64_tr_b16 a[34:35], v26 offset:41472
    ds_read_b64_tr_b16 a[36:37], v26 offset:41216
    ds_read_b64_tr_b16 a[38:39], v26 offset:41728
    v_mfma_f32_32x32x16_bf16 v[64:79], a[16:19], v[192:195], v[64:79]
    s_add_u32 m0, s63, 8192
    ds_read_b64_tr_b16 a[40:41], v26 offset:43008
    ds_read_b64_tr_b16 a[42:43], v26 offset:43520
    ds_read_b64_tr_b16 a[44:45], v26 offset:43264
    v_mfma_f32_32x32x16_bf16 v[80:95], a[20:23], v[192:195], v[80:95]
    buffer_load_dwordx4 v53, s[8:11], s71 offen lds
    ds_read_b64_tr_b16 a[46:47], v26 offset:43776
    ds_read_b64_tr_b16 a[48:49], v26 offset:45056
    ds_read_b64_tr_b16 a[50:51], v26 offset:45568
    v_mfma_f32_32x32x16_bf16 v[64:79], a[24:27], v[196:199], v[64:79]
    s_mov_b32 s71, 516096
    ds_read_b64_tr_b16 a[52:53], v26 offset:45312
    ds_read_b64_tr_b16 a[54:55], v26 offset:45824
    ds_read_b64_tr_b16 a[56:57], v26 offset:47104
    v_mfma_f32_32x32x16_bf16 v[80:95], a[28:31], v[196:199], v[80:95]
    s_add_u32 m0, s63, 12288
    ds_read_b64_tr_b16 a[58:59], v26 offset:47616
    buffer_load_dwordx4 v53, s[8:11], s71 offen lds
    ds_read_b64_tr_b16 a[60:61], v26 offset:47360
    ds_read_b64_tr_b16 a[62:63], v26 offset:47872
    s_waitcnt lgkmcnt(15)
    v_dot2c_f32_bf16 v30, s54, v44
    v_dot2c_f32_bf16 v31, s54, v48
    v_dot2c_f32_bf16 v30, s54, v45
    v_dot2c_f32_bf16 v31, s54, v49
    v_dot2c_f32_bf16 v30, s54, v46
    v_dot2c_f32_bf16 v31, s54, v50
    v_dot2c_f32_bf16 v30, s54, v47
    v_dot2c_f32_bf16 v31, s54, v51
    v_dot2c_f32_bf16 v28, s54, v224
    v_dot2c_f32_bf16 v29, v224, v224
    v_dot2c_f32_bf16 v28, s54, v225
    v_dot2c_f32_bf16 v29, v225, v225
    ds_write_b32 v60, v30
    ds_write_b32 v60, v31 offset:1024
    v_dot2c_f32_bf16 v28, s54, v226
    v_dot2c_f32_bf16 v29, v226, v226
    v_dot2c_f32_bf16 v28, s54, v227
    v_dot2c_f32_bf16 v29, v227, v227
    v_dot2c_f32_bf16 v28, s54, v228
    v_dot2c_f32_bf16 v29, v228, v228
    v_dot2c_f32_bf16 v28, s54, v229
    v_dot2c_f32_bf16 v29, v229, v229
    v_dot2c_f32_bf16 v28, s54, v230
    v_dot2c_f32_bf16 v29, v230, v230
    v_dot2c_f32_bf16 v28, s54, v231
    v_dot2c_f32_bf16 v29, v231, v231
    v_dot2c_f32_bf16 v28, s54, v232
    v_dot2c_f32_bf16 v29, v232, v232
    v_dot2c_f32_bf16 v28, s54, v233
    v_dot2c_f32_bf16 v29, v233, v233
    v_dot2c_f32_bf16 v28, s54, v234
    v_dot2c_f32_bf16 v29, v234, v234
    v_dot2c_f32_bf16 v28, s54, v235
    v_dot2c_f32_bf16 v29, v235, v235
    v_dot2c_f32_bf16 v28, s54, v236
    v_dot2c_f32_bf16 v29, v236, v236
    v_dot2c_f32_bf16 v28, s54, v237
    v_dot2c_f32_bf16 v29, v237, v237
    v_dot2c_f32_bf16 v28, s54, v238
    v_dot2c_f32_bf16 v29, v238, v238
    v_dot2c_f32_bf16 v28, s54, v239
    v_dot2c_f32_bf16 v29, v239, v239
    s_waitcnt vmcnt(4) lgkmcnt(0)
    s_barrier
    s_cmp_lt_u32 s37, 14
    s_cbranch_scc0 L_rare_5
L_back_6:
    v_mfma_f32_32x32x16_bf16 v[64:79], a[32:35], v[224:227], v[64:79]
    s_mov_b32 s71, 688128
    v_add_u32 v13, 156672, v1
    ds_read_b128 v[44:47], v13 offset:0
    v_mfma_f32_32x32x16_bf16 v[80:95], a[36:39], v[224:227], v[80:95]
    s_add_u32 m0, s63, 16384
    ds_read_b128 v[48:51], v13 offset:1024
    ds_read_b128 v[240:243], v22 offset:8192
    ds_read_b128 v[244:247], v23 offset:8192
    v_mfma_f32_32x32x16_bf16 v[64:79], a[40:43], v[228:231], v[64:79]
    buffer_load_dwordx4 v53, s[8:11], s71 offen lds
    ds_read_b128 v[248:251], v24 offset:8192
    ds_read_b128 v[252:255], v25 offset:8192
    ds_read_b64_tr_b16 a[0:1], v26 offset:49152
    v_mfma_f32_32x32x16_bf16 v[80:95], a[44:47], v[228:231], v[80:95]
    s_mov_b32 s71, 860160
    ds_read_b64_tr_b16 a[2:3], v26 offset:49664
    ds_read_b64_tr_b16 a[4:5], v26 offset:49408
    ds_read_b64_tr_b16 a[6:7], v26 offset:49920
    v_mfma_f32_32x32x16_bf16 v[64:79], a[48:51], v[232:235], v[64:79]
    s_add_u32 m0, s63, 20480
    ds_read_b64_tr_b16 a[8:9], v26 offset:51200
    ds_read_b64_tr_b16 a[10:11], v26 offset:51712
    ds_read_b64_tr_b16 a[12:13], v26 offset:51456
    v_mfma_f32_32x32x16_bf16 v[80:95], a[52:55], v[232:235], v[80:95]
    buffer_load_dwordx4 v53, s[8:11], s71 offen lds
    ds_read_b64_tr_b16 a[14:15], v26 offset:51968
    ds_read_b64_tr_b16 a[16:17], v26 offset:53248
    ds_read_b64_tr_b16 a[18:19], v26 offset:53760
    v_mfma_f32_32x32x16_bf16 v[64:79], a[56:59], v[236:239], v[64:79]
    s_mov_b32 s71, 1032192
    ds_read_b64_tr_b16 a[20:21], v26 offset:53504
    ds_read_b64_tr_b16 a[22:23], v26 offset:54016
    ds_read_b64_tr_b16 a[24:25], v26 offset:55296
    v_mfma_f32_32x32x16_bf16 v[80:95], a[60:63], v[236:239], v[80:95]
    s_add_u32 m0, s63, 24576
    ds_read_b64_tr_b16 a[26:27], v26 offset:55808
    buffer_load_dwordx4 v53, s[8:11], s71 offen lds
    ds_read_b64_tr_b16 a[28:29], v26 offset:55552
    ds_read_b64_tr_b16 a[30:31], v26 offset:56064
    s_waitcnt lgkmcnt(15)
    v_dot2c_f32_bf16 v28, s54, v240
    v_dot2c_f32_bf16 v29, v240, v240
    v_dot2c_f32_bf16 v28, s54, v241
    v_dot2c_f32_bf16 v29, v241, v241
    v_dot2c_f32_bf16 v28, s54, v242
    v_dot2c_f32_bf16 v29, v242, v242
    v_dot2c_f32_bf16 v28, s54, v243
    v_dot2c_f32_bf16 v29, v243, v243
    v_dot2c_f32_bf16 v28, s54, v244
    v_dot2c_f32_bf16 v29, v244, v244
    v_dot2c_f32_bf16 v28, s54, v245
    v_dot2c_f32_bf16 v29, v245, v245
    v_dot2c_f32_bf16 v28, s54, v246
    v_dot2c_f32_bf16 v29, v246, v246
    v_dot2c_f32_bf16 v28, s54, v247
    v_dot2c_f32_bf16 v29, v247, v247
    v_dot2c_f32_bf16 v28, s54, v248
    v_dot2c_f32_bf16 v29, v248, v248
    v_dot2c_f32_bf16 v28, s54, v249
    v_dot2c_f32_bf16 v29, v249, v249
    v_dot2c_f32_bf16 v28, s54, v250
    v_dot2c_f32_bf16 v29, v250, v250
    v_dot2c_f32_bf16 v28, s54, v251
    v_dot2c_f32_bf16 v29, v251, v251
    v_dot2c_f32_bf16 v28, s54, v252
    v_dot2c_f32_bf16 v29, v252, v252
    v_dot2c_f32_bf16 v28, s54, v253
    v_dot2c_f32_bf16 v29, v253, v253
    v_dot2c_f32_bf16 v28, s54, v254
    v_dot2c_f32_bf16 v29, v254, v254
    v_dot2c_f32_bf16 v28, s54, v255
    v_dot2c_f32_bf16 v29, v255, v255
    s_waitcnt lgkmcnt(0)
    v_mfma_f32_32x32x16_bf16 v[64:79], a[0:3], v[240:243], v[64:79]
    v_mov_b32 v14, v28
    v_mov_b32 v13, v29
    v_add_f32 v30, v44, v45
    v_add_f32 v46, v46, v47
    v_add_f32 v30, v30, v46
    v_mfma_f32_32x32x16_bf16 v[64:79], a[8:11], v[244:247], v[64:79]
    v_permlane32_swap_b32 v28, v14
    v_permlane32_swap_b32 v29, v13
    v_add_f32_e64 v28, v28, v14
    v_mul_f32 v56, 0xbb124925, v28
    v_cvt_pk_bf16_f32 v32, v56, v56
    v_and_b32 v5, 0xffff0000, v32
    v_mfma_f32_32x32x16_bf16 v[64:79], a[16:19], v[248:251], v[64:79]
    v_sub_f32_e64 v5, v56, v5
    v_cvt_pk_bf16_f32 v33, v5, 0
    v_cvt_pk_bf16_f32 v37, v30, 0
    v_lshlrev_b32 v4, 16, v37
    v_sub_f32 v5, v30, v4
    v_mfma_f32_32x32x16_bf16 v[64:79], a[24:27], v[252:255], v[64:79]
    global_load_dword v61, v34, s[26:27] sc1
    v_cvt_pk_bf16_f32 v36, v4, v5
    v_add_f32_e64 v29, v29, v13
    v_mul_f32 v14, 0x3b124925, v29
    v_fma_f32 v14, -v56, v56, v14
    v_max_f32_e64 v14, 0, v14
    v_add_f32 v14, 0x3727c5ac, v14
    v_mfma_f32_32x32x16_bf16 v[64:79], v[36:39], v[32:35], v[64:79]
    v_rsq_f32 v58, v14
    v_add_f32 v31, v48, v49
    v_add_f32 v50, v50, v51
    v_add_f32 v31, v31, v50
    v_cvt_pk_bf16_f32 v41, v31, 0
    v_mfma_f32_32x32x16_bf16 v[80:95], a[4:7], v[240:243], v[80:95]
    v_lshlrev_b32 v4, 16, v41
    v_sub_f32 v5, v31, v4
    v_cvt_pk_bf16_f32 v40, v4, v5
    s_lshl_b32 s58, s36, 16
    s_add_u32 s58, s58, 1048576
    s_lshl_b32 s72, s72, 8
    v_mfma_f32_32x32x16_bf16 v[80:95], a[12:15], v[244:247], v[80:95]
    v_mul_f32 v64, v64, v58
    v_mul_f32 v65, v65, v58
    v_mul_f32 v66, v66, v58
    v_mul_f32 v67, v67, v58
    v_cvt_pk_bf16_f32 v64, v64, v65
    v_cvt_pk_bf16_f32 v65, v66, v67
    v_mfma_f32_32x32x16_bf16 v[80:95], a[20:23], v[248:251], v[80:95]
    v_mul_f32 v68, v68, v58
    v_mul_f32 v69, v69, v58
    v_mul_f32 v70, v70, v58
    v_mul_f32 v71, v71, v58
    v_cvt_pk_bf16_f32 v66, v68, v69
    v_cvt_pk_bf16_f32 v67, v70, v71
    v_mfma_f32_32x32x16_bf16 v[80:95], a[28:31], v[252:255], v[80:95]
    v_mul_f32 v72, v72, v58
    v_mul_f32 v73, v73, v58
    v_mul_f32 v74, v74, v58
    v_mul_f32 v75, v75, v58
    v_cvt_pk_bf16_f32 v68, v72, v73
    v_cvt_pk_bf16_f32 v69, v74, v75
    v_mfma_f32_32x32x16_bf16 v[80:95], v[40:43], v[32:35], v[80:95]
    v_mul_f32 v76, v76, v58
    v_mul_f32 v77, v77, v58
    v_mul_f32 v78, v78, v58
    v_mul_f32 v79, v79, v58
    v_cvt_pk_bf16_f32 v70, v76, v77
    v_cvt_pk_bf16_f32 v71, v78, v79
    s_cmp_lt_u32 s37, 7
    s_cbranch_scc1 L_rare_8
    s_cmp_ge_u32 s37, 14
    s_cbranch_scc1 L_rare_9
    ds_write_b64 v112, v[64:65]
    ds_write_b64 v113, v[66:67]
    ds_write_b64 v114, v[68:69]
    ds_write_b64 v115, v[70:71]
    ds_read_b64_tr_b16 v[96:97], v116 offset:0
    ds_read_b64_tr_b16 v[98:99], v117 offset:512
    ds_read_b64_tr_b16 v[100:101], v116 offset:1024
    ds_read_b64_tr_b16 v[102:103], v117 offset:1536
    v_pk_mul_f32 v[80:81], v[80:81], v[58:59] op_sel_hi:[1,0]
    v_pk_mul_f32 v[82:83], v[82:83], v[58:59] op_sel_hi:[1,0]
    v_cvt_pk_bf16_f32 v80, v80, v81
    v_cvt_pk_bf16_f32 v81, v82, v83
    v_pk_mul_f32 v[84:85], v[84:85], v[58:59] op_sel_hi:[1,0]
    v_pk_mul_f32 v[86:87], v[86:87], v[58:59] op_sel_hi:[1,0]
    v_cvt_pk_bf16_f32 v82, v84, v85
    v_cvt_pk_bf16_f32 v83, v86, v87
    v_pk_mul_f32 v[88:89], v[88:89], v[58:59] op_sel_hi:[1,0]
    v_pk_mul_f32 v[90:91], v[90:91], v[58:59] op_sel_hi:[1,0]
    v_cvt_pk_bf16_f32 v84, v88, v89
    v_cvt_pk_bf16_f32 v85, v90, v91
    v_pk_mul_f32 v[92:93], v[92:93], v[58:59] op_sel_hi:[1,0]
    v_pk_mul_f32 v[94:95], v[94:95], v[58:59] op_sel_hi:[1,0]
    v_cvt_pk_bf16_f32 v86, v92, v93
    v_cvt_pk_bf16_f32 v87, v94, v95
    ds_write_b64 v112, v[80:81] offset:2048
    ds_write_b64 v113, v[82:83] offset:2048
    ds_write_b64 v114, v[84:85] offset:2048
    ds_write_b64 v115, v[86:87] offset:2048
    ds_read_b64_tr_b16 v[104:105], v116 offset:2048
    ds_read_b64_tr_b16 v[106:107], v117 offset:2560
    ds_read_b64_tr_b16 v[108:109], v116 offset:3072
    ds_read_b64_tr_b16 v[110:111], v117 offset:3584
    s_lshl_b32 s59, s37, 8
    s_add_u32 s60, s59, s58
    s_lshl2_add_u32 s58, s59, s58
    s_add_u32 s58, s58, 25600
    s_add_u32 s59, s58, 14336
    s_waitcnt lgkmcnt(10)
    buffer_store_dwordx4 v[96:99], v62, s[40:43], s58 offen offset:0 sc1
    s_waitcnt lgkmcnt(8)
    buffer_store_dwordx4 v[100:103], v62, s[40:43], s59 offen offset:0 sc1
    s_add_u32 s60, s60, 26880
    v_lshlrev_b32 v4, 2, v0
    v_mov_b32_e64 v5, s54
    buffer_store_dword v5, v4, s[40:43], s60 offen sc1
    s_waitcnt lgkmcnt(2)
    buffer_store_dwordx4 v[104:107], v62, s[40:43], s58 offen offset:512 sc1
    s_waitcnt lgkmcnt(0)
    buffer_store_dwordx4 v[108:111], v62, s[40:43], s59 offen offset:512 sc1
L_rolej_7:
    s_waitcnt vmcnt(4)
    ds_read_b64_tr_b16 v[64:65], v55 offset:0
    ds_read_b64_tr_b16 v[66:67], v55 offset:256
    ds_read_b64_tr_b16 v[68:69], v55 offset:4096
    ds_read_b64_tr_b16 v[70:71], v55 offset:4352
    ds_read_b64_tr_b16 v[72:73], v55 offset:8192
    ds_read_b64_tr_b16 v[74:75], v55 offset:8448
    ds_read_b64_tr_b16 v[76:77], v55 offset:12288
    ds_read_b64_tr_b16 v[78:79], v55 offset:12544
    ds_read_b64_tr_b16 v[80:81], v55 offset:16384
    ds_read_b64_tr_b16 v[82:83], v55 offset:16640
    ds_read_b64_tr_b16 v[84:85], v55 offset:20480
    ds_read_b64_tr_b16 v[86:87], v55 offset:20736
    ds_read_b64_tr_b16 v[88:89], v55 offset:24576
    ds_read_b64_tr_b16 v[90:91], v55 offset:24832
    s_waitcnt lgkmcnt(12)
    v_dot2c_f32_bf16 v52, s54, v64
    v_dot2c_f32_bf16 v52, s54, v65
    v_dot2c_f32_bf16 v52, s54, v66
    v_dot2c_f32_bf16 v52, s54, v67
    s_waitcnt lgkmcnt(10)
    v_dot2c_f32_bf16 v52, s54, v68
    v_dot2c_f32_bf16 v52, s54, v69
    v_dot2c_f32_bf16 v52, s54, v70
    v_dot2c_f32_bf16 v52, s54, v71
    s_waitcnt lgkmcnt(8)
    v_dot2c_f32_bf16 v52, s54, v72
    v_dot2c_f32_bf16 v52, s54, v73
    v_dot2c_f32_bf16 v52, s54, v74
    v_dot2c_f32_bf16 v52, s54, v75
    s_waitcnt lgkmcnt(6)
    v_dot2c_f32_bf16 v52, s54, v76
    v_dot2c_f32_bf16 v52, s54, v77
    v_dot2c_f32_bf16 v52, s54, v78
    v_dot2c_f32_bf16 v52, s54, v79
    s_waitcnt lgkmcnt(4)
    v_dot2c_f32_bf16 v52, s54, v80
    v_dot2c_f32_bf16 v52, s54, v81
    v_dot2c_f32_bf16 v52, s54, v82
    v_dot2c_f32_bf16 v52, s54, v83
    s_waitcnt lgkmcnt(2)
    v_dot2c_f32_bf16 v52, s54, v84
    v_dot2c_f32_bf16 v52, s54, v85
    v_dot2c_f32_bf16 v52, s54, v86
    v_dot2c_f32_bf16 v52, s54, v87
    s_waitcnt lgkmcnt(0)
    v_dot2c_f32_bf16 v52, s54, v88
    v_dot2c_f32_bf16 v52, s54, v89
    v_dot2c_f32_bf16 v52, s54, v90
    v_dot2c_f32_bf16 v52, s54, v91
    v_mul_f32 v58, 0x3e8b97f6, v58
    v_cmp_gt_u32 vcc, 3, v61
    s_nop 0
    ds_write_b32 v60, v52 offset:2048
    v_add_u32 v13, 156672, v1
    s_cbranch_vccnz L_rare_10
L_back_11:
    s_branch L_page
L_rare_1:
    s_lshl_b32 s58, s36, 14
    v_lshlrev_b32 v4, 8, v0
    buffer_store_dword v34, v4, s[40:43], s58 offen sc1
    s_branch L_back_2
L_rare_3:
    s_cmp_eq_u32 s48, 0
    s_cselect_b32 s58, 1, 0
    s_mov_b64 exec, 1
    v_mov_b32_e64 v2, s58
    global_atomic_add v34, v2, s[26:27] sc1
    s_mov_b64 exec, -1
    s_branch L_back_4
L_rare_5:
    s_and_b32 s58, s72, 31
    s_lshl2_add_u32 s58, s58, s48
    s_lshl_b32 s58, s58, 10
    v_mov_b32 v200, -1
    v_mov_b32 v201, -1
    v_mov_b32 v202, -1
    v_mov_b32_e64 v203, -1
    s_add_u32 s58, s58, 7344128
    buffer_store_dwordx4 v[200:203], v1, s[40:43], s58 offen sc1
    s_add_u32 s58, s58, 262144
    buffer_store_dwordx4 v[200:203], v1, s[40:43], s58 offen sc1
    s_add_u32 s58, s58, 262144
    buffer_store_dwordx4 v[200:203], v1, s[40:43], s58 offen sc1
    s_add_u32 s58, s58, 262144
    buffer_store_dwordx4 v[200:203], v1, s[40:43], s58 offen sc1
    s_add_u32 s58, s58, 262144
    buffer_store_dwordx4 v[200:203], v1, s[40:43], s58 offen sc1
    s_add_u32 s58, s58, 262144
    buffer_store_dwordx4 v[200:203], v1, s[40:43], s58 offen sc1
    s_add_u32 s58, s58, 262144
    buffer_store_dwordx4 v[200:203], v1, s[40:43], s58 offen sc1
    s_branch L_back_6
L_rare_8:
    s_lshl_b32 s59, s37, 12
    s_add_u32 s58, s58, s59
    buffer_store_dwordx4 v[64:67], v1, s[40:43], s58 offen offset:0 sc1
    buffer_store_dwordx4 v[68:71], v1, s[40:43], s58 offen offset:1024 sc1
    v_pk_mul_f32 v[80:81], v[80:81], v[58:59] op_sel_hi:[1,0]
    v_pk_mul_f32 v[82:83], v[82:83], v[58:59] op_sel_hi:[1,0]
    v_cvt_pk_bf16_f32 v80, v80, v81
    v_cvt_pk_bf16_f32 v81, v82, v83
    v_pk_mul_f32 v[84:85], v[84:85], v[58:59] op_sel_hi:[1,0]
    v_pk_mul_f32 v[86:87], v[86:87], v[58:59] op_sel_hi:[1,0]
    v_cvt_pk_bf16_f32 v82, v84, v85
    v_cvt_pk_bf16_f32 v83, v86, v87
    buffer_store_dwordx4 v[80:83], v1, s[40:43], s58 offen offset:2048 sc1
    v_pk_mul_f32 v[88:89], v[88:89], v[58:59] op_sel_hi:[1,0]
    v_pk_mul_f32 v[90:91], v[90:91], v[58:59] op_sel_hi:[1,0]
    v_cvt_pk_bf16_f32 v84, v88, v89
    v_cvt_pk_bf16_f32 v85, v90, v91
    v_pk_mul_f32 v[92:93], v[92:93], v[58:59] op_sel_hi:[1,0]
    v_pk_mul_f32 v[94:95], v[94:95], v[58:59] op_sel_hi:[1,0]
    v_cvt_pk_bf16_f32 v86, v92, v93
    v_cvt_pk_bf16_f32 v87, v94, v95
    buffer_store_dwordx4 v[84:87], v1, s[40:43], s58 offen offset:3072 sc1
    s_branch L_rolej_7
L_rare_9:
    s_waitcnt vmcnt(0)
    s_mov_b32 s14, 0x62000
    s_mov_b32 s15, 0x20000
    s_and_b32 s58, s37, 1
    s_lshl_b32 s58, s58, 6
    s_add_u32 s58, s58, s36
    s_mul_i32 s58, s58, 3200
    v_lshlrev_b32 v2, 7, v0
    s_bfm_b64 exec, 25, 0
    buffer_load_dword v3, v2, s[12:15], s58 offen
    s_mov_b64 exec, -1
    s_branch L_rolej_7
L_rare_10:
    s_mov_b32 s66, 0
L_poll_12:
    global_load_dword v2, v34, s[26:27] sc1
    s_add_u32 s66, s66, 1
    s_cmp_gt_u32 s66, 0x100000
    s_cbranch_scc1 L_polld_13
    s_waitcnt vmcnt(0)
    v_cmp_gt_u32 vcc, 3, v2
    s_cbranch_vccnz L_poll_12
L_polld_13:
    s_waitcnt vmcnt(0)
    s_branch L_back_11
    .p2align 12
L_page:
L_ws0_2:
    s_cbranch_execz L_wr0
    s_waitcnt lgkmcnt(0)
    s_cmp_ge_u32 s37, 14
    s_cbranch_scc1 L_nodrain_14
    s_waitcnt vmcnt(0)
L_nodrain_14:
    s_barrier
    s_cmp_lg_u32 s48, 0
    s_cbranch_scc1 L_nw0_15
    s_mov_b64 exec, 1
    v_mov_b32 v2, 1
    buffer_store_dword v2, off, s[40:43], s72 sc1
    s_mov_b64 exec, -1
L_nw0_15:
    ds_read_b64_tr_b16 a[0:1], v27 offset:0
    ds_read_b64_tr_b16 a[2:3], v27 offset:256
    ds_read_b64_tr_b16 a[4:5], v27 offset:1024
    ds_read_b64_tr_b16 a[6:7], v27 offset:1280
    ds_read_b64_tr_b16 a[8:9], v27 offset:2048
    ds_read_b64_tr_b16 a[10:11], v27 offset:2304
    ds_read_b64_tr_b16 a[12:13], v27 offset:3072
    ds_read_b64_tr_b16 a[14:15], v27 offset:3328
    ds_read_b128 v[44:47], v13 offset:2048
    s_add_u32 m0, s57, 0
    s_nop 0
    buffer_load_dwordx4 v220, s[12:15], 0 offen offset:0 lds
    buffer_load_dwordx4 v221, s[12:15], 0 offen offset:1024 lds
    buffer_load_dwordx4 v222, s[12:15], 0 offen offset:2048 lds
    buffer_load_dwordx4 v223, s[12:15], 0 offen offset:3072 lds
    s_mul_i32 s62, s49, 28
    s_bitcmp1_b32 s48, 0
    s_cselect_b32 s60, 27, 0
    s_add_u32 s60, s60, s62
    s_lshr_b32 s60, s60, 6
    s_bitcmp1_b32 s48, 1
    s_cselect_b32 s58, 7, 0
    s_cselect_b32 s61, 15, 14
    s_add_u32 s60, s60, s58
    s_and_b32 s58, s48, 1
    s_cmp_lt_u32 s49, s58
    s_cselect_b32 s60, s61, s60
    s_waitcnt lgkmcnt(5)
    v_mfma_f32_32x32x16_bf16 v[96:111], a[0:3], v[120:123], 0
    s_add_u32 m0, s57, 4096
    ds_read_b64_tr_b16 a[16:17], v27 offset:4096
    ds_read_b64_tr_b16 a[18:19], v27 offset:4352
    v_mfma_f32_32x32x16_bf16 v[96:111], a[4:7], v[124:127], v[96:111]
    s_add_u32 s12, s12, 25088
    s_addc_u32 s13, s13, 0
    ds_read_b64_tr_b16 a[20:21], v27 offset:5120
    ds_read_b64_tr_b16 a[22:23], v27 offset:5376
    s_waitcnt lgkmcnt(5)
    v_mfma_f32_32x32x16_bf16 v[96:111], a[8:11], v[128:131], v[96:111]
    s_mov_b32 s14, 376320
    ds_read_b64_tr_b16 a[24:25], v27 offset:6144
    ds_read_b64_tr_b16 a[26:27], v27 offset:6400
    buffer_load_dwordx4 v220, s[12:15], 0 offen offset:0 lds
    s_waitcnt lgkmcnt(6)
    v_add_f32 v52, v44, v45
    v_add_f32 v46, v46, v47
    v_add_f32 v52, v52, v46
    v_mfma_f32_32x32x16_bf16 v[96:111], a[12:15], v[132:135], v[96:111]
    s_lshl_b32 s60, s60, 12
    ds_read_b64_tr_b16 a[28:29], v27 offset:7168
    ds_read_b64_tr_b16 a[30:31], v27 offset:7424
    buffer_load_dwordx4 v221, s[12:15], 0 offen offset:1024 lds
    v_cvt_pk_bf16_f32 v37, v52, 0
    v_lshlrev_b32 v14, 16, v37
    v_sub_f32_e64 v15, v52, v14
    v_cvt_pk_bf16_f32 v36, v14, v15
    s_waitcnt lgkmcnt(4)
    v_mfma_f32_32x32x16_bf16 v[96:111], a[16:19], v[136:139], v[96:111]
    ds_read_b64_tr_b16 a[0:1], v27 offset:8192
    ds_read_b64_tr_b16 a[2:3], v27 offset:8448
    buffer_load_dwordx4 v222, s[12:15], 0 offen offset:2048 lds
    v_lshrrev_b32 v4, 2, v0
    v_lshl_add_u32 v205, v4, 8, s60
    v_mfma_f32_32x32x16_bf16 v[96:111], a[20:23], v[140:143], v[96:111]
    s_lshl_b32 s60, s48, 16
    ds_read_b64_tr_b16 a[4:5], v27 offset:9216
    ds_read_b64_tr_b16 a[6:7], v27 offset:9472
    buffer_load_dwordx4 v223, s[12:15], 0 offen offset:3072 lds
    s_add_u32 s60, s60, 1048576
    s_lshr_b32 s59, s62, 3
    s_waitcnt lgkmcnt(4)
    v_mfma_f32_32x32x16_bf16 v[96:111], a[24:27], v[144:147], v[96:111]
    s_lshl_b32 s59, s59, 9
    ds_read_b64_tr_b16 a[8:9], v27 offset:10240
    ds_read_b64_tr_b16 a[10:11], v27 offset:10496
    s_add_u32 s59, s59, s60
    v_add_u32 v213, s59, v1
    v_mfma_f32_32x32x16_bf16 v[96:111], a[28:31], v[148:151], v[96:111]
    s_lshl4_add_u32 s59, s62, s60
    ds_read_b64_tr_b16 a[12:13], v27 offset:11264
    ds_read_b64_tr_b16 a[14:15], v27 offset:11520
    s_add_u32 s59, s59, 32768
    v_add_u32 v215, s59, v62
    s_waitcnt lgkmcnt(4)
    v_mfma_f32_32x32x16_bf16 v[96:111], a[0:3], v[152:155], v[96:111]
    ds_read_b64_tr_b16 a[16:17], v27 offset:12288
    ds_read_b64_tr_b16 a[18:19], v27 offset:12544
    v_add_u32 v216, 14336, v215
    v_and_b32 v4, 3, v0
    v_mfma_f32_32x32x16_bf16 v[96:111], a[4:7], v[156:159], v[96:111]
    s_andn2_b32 s62, s62, 63
    ds_read_b64_tr_b16 a[20:21], v27 offset:13312
    ds_read_b64_tr_b16 a[22:23], v27 offset:13568
    s_lshl2_add_u32 s60, s62, s60
    s_add_u32 s60, s60, 28672
    s_waitcnt lgkmcnt(4)
    v_mfma_f32_32x32x16_bf16 v[96:111], a[8:11], v[160:163], v[96:111]
    ds_read_b64_tr_b16 a[24:25], v27 offset:14336
    ds_read_b64_tr_b16 a[26:27], v27 offset:14592
    v_lshl_add_u32 v4, v4, 28, s60
    s_mov_b32 exec_lo, 0xf0000000
    s_mov_b32 exec_hi, exec_lo
    v_mov_b32_e64 v215, v4
    v_mov_b32 v216, v4
    s_mov_b64 exec, -1
    v_mfma_f32_32x32x16_bf16 v[96:111], a[12:15], v[164:167], v[96:111]
    s_and_b32 s70, s50, 8
    ds_read_b64_tr_b16 a[28:29], v27 offset:15360
    ds_read_b64_tr_b16 a[30:31], v27 offset:15616
    s_lshl_b32 s70, s70, 18
    s_mov_b32 s46, 0x1000000
    s_waitcnt lgkmcnt(4)
    v_mfma_f32_32x32x16_bf16 v[96:111], a[16:19], v[168:171], v[96:111]
    ds_read_b64_tr_b16 a[0:1], v27 offset:16384
    ds_read_b64_tr_b16 a[2:3], v27 offset:16640
    s_bitcmp1_b32 s3, 0
    s_cselect_b32 s61, 0, 4
    s_andn2_b32 s58, 2, s3
    v_mfma_f32_32x32x16_bf16 v[96:111], a[20:23], v[172:175], v[96:111]
    s_or_b32 s61, s61, s58
    ds_read_b64_tr_b16 a[4:5], v27 offset:17408
    ds_read_b64_tr_b16 a[6:7], v27 offset:17664
    v_xor_b32 v5, s61, v63
    v_mul_u32_u24 v4, 3584, v57
    s_waitcnt lgkmcnt(4)
    v_mfma_f32_32x32x16_bf16 v[96:111], a[24:27], v[176:179], v[96:111]
    s_mul_i32 s61, s48, 14336
    ds_read_b64_tr_b16 a[8:9], v27 offset:18432
    ds_read_b64_tr_b16 a[10:11], v27 offset:18688
    s_add_u32 s61, s61, s53
    s_lshl_b32 s61, s61, 7
    v_mfma_f32_32x32x16_bf16 v[96:111], a[28:31], v[180:183], v[96:111]
    ds_read_b64_tr_b16 a[12:13], v27 offset:19456
    ds_read_b64_tr_b16 a[14:15], v27 offset:19712
    s_cmp_eq_u32 s51, 7
    s_cselect_b32 s61, 2.0, s61
    s_cmp_eq_u32 s56, 7
    s_cselect_b32 s61, 2.0, s61
    s_waitcnt lgkmcnt(4)
    v_mfma_f32_32x32x16_bf16 v[96:111], a[0:3], v[184:187], v[96:111]
    ds_read_b64_tr_b16 a[16:17], v27 offset:20480
    ds_read_b64_tr_b16 a[18:19], v27 offset:20736
    v_lshl_add_u32 v4, v5, 4, v4
    v_add_u32_e64 v200, s61, v4
    v_mfma_f32_32x32x16_bf16 v[96:111], a[4:7], v[188:191], v[96:111]
    ds_read_b64_tr_b16 a[20:21], v27 offset:21504
    ds_read_b64_tr_b16 a[22:23], v27 offset:21760
    v_add_u32 v201, 27648, v200
    v_xor_b32 v201, 32, v201
    s_waitcnt lgkmcnt(4)
    v_mfma_f32_32x32x16_bf16 v[96:111], a[8:11], v[192:195], v[96:111]
    ds_read_b64_tr_b16 a[24:25], v27 offset:22528
    ds_read_b64_tr_b16 a[26:27], v27 offset:22784
    v_add_u32 v202, 55296, v200
    v_add_u32 v203, 82944, v200
    v_mfma_f32_32x32x16_bf16 v[96:111], a[12:15], v[196:199], v[96:111]
    ds_read_b64_tr_b16 a[28:29], v27 offset:23552
    ds_read_b64_tr_b16 a[30:31], v27 offset:23808
    v_xor_b32_e64 v203, 32, v203
    v_and_b32 v4, 31, v0
    s_waitcnt lgkmcnt(4)
    v_mfma_f32_32x32x16_bf16 v[96:111], a[16:19], v[224:227], v[96:111]
    ds_read_b64_tr_b16 a[0:1], v27 offset:24576
    ds_read_b64_tr_b16 a[2:3], v27 offset:24832
    v_lshlrev_b32_e64 v209, 1, v4
    v_mul_u32_u24 v4, 896, v4
    v_mfma_f32_32x32x16_bf16 v[96:111], a[20:23], v[228:231], v[96:111]
    ds_read_b64_tr_b16 a[4:5], v27 offset:25600
    ds_read_b64_tr_b16 a[6:7], v27 offset:25856
    v_lshrrev_b32_e64 v5, 5, v0
    v_add_u32 v219, -1, v5
    s_waitcnt lgkmcnt(4)
    v_mfma_f32_32x32x16_bf16 v[96:111], a[24:27], v[232:235], v[96:111]
    ds_read_b64_tr_b16 a[8:9], v27 offset:26624
    ds_read_b64_tr_b16 a[10:11], v27 offset:26880
    v_lshl_add_u32 v207, v5, 3, v4
    v_lshrrev_b32_e64 v5, 4, v0
    buffer_load_dword v210, v205, s[40:43], 0 offen sc1
    v_mfma_f32_32x32x16_bf16 v[96:111], a[28:31], v[236:239], v[96:111]
    ds_read_b64_tr_b16 a[12:13], v27 offset:27648
    ds_read_b64_tr_b16 a[14:15], v27 offset:27904
    v_lshlrev_b32_e64 v208, 3, v5
    v_lshlrev_b32 v214, 2, v0
    s_waitcnt lgkmcnt(4)
    v_mfma_f32_32x32x16_bf16 v[96:111], a[0:3], v[240:243], v[96:111]
    s_cmp_ge_u32 s49, 14
    s_cselect_b32 s59, 0, -1
    v_mov_b32_e64 v218, s59
    s_mul_i32 s58, s48, 12288
    v_add_u32 v9, s58, v1
    s_xor_b32 s58, s48, 1
    v_mfma_f32_32x32x16_bf16 v[96:111], a[4:7], v[244:247], v[96:111]
    s_mul_i32 s58, s58, 12288
    s_add_u32 s58, s58, 0
    v_add_u32 v6, s58, v1
    s_xor_b32 s58, s48, 2
    s_mul_i32 s58, s58, 12288
    s_add_u32 s58, s58, 4096
    s_waitcnt lgkmcnt(0)
    v_mfma_f32_32x32x16_bf16 v[96:111], a[8:11], v[248:251], v[96:111]
    v_add_u32 v7, s58, v1
    s_xor_b32 s58, s48, 3
    s_mul_i32 s58, s58, 12288
    s_add_u32 s58, s58, 8192
    v_add_u32_e64 v8, s58, v1
    v_mfma_f32_32x32x16_bf16 v[96:111], a[12:15], v[252:255], v[96:111]
    s_lshl_b32 s58, s48, 11
    v_add_u32 v54, s58, v1
    v_mfma_f32_32x32x16_bf16 v[96:111], v[36:39], v[32:35], v[96:111]
    v_mov_b32 v13, 156160
    ds_write_b32 v13, v34
    s_bitcmp1_b32 s49, 0
    s_cselect_b32 s59, -1, 0
    s_nop 7
    v_pk_mul_f32 v[96:97], v[96:97], v[58:59] op_sel_hi:[1,0]
    v_pk_mul_f32 v[98:99], v[98:99], v[58:59] op_sel_hi:[1,0]
    v_pk_mul_f32 v[100:101], v[100:101], v[58:59] op_sel_hi:[1,0]
    v_pk_mul_f32 v[102:103], v[102:103], v[58:59] op_sel_hi:[1,0]
    v_cvt_pk_bf16_f32 v64, v96, v97
    v_cvt_pk_bf16_f32 v65, v98, v99
    v_cvt_pk_bf16_f32 v66, v100, v101
    v_cvt_pk_bf16_f32 v67, v102, v103
    s_mov_b32 exec_lo, s59
    s_mov_b32 exec_hi, 0
    v_mov_b32 v64, 0
    v_mov_b32 v65, 0
    s_mov_b64 exec, -1
    ds_write_b128 v54, v[64:67] offset:49152
    v_pk_mul_f32 v[104:105], v[104:105], v[58:59] op_sel_hi:[1,0]
    v_pk_mul_f32 v[106:107], v[106:107], v[58:59] op_sel_hi:[1,0]
    v_pk_mul_f32 v[108:109], v[108:109], v[58:59] op_sel_hi:[1,0]
    v_pk_mul_f32 v[110:111], v[110:111], v[58:59] op_sel_hi:[1,0]
    v_cvt_pk_bf16_f32 v68, v104, v105
    v_cvt_pk_bf16_f32 v69, v106, v107
    v_cvt_pk_bf16_f32 v70, v108, v109
    v_cvt_pk_bf16_f32 v71, v110, v111
    s_mov_b32 exec_lo, 0
    s_not_b32 exec_hi, s59
    v_mov_b32_e64 v70, 0
    v_mov_b32 v71, 0
    s_mov_b64 exec, -1
    ds_write_b128 v54, v[68:71] offset:50176
    v_xor_b32 v13, 2048, v54
    v_xor_b32 v14, 4096, v54
    v_xor_b32 v15, 6144, v54
    s_xor_b32 s65, s70, 0
    s_add_u32 s44, s40, s65
    s_addc_u32 s45, s41, 0
    s_waitcnt vmcnt(0)
    v_cmp_gt_u32 vcc, 1, v210
    s_cbranch_vccnz L_rare_16
L_back_17:
    s_waitcnt lgkmcnt(0)
    s_barrier
    buffer_load_dwordx4 v[240:243], v213, s[44:47], 0 offen offset:0 sc1
    buffer_load_dwordx4 v[244:247], v213, s[44:47], 0 offen offset:1024 sc1
    ds_read_b128 v[16:19], v15 offset:49152
    ds_read_b128 v[20:23], v15 offset:50176
    ds_read_b128 v[24:27], v14 offset:49152
    ds_read_b128 v[28:31], v14 offset:50176
    ds_read_b128 v[32:35], v13 offset:49152
    ds_read_b128 v[36:39], v13 offset:50176
    ds_read_b128 v[40:43], v54 offset:49152
    ds_read_b128 v[44:47], v54 offset:50176
    buffer_load_dwordx4 v[248:251], v215, s[44:47], 0 offen sc1
    buffer_load_dwordx4 v[252:255], v216, s[44:47], 0 offen sc1
    s_mul_i32 s61, s48, 1835008
    v_lshrrev_b32_e64 v13, 2, v0
    v_and_b32 v14, 3, v0
    s_lshr_b32 s59, s2, 3
    s_mul_i32 s59, s59, 24576
    s_add_u32 s59, s59, s61
    s_lshr_b32 s60, s2, 6
    s_sub_u32 s60, s52, s60
    s_lshl_b32 s60, s60, 7
    s_add_u32 s59, s59, s60
    v_add_u32 v4, 40, v0
    v_and_b32_e64 v4, 64, v4
    v_lshl_add_u32 v4, v4, 16, v14
    v_mul_u32_u24 v5, 32, v13
    v_add_lshl_u32 v4, v4, v5, 7
    v_add_u32 v204, s59, v4
    s_and_b32 s60, s2, 1
    v_add_u32 v5, s60, v14
    v_and_b32_e64 v5, 4, v5
    v_lshl_add_u32 v14, v5, 19, v14
    s_lshr_b32 s59, s2, 3
    s_mul_i32 s59, s59, 21504
    s_add_u32 s59, s59, s61
    s_lshr_b32 s60, s2, 6
    s_sub_u32 s60, s53, s60
    s_lshl_b32 s60, s60, 7
    s_add_u32 s59, s59, s60
    v_add_u32 v4, 40, v0
    v_and_b32 v4, 64, v4
    v_lshl_add_u32 v4, v4, 16, v14
    v_mul_u32_u24 v5, 28, v13
    v_add_lshl_u32 v4, v4, v5, 7
    v_add_u32 v212, s59, v4
    v_add_u32 v10, s57, v10
    v_lshrrev_b32 v4, 5, v0
    v_lshl_add_u32 v4, v4, 9, v10
    v_bfe_u32 v5, v0, 4, 1
    v_lshl_add_u32 v206, v5, 5, v4
    v_lshrrev_b32_e64 v4, 4, v0
    v_lshl_add_u32 v10, v4, 10, v10
    v_lshl_add_u32 v10, v5, 5, v10
    v_xor_b32 v15, 32, v10
    s_bitcmp1_b32 s3, 0
    s_cselect_b32 s61, 0, 4
    s_andn2_b32 s58, 2, s3
    s_or_b32 s61, s61, s58
    v_xor_b32 v5, s61, v63
    v_mul_u32_u24 v4, 4096, v57
    s_mul_i32 s61, s48, 14336
    s_add_u32 s61, s61, s52
    s_lshl_b32 s61, s61, 7
    s_cmp_eq_u32 s51, 7
    s_cselect_b32 s61, 2.0, s61
    v_lshl_add_u32 v4, v5, 4, v4
    v_add_u32_e64 v12, s61, v4
    s_xor_b32 s65, s70, 262144
    s_add_u32 s44, s40, s65
    s_addc_u32 s45, s41, 0
    buffer_load_dwordx4 v[152:155], v213, s[44:47], 0 offen offset:0 sc1
    buffer_load_dwordx4 v[156:159], v213, s[44:47], 0 offen offset:1024 sc1
    buffer_load_dwordx4 v[160:163], v215, s[44:47], 0 offen sc1
    buffer_load_dwordx4 v[164:167], v216, s[44:47], 0 offen sc1
    ds_read_b64_tr_b16 a[192:193], v206 offset:0
    ds_read_b64_tr_b16 a[194:195], v206 offset:1024
    ds_read_b64_tr_b16 a[196:197], v206 offset:256
    ds_read_b64_tr_b16 a[198:199], v206 offset:1280
    ds_read_b64_tr_b16 a[200:201], v206 offset:2048
    ds_read_b64_tr_b16 a[202:203], v206 offset:3072
    ds_read_b64_tr_b16 a[204:205], v206 offset:2304
    ds_read_b64_tr_b16 a[206:207], v206 offset:3328
    ds_read_b64_tr_b16 a[208:209], v206 offset:4096
    ds_read_b64_tr_b16 a[210:211], v206 offset:5120
    ds_read_b64_tr_b16 a[212:213], v206 offset:4352
    ds_read_b64_tr_b16 a[214:215], v206 offset:5376
    ds_read_b64_tr_b16 a[216:217], v206 offset:6144
    ds_read_b64_tr_b16 a[218:219], v206 offset:7168
    ds_read_b64_tr_b16 a[220:221], v206 offset:6400
    ds_read_b64_tr_b16 a[222:223], v206 offset:7424
    s_waitcnt vmcnt(6) lgkmcnt(15)
    v_mfma_f32_32x32x16_bf16 v[112:127], v[240:243], v[16:19], 0
    v_mfma_f32_32x32x16_bf16 v[112:127], v[244:247], v[20:23], v[112:127]
    v_mfma_f32_32x32x16_bf16 v[128:143], v[240:243], v[24:27], 0
    s_xor_b32 s65, s70, 524288
    s_nop 9
    v_exp_f32 v112, v112
    v_exp_f32 v113, v113
    v_exp_f32 v114, v114
    v_exp_f32 v115, v115
    v_cvt_pk_bf16_f32 v144, v112, v113
    v_cvt_pk_bf16_f32 v145, v114, v115
    v_exp_f32 v116, v116
    v_exp_f32 v117, v117
    v_exp_f32 v118, v118
    v_exp_f32 v119, v119
    v_cvt_pk_bf16_f32 v146, v116, v117
    v_cvt_pk_bf16_f32 v147, v118, v119
    v_mfma_f32_32x32x16_bf16 v[128:143], v[244:247], v[28:31], v[128:143]
    s_add_u32 s44, s40, s65
    v_exp_f32 v120, v120
    v_exp_f32 v121, v121
    v_exp_f32 v122, v122
    v_exp_f32_e64 v123, v123
    v_cvt_pk_bf16_f32 v148, v120, v121
    v_cvt_pk_bf16_f32 v149, v122, v123
    s_waitcnt vmcnt(4)
    v_mfma_f32_32x32x16_bf16 v[48:63], v[248:251], v[144:147], 0
    s_addc_u32 s45, s41, 0
    buffer_load_dwordx4 v[168:171], v213, s[44:47], 0 offen offset:0 sc1
    buffer_load_dwordx4 v[172:175], v213, s[44:47], 0 offen offset:1024 sc1
    buffer_load_dwordx4 v[176:179], v215, s[44:47], 0 offen sc1
    v_exp_f32 v124, v124
    v_exp_f32 v125, v125
    v_exp_f32 v126, v126
    v_exp_f32 v127, v127
    v_cvt_pk_bf16_f32 v150, v124, v125
    v_cvt_pk_bf16_f32 v151, v126, v127
    v_mfma_f32_32x32x16_bf16 v[112:127], v[240:243], v[32:35], 0
    buffer_load_dwordx4 v[180:183], v216, s[44:47], 0 offen sc1
    v_exp_f32 v128, v128
    v_exp_f32 v129, v129
    v_exp_f32 v130, v130
    v_exp_f32 v131, v131
    v_cvt_pk_bf16_f32 v144, v128, v129
    v_cvt_pk_bf16_f32 v145, v130, v131
    v_mfma_f32_32x32x16_bf16 v[48:63], v[252:255], v[148:151], v[48:63]
    s_xor_b32 s65, s70, 786432
    v_exp_f32 v132, v132
    v_exp_f32 v133, v133
    v_exp_f32 v134, v134
    v_exp_f32 v135, v135
    v_cvt_pk_bf16_f32 v146, v132, v133
    v_cvt_pk_bf16_f32 v147, v134, v135
    v_mfma_f32_32x32x16_bf16 v[112:127], v[244:247], v[36:39], v[112:127]
    s_add_u32 s44, s40, s65
    v_exp_f32 v136, v136
    v_exp_f32 v137, v137
    v_exp_f32 v138, v138
    v_exp_f32_e64 v139, v139
    v_cvt_pk_bf16_f32 v148, v136, v137
    v_cvt_pk_bf16_f32 v149, v138, v139
    v_mfma_f32_32x32x16_bf16 v[64:79], v[248:251], v[144:147], 0
    s_addc_u32 s45, s41, 0
    buffer_load_dwordx4 v[184:187], v213, s[44:47], 0 offen offset:0 sc1
    buffer_load_dwordx4 v[188:191], v213, s[44:47], 0 offen offset:1024 sc1
    v_exp_f32 v140, v140
    v_exp_f32 v141, v141
    v_exp_f32 v142, v142
    v_exp_f32_e64 v143, v143
    v_cvt_pk_bf16_f32 v150, v140, v141
    v_cvt_pk_bf16_f32 v151, v142, v143
    v_mfma_f32_32x32x16_bf16 v[128:143], v[240:243], v[40:43], 0
    buffer_load_dwordx4 v[192:195], v215, s[44:47], 0 offen sc1
    buffer_load_dwordx4 v[196:199], v216, s[44:47], 0 offen sc1
    v_exp_f32 v112, v112
    v_exp_f32 v113, v113
    v_exp_f32 v114, v114
    v_exp_f32 v115, v115
    v_cvt_pk_bf16_f32 v144, v112, v113
    v_cvt_pk_bf16_f32 v145, v114, v115
    v_mfma_f32_32x32x16_bf16 v[64:79], v[252:255], v[148:151], v[64:79]
    s_mov_b32 s67, 0
    v_exp_f32 v116, v116
    v_exp_f32 v117, v117
    v_exp_f32 v118, v118
    v_exp_f32_e64 v119, v119
    v_cvt_pk_bf16_f32 v146, v116, v117
    v_cvt_pk_bf16_f32 v147, v118, v119
    v_mfma_f32_32x32x16_bf16 v[128:143], v[244:247], v[44:47], v[128:143]
    buffer_load_dword v211, v212, s[16:19], s67 offen
    v_exp_f32 v120, v120
    v_exp_f32 v121, v121
    v_exp_f32 v122, v122
    v_exp_f32 v123, v123
    v_cvt_pk_bf16_f32 v148, v120, v121
    v_cvt_pk_bf16_f32 v149, v122, v123
    v_mfma_f32_32x32x16_bf16 v[80:95], v[248:251], v[144:147], 0
    s_waitcnt vmcnt(9) lgkmcnt(0)
    v_exp_f32 v124, v124
    v_exp_f32 v125, v125
    v_exp_f32 v126, v126
    v_exp_f32_e64 v127, v127
    v_cvt_pk_bf16_f32 v150, v124, v125
    v_cvt_pk_bf16_f32 v151, v126, v127
    v_mfma_f32_32x32x16_bf16 v[112:127], v[152:155], v[16:19], 0
    s_xor_b32 s65, s70, 1048576
    v_exp_f32 v128, v128
    v_exp_f32 v129, v129
    v_exp_f32 v130, v130
    v_exp_f32 v131, v131
    v_cvt_pk_bf16_f32 v144, v128, v129
    v_cvt_pk_bf16_f32 v145, v130, v131
    v_mfma_f32_32x32x16_bf16 v[80:95], v[252:255], v[148:151], v[80:95]
    s_add_u32 s44, s40, s65
    v_exp_f32 v132, v132
    v_exp_f32 v133, v133
    v_exp_f32 v134, v134
    v_exp_f32_e64 v135, v135
    v_cvt_pk_bf16_f32 v146, v132, v133
    v_cvt_pk_bf16_f32 v147, v134, v135
    v_mfma_f32_32x32x16_bf16 v[112:127], v[156:159], v[20:23], v[112:127]
    s_addc_u32 s45, s41, 0
    v_exp_f32 v136, v136
    v_exp_f32 v137, v137
    v_exp_f32 v138, v138
    v_exp_f32_e64 v139, v139
    v_cvt_pk_bf16_f32 v148, v136, v137
    v_cvt_pk_bf16_f32 v149, v138, v139
    v_mfma_f32_32x32x16_bf16 v[96:111], v[248:251], v[144:147], 0
    v_exp_f32 v140, v140
    v_exp_f32 v141, v141
    v_exp_f32 v142, v142
    v_exp_f32 v143, v143
    v_cvt_pk_bf16_f32 v150, v140, v141
    v_cvt_pk_bf16_f32 v151, v142, v143
    v_mfma_f32_32x32x16_bf16 v[128:143], v[152:155], v[24:27], 0
    v_exp_f32 v112, v112
    v_exp_f32 v113, v113
    v_exp_f32 v114, v114
    v_exp_f32 v115, v115
    v_cvt_pk_bf16_f32 v144, v112, v113
    v_cvt_pk_bf16_f32 v145, v114, v115
    v_mfma_f32_32x32x16_bf16 v[96:111], v[252:255], v[148:151], v[96:111]
    buffer_load_dwordx4 v[240:243], v213, s[44:47], 0 offen offset:0 sc1
    v_exp_f32 v116, v116
    v_exp_f32 v117, v117
    v_exp_f32 v118, v118
    v_exp_f32 v119, v119
    v_cvt_pk_bf16_f32 v146, v116, v117
    v_cvt_pk_bf16_f32 v147, v118, v119
    v_mfma_f32_32x32x16_bf16 v[128:143], v[156:159], v[28:31], v[128:143]
    buffer_load_dwordx4 v[244:247], v213, s[44:47], 0 offen offset:1024 sc1
    v_exp_f32 v120, v120
    v_exp_f32 v121, v121
    v_exp_f32 v122, v122
    v_exp_f32 v123, v123
    v_cvt_pk_bf16_f32 v148, v120, v121
    v_cvt_pk_bf16_f32 v149, v122, v123
    v_mfma_f32_32x32x16_bf16 v[48:63], v[160:163], v[144:147], v[48:63]
    buffer_load_dwordx4 v[248:251], v215, s[44:47], 0 offen sc1
    v_exp_f32 v124, v124
    v_exp_f32 v125, v125
    v_exp_f32 v126, v126
    v_exp_f32 v127, v127
    v_cvt_pk_bf16_f32 v150, v124, v125
    v_cvt_pk_bf16_f32 v151, v126, v127
    v_mfma_f32_32x32x16_bf16 v[112:127], v[152:155], v[32:35], 0
    buffer_load_dwordx4 v[252:255], v216, s[44:47], 0 offen sc1
    v_exp_f32 v128, v128
    v_exp_f32 v129, v129
    v_exp_f32 v130, v130
    v_exp_f32 v131, v131
    v_cvt_pk_bf16_f32 v144, v128, v129
    v_cvt_pk_bf16_f32 v145, v130, v131
    v_mfma_f32_32x32x16_bf16 v[48:63], v[164:167], v[148:151], v[48:63]
    v_exp_f32 v132, v132
    v_exp_f32 v133, v133
    v_exp_f32 v134, v134
    v_exp_f32 v135, v135
    v_cvt_pk_bf16_f32 v146, v132, v133
    v_cvt_pk_bf16_f32 v147, v134, v135
    v_mfma_f32_32x32x16_bf16 v[112:127], v[156:159], v[36:39], v[112:127]
    v_exp_f32 v136, v136
    v_exp_f32 v137, v137
    v_exp_f32 v138, v138
    v_exp_f32 v139, v139
    v_cvt_pk_bf16_f32 v148, v136, v137
    v_cvt_pk_bf16_f32 v149, v138, v139
    v_mfma_f32_32x32x16_bf16 v[64:79], v[160:163], v[144:147], v[64:79]
    v_exp_f32 v140, v140
    v_exp_f32 v141, v141
    v_exp_f32 v142, v142
    v_exp_f32 v143, v143
    v_cvt_pk_bf16_f32 v150, v140, v141
    v_cvt_pk_bf16_f32 v151, v142, v143
    v_mfma_f32_32x32x16_bf16 v[128:143], v[152:155], v[40:43], 0
    v_exp_f32 v112, v112
    v_exp_f32 v113, v113
    v_exp_f32 v114, v114
    v_exp_f32 v115, v115
    v_cvt_pk_bf16_f32 v144, v112, v113
    v_cvt_pk_bf16_f32 v145, v114, v115
    v_mfma_f32_32x32x16_bf16 v[64:79], v[164:167], v[148:151], v[64:79]
    v_exp_f32 v116, v116
    v_exp_f32 v117, v117
    v_exp_f32 v118, v118
    v_exp_f32 v119, v119
    v_cvt_pk_bf16_f32 v146, v116, v117
    v_cvt_pk_bf16_f32 v147, v118, v119
    v_mfma_f32_32x32x16_bf16 v[128:143], v[156:159], v[44:47], v[128:143]
    v_exp_f32 v120, v120
    v_exp_f32 v121, v121
    v_exp_f32 v122, v122
    v_exp_f32 v123, v123
    v_cvt_pk_bf16_f32 v148, v120, v121
    v_cvt_pk_bf16_f32 v149, v122, v123
    v_mfma_f32_32x32x16_bf16 v[80:95], v[160:163], v[144:147], v[80:95]
    s_waitcnt vmcnt(9)
    v_exp_f32 v124, v124
    v_exp_f32 v125, v125
    v_exp_f32 v126, v126
    v_exp_f32_e64 v127, v127
    v_cvt_pk_bf16_f32 v150, v124, v125
    v_cvt_pk_bf16_f32 v151, v126, v127
    v_mfma_f32_32x32x16_bf16 v[112:127], v[168:171], v[16:19], 0
    s_and_b32 s58, s3, 1
    s_lshl1_add_u32 s59, s53, s58
    v_exp_f32 v128, v128
    v_exp_f32 v129, v129
    v_exp_f32 v130, v130
    v_exp_f32 v131, v131
    v_cvt_pk_bf16_f32 v144, v128, v129
    v_cvt_pk_bf16_f32 v145, v130, v131
    v_mfma_f32_32x32x16_bf16 v[80:95], v[164:167], v[148:151], v[80:95]
    s_lshr_b32 s61, s3, 1
    s_lshl1_add_u32 s59, s59, s61
    v_exp_f32 v132, v132
    v_exp_f32 v133, v133
    v_exp_f32 v134, v134
    v_exp_f32 v135, v135
    v_cvt_pk_bf16_f32 v146, v132, v133
    v_cvt_pk_bf16_f32 v147, v134, v135
    v_mfma_f32_32x32x16_bf16 v[112:127], v[172:175], v[20:23], v[112:127]
    s_lshl_b32 s61, s59, 5
    v_exp_f32 v136, v136
    v_exp_f32 v137, v137
    v_exp_f32 v138, v138
    v_exp_f32_e64 v139, v139
    v_cvt_pk_bf16_f32 v148, v136, v137
    v_cvt_pk_bf16_f32 v149, v138, v139
    v_mfma_f32_32x32x16_bf16 v[96:111], v[160:163], v[144:147], v[96:111]
    s_lshl1_add_u32 s58, s52, s58
    v_exp_f32 v140, v140
    v_exp_f32 v141, v141
    v_exp_f32 v142, v142
    v_exp_f32_e64 v143, v143
    v_cvt_pk_bf16_f32 v150, v140, v141
    v_cvt_pk_bf16_f32 v151, v142, v143
    v_mfma_f32_32x32x16_bf16 v[128:143], v[168:171], v[24:27], 0
    s_lshl_b32 s62, s58, 6
    v_exp_f32 v112, v112
    v_exp_f32 v113, v113
    v_exp_f32 v114, v114
    v_exp_f32_e64 v115, v115
    v_cvt_pk_bf16_f32 v144, v112, v113
    v_cvt_pk_bf16_f32 v145, v114, v115
    v_mfma_f32_32x32x16_bf16 v[96:111], v[164:167], v[148:151], v[96:111]
    s_mul_i32 s58, s58, 28672
    v_exp_f32 v116, v116
    v_exp_f32 v117, v117
    v_exp_f32 v118, v118
    v_exp_f32 v119, v119
    v_cvt_pk_bf16_f32 v146, v116, v117
    v_cvt_pk_bf16_f32 v147, v118, v119
    v_mfma_f32_32x32x16_bf16 v[128:143], v[172:175], v[28:31], v[128:143]
    s_lshr_b32 s59, s3, 1
    v_exp_f32 v120, v120
    v_exp_f32 v121, v121
    v_exp_f32 v122, v122
    v_exp_f32_e64 v123, v123
    v_cvt_pk_bf16_f32 v148, v120, v121
    v_cvt_pk_bf16_f32 v149, v122, v123
    v_mfma_f32_32x32x16_bf16 v[48:63], v[176:179], v[144:147], v[48:63]
    s_lshl1_add_u32 s59, s51, s59
    v_exp_f32 v124, v124
    v_exp_f32 v125, v125
    v_exp_f32 v126, v126
    v_exp_f32_e64 v127, v127
    v_cvt_pk_bf16_f32 v150, v124, v125
    v_cvt_pk_bf16_f32 v151, v126, v127
    v_mfma_f32_32x32x16_bf16 v[112:127], v[168:171], v[32:35], 0
    s_lshl_b32 s59, s59, 6
    v_exp_f32 v128, v128
    v_exp_f32 v129, v129
    v_exp_f32 v130, v130
    v_exp_f32_e64 v131, v131
    v_cvt_pk_bf16_f32 v144, v128, v129
    v_cvt_pk_bf16_f32 v145, v130, v131
    v_mfma_f32_32x32x16_bf16 v[48:63], v[180:183], v[148:151], v[48:63]
    s_add_u32 s73, s58, s59
    v_exp_f32 v132, v132
    v_exp_f32 v133, v133
    v_exp_f32 v134, v134
    v_exp_f32_e64 v135, v135
    v_cvt_pk_bf16_f32 v146, v132, v133
    v_cvt_pk_bf16_f32 v147, v134, v135
    v_mfma_f32_32x32x16_bf16 v[112:127], v[172:175], v[36:39], v[112:127]
    s_xor_b32 s65, s70, 1310720
    v_exp_f32 v136, v136
    v_exp_f32 v137, v137
    v_exp_f32 v138, v138
    v_exp_f32 v139, v139
    v_cvt_pk_bf16_f32 v148, v136, v137
    v_cvt_pk_bf16_f32 v149, v138, v139
    v_mfma_f32_32x32x16_bf16 v[64:79], v[176:179], v[144:147], v[64:79]
L_ws0_3:
    s_cbranch_execz L_wr0
    s_add_u32 s44, s40, s65
    v_exp_f32 v140, v140
    v_exp_f32 v141, v141
    v_exp_f32 v142, v142
    v_exp_f32 v143, v143
    v_cvt_pk_bf16_f32 v150, v140, v141
    v_cvt_pk_bf16_f32 v151, v142, v143
    v_mfma_f32_32x32x16_bf16 v[128:143], v[168:171], v[40:43], 0
    s_addc_u32 s45, s41, 0
    buffer_load_dwordx4 v[152:155], v213, s[44:47], 0 offen offset:0 sc1
    buffer_load_dwordx4 v[156:159], v213, s[44:47], 0 offen offset:1024 sc1
    buffer_load_dwordx4 v[160:163], v215, s[44:47], 0 offen sc1
    v_exp_f32 v112, v112
    v_exp_f32 v113, v113
    v_exp_f32 v114, v114
    v_exp_f32_e64 v115, v115
    v_cvt_pk_bf16_f32 v144, v112, v113
    v_cvt_pk_bf16_f32 v145, v114, v115
    v_mfma_f32_32x32x16_bf16 v[64:79], v[180:183], v[148:151], v[64:79]
    buffer_load_dwordx4 v[164:167], v216, s[44:47], 0 offen sc1
    v_exp_f32 v116, v116
    v_exp_f32 v117, v117
    v_exp_f32 v118, v118
    v_exp_f32 v119, v119
    v_cvt_pk_bf16_f32 v146, v116, v117
    v_cvt_pk_bf16_f32 v147, v118, v119
    v_mfma_f32_32x32x16_bf16 v[128:143], v[172:175], v[44:47], v[128:143]
    s_mov_b32 s67, 688128
    buffer_load_dword v211, v212, s[16:19], s67 offen
    v_exp_f32 v120, v120
    v_exp_f32 v121, v121
    v_exp_f32 v122, v122
    v_exp_f32 v123, v123
    v_cvt_pk_bf16_f32 v148, v120, v121
    v_cvt_pk_bf16_f32 v149, v122, v123
    v_mfma_f32_32x32x16_bf16 v[80:95], v[176:179], v[144:147], v[80:95]
    s_waitcnt vmcnt(10)
    v_exp_f32 v124, v124
    v_exp_f32 v125, v125
    v_exp_f32 v126, v126
    v_exp_f32_e64 v127, v127
    v_cvt_pk_bf16_f32 v150, v124, v125
    v_cvt_pk_bf16_f32 v151, v126, v127
    v_mfma_f32_32x32x16_bf16 v[112:127], v[184:187], v[16:19], 0
    s_mov_b32 s26, 0x1c0000
    v_exp_f32 v128, v128
    v_exp_f32 v129, v129
    v_exp_f32 v130, v130
    v_exp_f32 v131, v131
    v_cvt_pk_bf16_f32 v144, v128, v129
    v_cvt_pk_bf16_f32 v145, v130, v131
    v_mfma_f32_32x32x16_bf16 v[80:95], v[180:183], v[148:151], v[80:95]
    s_mov_b32 s27, 0x20000
    v_exp_f32 v132, v132
    v_exp_f32 v133, v133
    v_exp_f32 v134, v134
    v_exp_f32 v135, v135
    v_cvt_pk_bf16_f32 v146, v132, v133
    v_cvt_pk_bf16_f32 v147, v134, v135
    v_mfma_f32_32x32x16_bf16 v[112:127], v[188:191], v[20:23], v[112:127]
    s_mov_b32 s55, 0
    v_exp_f32 v136, v136
    v_exp_f32 v137, v137
    v_exp_f32 v138, v138
    v_exp_f32_e64 v139, v139
    v_cvt_pk_bf16_f32 v148, v136, v137
    v_cvt_pk_bf16_f32 v149, v138, v139
    v_mfma_f32_32x32x16_bf16 v[96:111], v[176:179], v[144:147], v[96:111]
    s_lshl4_add_u32 s59, s36, s49
    v_exp_f32 v140, v140
    v_exp_f32 v141, v141
    v_exp_f32 v142, v142
    v_exp_f32_e64 v143, v143
    v_cvt_pk_bf16_f32 v150, v140, v141
    v_cvt_pk_bf16_f32 v151, v142, v143
    v_mfma_f32_32x32x16_bf16 v[128:143], v[184:187], v[24:27], 0
    s_lshl_b32 s60, s59, 8
    v_exp_f32 v112, v112
    v_exp_f32 v113, v113
    v_exp_f32 v114, v114
    v_exp_f32_e64 v115, v115
    v_cvt_pk_bf16_f32 v144, v112, v113
    v_cvt_pk_bf16_f32 v145, v114, v115
    v_mfma_f32_32x32x16_bf16 v[96:111], v[180:183], v[148:151], v[96:111]
    s_add_u32 s60, s60, 786432
    v_exp_f32 v116, v116
    v_exp_f32 v117, v117
    v_exp_f32 v118, v118
    v_exp_f32 v119, v119
    v_cvt_pk_bf16_f32 v146, v116, v117
    v_cvt_pk_bf16_f32 v147, v118, v119
    v_mfma_f32_32x32x16_bf16 v[128:143], v[188:191], v[28:31], v[128:143]
    s_lshl_b32 s59, s59, 11
    v_exp_f32 v120, v120
    v_exp_f32 v121, v121
    v_exp_f32 v122, v122
    v_exp_f32_e64 v123, v123
    v_cvt_pk_bf16_f32 v148, v120, v121
    v_cvt_pk_bf16_f32 v149, v122, v123
    v_mfma_f32_32x32x16_bf16 v[48:63], v[192:195], v[144:147], v[48:63]
    s_add_u32 s59, s59, 5242880
    v_exp_f32 v124, v124
    v_exp_f32 v125, v125
    v_exp_f32 v126, v126
    v_exp_f32 v127, v127
    v_cvt_pk_bf16_f32 v150, v124, v125
    v_cvt_pk_bf16_f32 v151, v126, v127
    v_mfma_f32_32x32x16_bf16 v[112:127], v[184:187], v[32:35], 0
    s_lshl4_add_u32 s58, s50, s49
    v_exp_f32 v128, v128
    v_exp_f32 v129, v129
    v_exp_f32 v130, v130
    v_exp_f32_e64 v131, v131
    v_cvt_pk_bf16_f32 v144, v128, v129
    v_cvt_pk_bf16_f32 v145, v130, v131
    v_mfma_f32_32x32x16_bf16 v[48:63], v[196:199], v[148:151], v[48:63]
    s_lshl_b32 s58, s58, 8
    v_exp_f32 v132, v132
    v_exp_f32 v133, v133
    v_exp_f32 v134, v134
    v_exp_f32_e64 v135, v135
    v_cvt_pk_bf16_f32 v146, v132, v133
    v_cvt_pk_bf16_f32 v147, v134, v135
    v_mfma_f32_32x32x16_bf16 v[112:127], v[188:191], v[36:39], v[112:127]
    s_add_u32 s58, s58, 65536
    v_exp_f32 v136, v136
    v_exp_f32 v137, v137
    v_exp_f32 v138, v138
    v_exp_f32 v139, v139
    v_cvt_pk_bf16_f32 v148, v136, v137
    v_cvt_pk_bf16_f32 v149, v138, v139
    v_mfma_f32_32x32x16_bf16 v[64:79], v[192:195], v[144:147], v[64:79]
    s_xor_b32 s65, s70, 1572864
    v_exp_f32 v140, v140
    v_exp_f32 v141, v141
    v_exp_f32 v142, v142
    v_exp_f32 v143, v143
    v_cvt_pk_bf16_f32 v150, v140, v141
    v_cvt_pk_bf16_f32 v151, v142, v143
    v_mfma_f32_32x32x16_bf16 v[128:143], v[184:187], v[40:43], 0
    s_add_u32 s44, s40, s65
    v_exp_f32 v112, v112
    v_exp_f32 v113, v113
    v_exp_f32 v114, v114
    v_exp_f32_e64 v115, v115
    v_cvt_pk_bf16_f32 v144, v112, v113
    v_cvt_pk_bf16_f32 v145, v114, v115
    v_mfma_f32_32x32x16_bf16 v[64:79], v[196:199], v[148:151], v[64:79]
    s_addc_u32 s45, s41, 0
    v_exp_f32 v116, v116
    v_exp_f32 v117, v117
    v_exp_f32 v118, v118
    v_exp_f32_e64 v119, v119
    v_cvt_pk_bf16_f32 v146, v116, v117
    v_cvt_pk_bf16_f32 v147, v118, v119
    v_mfma_f32_32x32x16_bf16 v[128:143], v[188:191], v[44:47], v[128:143]
    buffer_load_dwordx4 v[168:171], v213, s[44:47], 0 offen offset:0 sc1
    buffer_load_dwordx4 v[172:175], v213, s[44:47], 0 offen offset:1024 sc1
    buffer_load_dwordx4 v[176:179], v215, s[44:47], 0 offen sc1
    buffer_load_dwordx4 v[180:183], v216, s[44:47], 0 offen sc1
    v_exp_f32 v120, v120
    v_exp_f32 v121, v121
    v_exp_f32 v122, v122
    v_exp_f32 v123, v123
    v_cvt_pk_bf16_f32 v148, v120, v121
    v_cvt_pk_bf16_f32 v149, v122, v123
    v_mfma_f32_32x32x16_bf16 v[80:95], v[192:195], v[144:147], v[80:95]
    s_waitcnt vmcnt(9)
    v_exp_f32 v124, v124
    v_exp_f32 v125, v125
    v_exp_f32 v126, v126
    v_exp_f32_e64 v127, v127
    v_cvt_pk_bf16_f32 v150, v124, v125
    v_cvt_pk_bf16_f32 v151, v126, v127
    v_mfma_f32_32x32x16_bf16 v[112:127], v[240:243], v[16:19], 0
    s_xor_b32 s65, s70, 1835008
    v_exp_f32 v128, v128
    v_exp_f32 v129, v129
    v_exp_f32 v130, v130
    v_exp_f32 v131, v131
    v_cvt_pk_bf16_f32 v144, v128, v129
    v_cvt_pk_bf16_f32 v145, v130, v131
    v_mfma_f32_32x32x16_bf16 v[80:95], v[196:199], v[148:151], v[80:95]
    s_add_u32 s44, s40, s65
    v_exp_f32 v132, v132
    v_exp_f32 v133, v133
    v_exp_f32 v134, v134
    v_exp_f32_e64 v135, v135
    v_cvt_pk_bf16_f32 v146, v132, v133
    v_cvt_pk_bf16_f32 v147, v134, v135
    v_mfma_f32_32x32x16_bf16 v[112:127], v[244:247], v[20:23], v[112:127]
    s_addc_u32 s45, s41, 0
    v_exp_f32 v136, v136
    v_exp_f32 v137, v137
    v_exp_f32 v138, v138
    v_exp_f32_e64 v139, v139
    v_cvt_pk_bf16_f32 v148, v136, v137
    v_cvt_pk_bf16_f32 v149, v138, v139
    v_mfma_f32_32x32x16_bf16 v[96:111], v[192:195], v[144:147], v[96:111]
    v_exp_f32 v140, v140
    v_exp_f32 v141, v141
    v_exp_f32 v142, v142
    v_exp_f32 v143, v143
    v_cvt_pk_bf16_f32 v150, v140, v141
    v_cvt_pk_bf16_f32 v151, v142, v143
    v_mfma_f32_32x32x16_bf16 v[128:143], v[240:243], v[24:27], 0
    v_exp_f32 v112, v112
    v_exp_f32 v113, v113
    v_exp_f32 v114, v114
    v_exp_f32 v115, v115
    v_cvt_pk_bf16_f32 v144, v112, v113
    v_cvt_pk_bf16_f32 v145, v114, v115
    v_mfma_f32_32x32x16_bf16 v[96:111], v[196:199], v[148:151], v[96:111]
    buffer_load_dwordx4 v[184:187], v213, s[44:47], 0 offen offset:0 sc1
    v_exp_f32 v116, v116
    v_exp_f32 v117, v117
    v_exp_f32 v118, v118
    v_exp_f32 v119, v119
    v_cvt_pk_bf16_f32 v146, v116, v117
    v_cvt_pk_bf16_f32 v147, v118, v119
    v_mfma_f32_32x32x16_bf16 v[128:143], v[244:247], v[28:31], v[128:143]
    buffer_load_dwordx4 v[188:191], v213, s[44:47], 0 offen offset:1024 sc1
    v_exp_f32 v120, v120
    v_exp_f32 v121, v121
    v_exp_f32 v122, v122
    v_exp_f32 v123, v123
    v_cvt_pk_bf16_f32 v148, v120, v121
    v_cvt_pk_bf16_f32 v149, v122, v123
    v_mfma_f32_32x32x16_bf16 v[48:63], v[248:251], v[144:147], v[48:63]
    buffer_load_dwordx4 v[192:195], v215, s[44:47], 0 offen sc1
    v_exp_f32 v124, v124
    v_exp_f32 v125, v125
    v_exp_f32 v126, v126
    v_exp_f32 v127, v127
    v_cvt_pk_bf16_f32 v150, v124, v125
    v_cvt_pk_bf16_f32 v151, v126, v127
    v_mfma_f32_32x32x16_bf16 v[112:127], v[240:243], v[32:35], 0
    buffer_load_dwordx4 v[196:199], v216, s[44:47], 0 offen sc1
    v_exp_f32 v128, v128
    v_exp_f32 v129, v129
    v_exp_f32 v130, v130
    v_exp_f32 v131, v131
    v_cvt_pk_bf16_f32 v144, v128, v129
    v_cvt_pk_bf16_f32 v145, v130, v131
    v_mfma_f32_32x32x16_bf16 v[48:63], v[252:255], v[148:151], v[48:63]
    s_mov_b32 s67, 1376256
    v_exp_f32 v132, v132
    v_exp_f32 v133, v133
    v_exp_f32 v134, v134
    v_exp_f32 v135, v135
    v_cvt_pk_bf16_f32 v146, v132, v133
    v_cvt_pk_bf16_f32 v147, v134, v135
    v_mfma_f32_32x32x16_bf16 v[112:127], v[244:247], v[36:39], v[112:127]
    buffer_load_dword v211, v212, s[16:19], s67 offen
    v_exp_f32 v136, v136
    v_exp_f32 v137, v137
    v_exp_f32 v138, v138
    v_exp_f32 v139, v139
    v_cvt_pk_bf16_f32 v148, v136, v137
    v_cvt_pk_bf16_f32 v149, v138, v139
    v_mfma_f32_32x32x16_bf16 v[64:79], v[248:251], v[144:147], v[64:79]
    v_exp_f32 v140, v140
    v_exp_f32 v141, v141
    v_exp_f32 v142, v142
    v_exp_f32 v143, v143
    v_cvt_pk_bf16_f32 v150, v140, v141
    v_cvt_pk_bf16_f32 v151, v142, v143
    v_mfma_f32_32x32x16_bf16 v[128:143], v[240:243], v[40:43], 0
    v_exp_f32 v112, v112
    v_exp_f32 v113, v113
    v_exp_f32 v114, v114
    v_exp_f32 v115, v115
    v_cvt_pk_bf16_f32 v144, v112, v113
    v_cvt_pk_bf16_f32 v145, v114, v115
    v_mfma_f32_32x32x16_bf16 v[64:79], v[252:255], v[148:151], v[64:79]
    v_exp_f32 v116, v116
    v_exp_f32 v117, v117
    v_exp_f32 v118, v118
    v_exp_f32 v119, v119
    v_cvt_pk_bf16_f32 v146, v116, v117
    v_cvt_pk_bf16_f32 v147, v118, v119
    v_mfma_f32_32x32x16_bf16 v[128:143], v[244:247], v[44:47], v[128:143]
    v_exp_f32 v120, v120
    v_exp_f32 v121, v121
    v_exp_f32 v122, v122
    v_exp_f32 v123, v123
    v_cvt_pk_bf16_f32 v148, v120, v121
    v_cvt_pk_bf16_f32 v149, v122, v123
    v_mfma_f32_32x32x16_bf16 v[80:95], v[248:251], v[144:147], v[80:95]
    s_waitcnt vmcnt(10)
    v_exp_f32 v124, v124
    v_exp_f32 v125, v125
    v_exp_f32 v126, v126
    v_exp_f32_e64 v127, v127
    v_cvt_pk_bf16_f32 v150, v124, v125
    v_cvt_pk_bf16_f32 v151, v126, v127
    v_mfma_f32_32x32x16_bf16 v[112:127], v[152:155], v[16:19], 0
    s_xor_b32 s65, s70, 2097152
    v_exp_f32 v128, v128
    v_exp_f32 v129, v129
    v_exp_f32 v130, v130
    v_exp_f32 v131, v131
    v_cvt_pk_bf16_f32 v144, v128, v129
    v_cvt_pk_bf16_f32 v145, v130, v131
    v_mfma_f32_32x32x16_bf16 v[80:95], v[252:255], v[148:151], v[80:95]
    s_add_u32 s44, s40, s65
    v_exp_f32 v132, v132
    v_exp_f32 v133, v133
    v_exp_f32 v134, v134
    v_exp_f32_e64 v135, v135
    v_cvt_pk_bf16_f32 v146, v132, v133
    v_cvt_pk_bf16_f32 v147, v134, v135
    v_mfma_f32_32x32x16_bf16 v[112:127], v[156:159], v[20:23], v[112:127]
    s_addc_u32 s45, s41, 0
    v_exp_f32 v136, v136
    v_exp_f32 v137, v137
    v_exp_f32 v138, v138
    v_exp_f32_e64 v139, v139
    v_cvt_pk_bf16_f32 v148, v136, v137
    v_cvt_pk_bf16_f32 v149, v138, v139
    v_mfma_f32_32x32x16_bf16 v[96:111], v[248:251], v[144:147], v[96:111]
    v_exp_f32 v140, v140
    v_exp_f32 v141, v141
    v_exp_f32 v142, v142
    v_exp_f32 v143, v143
    v_cvt_pk_bf16_f32 v150, v140, v141
    v_cvt_pk_bf16_f32 v151, v142, v143
    v_mfma_f32_32x32x16_bf16 v[128:143], v[152:155], v[24:27], 0
    v_exp_f32 v112, v112
    v_exp_f32 v113, v113
    v_exp_f32 v114, v114
    v_exp_f32 v115, v115
    v_cvt_pk_bf16_f32 v144, v112, v113
    v_cvt_pk_bf16_f32 v145, v114, v115
    v_mfma_f32_32x32x16_bf16 v[96:111], v[252:255], v[148:151], v[96:111]
    buffer_load_dwordx4 v[240:243], v213, s[44:47], 0 offen offset:0 sc1
    v_exp_f32 v116, v116
    v_exp_f32 v117, v117
    v_exp_f32 v118, v118
    v_exp_f32 v119, v119
    v_cvt_pk_bf16_f32 v146, v116, v117
    v_cvt_pk_bf16_f32 v147, v118, v119
    v_mfma_f32_32x32x16_bf16 v[128:143], v[156:159], v[28:31], v[128:143]
    buffer_load_dwordx4 v[244:247], v213, s[44:47], 0 offen offset:1024 sc1
    v_exp_f32 v120, v120
    v_exp_f32 v121, v121
    v_exp_f32 v122, v122
    v_exp_f32 v123, v123
    v_cvt_pk_bf16_f32 v148, v120, v121
    v_cvt_pk_bf16_f32 v149, v122, v123
    v_mfma_f32_32x32x16_bf16 v[48:63], v[160:163], v[144:147], v[48:63]
    buffer_load_dwordx4 v[248:251], v215, s[44:47], 0 offen sc1
    v_exp_f32 v124, v124
    v_exp_f32 v125, v125
    v_exp_f32 v126, v126
    v_exp_f32 v127, v127
    v_cvt_pk_bf16_f32 v150, v124, v125
    v_cvt_pk_bf16_f32 v151, v126, v127
    v_mfma_f32_32x32x16_bf16 v[112:127], v[152:155], v[32:35], 0
    buffer_load_dwordx4 v[252:255], v216, s[44:47], 0 offen sc1
    v_exp_f32 v128, v128
    v_exp_f32 v129, v129
    v_exp_f32 v130, v130
    v_exp_f32 v131, v131
    v_cvt_pk_bf16_f32 v144, v128, v129
    v_cvt_pk_bf16_f32 v145, v130, v131
    v_mfma_f32_32x32x16_bf16 v[48:63], v[164:167], v[148:151], v[48:63]
    v_exp_f32 v132, v132
    v_exp_f32 v133, v133
    v_exp_f32 v134, v134
    v_exp_f32 v135, v135
    v_cvt_pk_bf16_f32 v146, v132, v133
    v_cvt_pk_bf16_f32 v147, v134, v135
    v_mfma_f32_32x32x16_bf16 v[112:127], v[156:159], v[36:39], v[112:127]
    v_exp_f32 v136, v136
    v_exp_f32 v137, v137
    v_exp_f32 v138, v138
    v_exp_f32 v139, v139
    v_cvt_pk_bf16_f32 v148, v136, v137
    v_cvt_pk_bf16_f32 v149, v138, v139
    v_mfma_f32_32x32x16_bf16 v[64:79], v[160:163], v[144:147], v[64:79]
    v_exp_f32 v140, v140
    v_exp_f32 v141, v141
    v_exp_f32 v142, v142
    v_exp_f32 v143, v143
    v_cvt_pk_bf16_f32 v150, v140, v141
    v_cvt_pk_bf16_f32 v151, v142, v143
    v_mfma_f32_32x32x16_bf16 v[128:143], v[152:155], v[40:43], 0
    v_exp_f32 v112, v112
    v_exp_f32 v113, v113
    v_exp_f32 v114, v114
    v_exp_f32 v115, v115
    v_cvt_pk_bf16_f32 v144, v112, v113
    v_cvt_pk_bf16_f32 v145, v114, v115
    v_mfma_f32_32x32x16_bf16 v[64:79], v[164:167], v[148:151], v[64:79]
    v_exp_f32 v116, v116
    v_exp_f32 v117, v117
    v_exp_f32 v118, v118
    v_exp_f32 v119, v119
    v_cvt_pk_bf16_f32 v146, v116, v117
    v_cvt_pk_bf16_f32 v147, v118, v119
    v_mfma_f32_32x32x16_bf16 v[128:143], v[156:159], v[44:47], v[128:143]
    v_exp_f32 v120, v120
    v_exp_f32 v121, v121
    v_exp_f32 v122, v122
    v_exp_f32 v123, v123
    v_cvt_pk_bf16_f32 v148, v120, v121
    v_cvt_pk_bf16_f32 v149, v122, v123
    v_mfma_f32_32x32x16_bf16 v[80:95], v[160:163], v[144:147], v[80:95]
    s_waitcnt vmcnt(9)
    v_exp_f32 v124, v124
    v_exp_f32 v125, v125
    v_exp_f32 v126, v126
    v_exp_f32_e64 v127, v127
    v_cvt_pk_bf16_f32 v150, v124, v125
    v_cvt_pk_bf16_f32 v151, v126, v127
    v_mfma_f32_32x32x16_bf16 v[112:127], v[168:171], v[16:19], 0
    s_add_u32 m0, s57, 8192
    v_exp_f32 v128, v128
    v_exp_f32 v129, v129
    v_exp_f32 v130, v130
    v_exp_f32 v131, v131
    v_cvt_pk_bf16_f32 v144, v128, v129
    v_cvt_pk_bf16_f32 v145, v130, v131
    v_mfma_f32_32x32x16_bf16 v[80:95], v[164:167], v[148:151], v[80:95]
    s_add_u32 s12, s12, 25088
    v_exp_f32 v132, v132
    v_exp_f32 v133, v133
    v_exp_f32 v134, v134
    v_exp_f32 v135, v135
    v_cvt_pk_bf16_f32 v146, v132, v133
    v_cvt_pk_bf16_f32 v147, v134, v135
    v_mfma_f32_32x32x16_bf16 v[112:127], v[172:175], v[20:23], v[112:127]
    s_addc_u32 s13, s13, 0
    v_exp_f32 v136, v136
    v_exp_f32 v137, v137
    v_exp_f32 v138, v138
    v_exp_f32_e64 v139, v139
    v_cvt_pk_bf16_f32 v148, v136, v137
    v_cvt_pk_bf16_f32 v149, v138, v139
    v_mfma_f32_32x32x16_bf16 v[96:111], v[160:163], v[144:147], v[96:111]
    s_mov_b32 s14, 351232
    v_exp_f32 v140, v140
    v_exp_f32 v141, v141
    v_exp_f32 v142, v142
    v_exp_f32 v143, v143
    v_cvt_pk_bf16_f32 v150, v140, v141
    v_cvt_pk_bf16_f32 v151, v142, v143
    v_mfma_f32_32x32x16_bf16 v[128:143], v[168:171], v[24:27], 0
    buffer_load_dwordx4 v220, s[12:15], 0 offen offset:0 lds
    v_exp_f32 v112, v112
    v_exp_f32 v113, v113
    v_exp_f32 v114, v114
    v_exp_f32 v115, v115
    v_cvt_pk_bf16_f32 v144, v112, v113
    v_cvt_pk_bf16_f32 v145, v114, v115
    v_mfma_f32_32x32x16_bf16 v[96:111], v[164:167], v[148:151], v[96:111]
    buffer_load_dwordx4 v221, s[12:15], 0 offen offset:1024 lds
    v_exp_f32 v116, v116
    v_exp_f32 v117, v117
    v_exp_f32 v118, v118
    v_exp_f32 v119, v119
    v_cvt_pk_bf16_f32 v146, v116, v117
    v_cvt_pk_bf16_f32 v147, v118, v119
    v_mfma_f32_32x32x16_bf16 v[128:143], v[172:175], v[28:31], v[128:143]
    buffer_load_dwordx4 v222, s[12:15], 0 offen offset:2048 lds
    v_exp_f32 v120, v120
    v_exp_f32 v121, v121
    v_exp_f32 v122, v122
    v_exp_f32 v123, v123
    v_cvt_pk_bf16_f32 v148, v120, v121
    v_cvt_pk_bf16_f32 v149, v122, v123
    v_mfma_f32_32x32x16_bf16 v[48:63], v[176:179], v[144:147], v[48:63]
    buffer_load_dwordx4 v223, s[12:15], 0 offen offset:3072 lds
    v_exp_f32 v124, v124
    v_exp_f32 v125, v125
    v_exp_f32 v126, v126
    v_exp_f32 v127, v127
    v_cvt_pk_bf16_f32 v150, v124, v125
    v_cvt_pk_bf16_f32 v151, v126, v127
    v_mfma_f32_32x32x16_bf16 v[112:127], v[168:171], v[32:35], 0
    s_xor_b32 s65, s70, 2359296
    v_exp_f32 v128, v128
    v_exp_f32 v129, v129
    v_exp_f32 v130, v130
    v_exp_f32 v131, v131
    v_cvt_pk_bf16_f32 v144, v128, v129
    v_cvt_pk_bf16_f32 v145, v130, v131
    v_mfma_f32_32x32x16_bf16 v[48:63], v[180:183], v[148:151], v[48:63]
    s_add_u32 s44, s40, s65
    v_exp_f32 v132, v132
    v_exp_f32 v133, v133
    v_exp_f32 v134, v134
    v_exp_f32_e64 v135, v135
    v_cvt_pk_bf16_f32 v146, v132, v133
    v_cvt_pk_bf16_f32 v147, v134, v135
    v_mfma_f32_32x32x16_bf16 v[112:127], v[172:175], v[36:39], v[112:127]
    s_addc_u32 s45, s41, 0
    v_exp_f32 v136, v136
    v_exp_f32 v137, v137
    v_exp_f32 v138, v138
    v_exp_f32_e64 v139, v139
    v_cvt_pk_bf16_f32 v148, v136, v137
    v_cvt_pk_bf16_f32 v149, v138, v139
    v_mfma_f32_32x32x16_bf16 v[64:79], v[176:179], v[144:147], v[64:79]
    buffer_load_dwordx4 v[152:155], v213, s[44:47], 0 offen offset:0 sc1
    v_exp_f32 v140, v140
    v_exp_f32 v141, v141
    v_exp_f32 v142, v142
    v_exp_f32 v143, v143
    v_cvt_pk_bf16_f32 v150, v140, v141
    v_cvt_pk_bf16_f32 v151, v142, v143
    v_mfma_f32_32x32x16_bf16 v[128:143], v[168:171], v[40:43], 0
    buffer_load_dwordx4 v[156:159], v213, s[44:47], 0 offen offset:1024 sc1
    v_exp_f32 v112, v112
    v_exp_f32 v113, v113
    v_exp_f32 v114, v114
    v_exp_f32 v115, v115
    v_cvt_pk_bf16_f32 v144, v112, v113
    v_cvt_pk_bf16_f32 v145, v114, v115
    v_mfma_f32_32x32x16_bf16 v[64:79], v[180:183], v[148:151], v[64:79]
    buffer_load_dwordx4 v[160:163], v215, s[44:47], 0 offen sc1
    v_exp_f32 v116, v116
    v_exp_f32 v117, v117
    v_exp_f32 v118, v118
    v_exp_f32 v119, v119
    v_cvt_pk_bf16_f32 v146, v116, v117
    v_cvt_pk_bf16_f32 v147, v118, v119
    v_mfma_f32_32x32x16_bf16 v[128:143], v[172:175], v[44:47], v[128:143]
    buffer_load_dwordx4 v[164:167], v216, s[44:47], 0 offen sc1
    v_exp_f32 v120, v120
    v_exp_f32 v121, v121
    v_exp_f32 v122, v122
    v_exp_f32 v123, v123
    v_cvt_pk_bf16_f32 v148, v120, v121
    v_cvt_pk_bf16_f32 v149, v122, v123
    v_mfma_f32_32x32x16_bf16 v[80:95], v[176:179], v[144:147], v[80:95]
    s_waitcnt vmcnt(13)
    v_exp_f32 v124, v124
    v_exp_f32 v125, v125
    v_exp_f32 v126, v126
    v_exp_f32_e64 v127, v127
    v_cvt_pk_bf16_f32 v150, v124, v125
    v_cvt_pk_bf16_f32 v151, v126, v127
    v_mfma_f32_32x32x16_bf16 v[112:127], v[184:187], v[16:19], 0
    s_add_u32 m0, s57, 12288
    v_exp_f32 v128, v128
    v_exp_f32 v129, v129
    v_exp_f32 v130, v130
    v_exp_f32 v131, v131
    v_cvt_pk_bf16_f32 v144, v128, v129
    v_cvt_pk_bf16_f32 v145, v130, v131
    v_mfma_f32_32x32x16_bf16 v[80:95], v[180:183], v[148:151], v[80:95]
    s_add_u32 s12, s12, 25088
    v_exp_f32 v132, v132
    v_exp_f32 v133, v133
    v_exp_f32 v134, v134
    v_exp_f32 v135, v135
    v_cvt_pk_bf16_f32 v146, v132, v133
    v_cvt_pk_bf16_f32 v147, v134, v135
    v_mfma_f32_32x32x16_bf16 v[112:127], v[188:191], v[20:23], v[112:127]
    s_addc_u32 s13, s13, 0
    v_exp_f32 v136, v136
    v_exp_f32 v137, v137
    v_exp_f32 v138, v138
    v_exp_f32_e64 v139, v139
    v_cvt_pk_bf16_f32 v148, v136, v137
    v_cvt_pk_bf16_f32 v149, v138, v139
    v_mfma_f32_32x32x16_bf16 v[96:111], v[176:179], v[144:147], v[96:111]
    s_mov_b32 s14, 326144
    v_exp_f32 v140, v140
    v_exp_f32 v141, v141
    v_exp_f32 v142, v142
    v_exp_f32 v143, v143
    v_cvt_pk_bf16_f32 v150, v140, v141
    v_cvt_pk_bf16_f32 v151, v142, v143
    v_mfma_f32_32x32x16_bf16 v[128:143], v[184:187], v[24:27], 0
    buffer_load_dwordx4 v220, s[12:15], 0 offen offset:0 lds
    v_exp_f32 v112, v112
    v_exp_f32 v113, v113
    v_exp_f32 v114, v114
    v_exp_f32 v115, v115
    v_cvt_pk_bf16_f32 v144, v112, v113
    v_cvt_pk_bf16_f32 v145, v114, v115
    v_mfma_f32_32x32x16_bf16 v[96:111], v[180:183], v[148:151], v[96:111]
    buffer_load_dwordx4 v221, s[12:15], 0 offen offset:1024 lds
    v_exp_f32 v116, v116
    v_exp_f32 v117, v117
    v_exp_f32 v118, v118
    v_exp_f32 v119, v119
    v_cvt_pk_bf16_f32 v146, v116, v117
    v_cvt_pk_bf16_f32 v147, v118, v119
    v_mfma_f32_32x32x16_bf16 v[128:143], v[188:191], v[28:31], v[128:143]
    buffer_load_dwordx4 v222, s[12:15], 0 offen offset:2048 lds
    v_exp_f32 v120, v120
    v_exp_f32 v121, v121
    v_exp_f32 v122, v122
    v_exp_f32 v123, v123
    v_cvt_pk_bf16_f32 v148, v120, v121
    v_cvt_pk_bf16_f32 v149, v122, v123
    v_mfma_f32_32x32x16_bf16 v[48:63], v[192:195], v[144:147], v[48:63]
    buffer_load_dwordx4 v223, s[12:15], 0 offen offset:3072 lds
    v_exp_f32 v124, v124
    v_exp_f32 v125, v125
    v_exp_f32 v126, v126
    v_exp_f32 v127, v127
    v_cvt_pk_bf16_f32 v150, v124, v125
    v_cvt_pk_bf16_f32 v151, v126, v127
    v_mfma_f32_32x32x16_bf16 v[112:127], v[184:187], v[32:35], 0
    s_xor_b32 s65, s70, 2621440
    v_exp_f32 v128, v128
    v_exp_f32 v129, v129
    v_exp_f32 v130, v130
    v_exp_f32 v131, v131
    v_cvt_pk_bf16_f32 v144, v128, v129
    v_cvt_pk_bf16_f32 v145, v130, v131
    v_mfma_f32_32x32x16_bf16 v[48:63], v[196:199], v[148:151], v[48:63]
    s_add_u32 s44, s40, s65
    v_exp_f32 v132, v132
    v_exp_f32 v133, v133
    v_exp_f32 v134, v134
    v_exp_f32_e64 v135, v135
    v_cvt_pk_bf16_f32 v146, v132, v133
    v_cvt_pk_bf16_f32 v147, v134, v135
    v_mfma_f32_32x32x16_bf16 v[112:127], v[188:191], v[36:39], v[112:127]
    s_addc_u32 s45, s41, 0
    v_exp_f32 v136, v136
    v_exp_f32 v137, v137
    v_exp_f32 v138, v138
    v_exp_f32_e64 v139, v139
    v_cvt_pk_bf16_f32 v148, v136, v137
    v_cvt_pk_bf16_f32 v149, v138, v139
    v_mfma_f32_32x32x16_bf16 v[64:79], v[192:195], v[144:147], v[64:79]
    buffer_load_dwordx4 v[168:171], v213, s[44:47], 0 offen offset:0 sc1
    v_exp_f32 v140, v140
    v_exp_f32 v141, v141
    v_exp_f32 v142, v142
    v_exp_f32 v143, v143
    v_cvt_pk_bf16_f32 v150, v140, v141
    v_cvt_pk_bf16_f32 v151, v142, v143
    v_mfma_f32_32x32x16_bf16 v[128:143], v[184:187], v[40:43], 0
    buffer_load_dwordx4 v[172:175], v213, s[44:47], 0 offen offset:1024 sc1
    v_exp_f32 v112, v112
    v_exp_f32 v113, v113
    v_exp_f32 v114, v114
    v_exp_f32 v115, v115
    v_cvt_pk_bf16_f32 v144, v112, v113
    v_cvt_pk_bf16_f32 v145, v114, v115
    v_mfma_f32_32x32x16_bf16 v[64:79], v[196:199], v[148:151], v[64:79]
    buffer_load_dwordx4 v[176:179], v215, s[44:47], 0 offen sc1
    v_exp_f32 v116, v116
    v_exp_f32 v117, v117
    v_exp_f32 v118, v118
    v_exp_f32 v119, v119
    v_cvt_pk_bf16_f32 v146, v116, v117
    v_cvt_pk_bf16_f32 v147, v118, v119
    v_mfma_f32_32x32x16_bf16 v[128:143], v[188:191], v[44:47], v[128:143]
    buffer_load_dwordx4 v[180:183], v216, s[44:47], 0 offen sc1
    v_exp_f32 v120, v120
    v_exp_f32 v121, v121
    v_exp_f32 v122, v122
    v_exp_f32 v123, v123
    v_cvt_pk_bf16_f32 v148, v120, v121
    v_cvt_pk_bf16_f32 v149, v122, v123
    v_mfma_f32_32x32x16_bf16 v[80:95], v[192:195], v[144:147], v[80:95]
    s_waitcnt vmcnt(12)
    v_exp_f32 v124, v124
    v_exp_f32 v125, v125
    v_exp_f32 v126, v126
    v_exp_f32_e64 v127, v127
    v_cvt_pk_bf16_f32 v150, v124, v125
    v_cvt_pk_bf16_f32 v151, v126, v127
    v_mfma_f32_32x32x16_bf16 v[112:127], v[240:243], v[16:19], 0
    s_add_u32 m0, s57, 16384
    ds_read_b64_tr_b16 a[224:225], v206 offset:8192
    buffer_load_dwordx4 v200, s[16:19], 0 offen offset:0 lds
    buffer_load_dwordx4 v201, s[16:19], 0 offen offset:1024 lds
    v_exp_f32 v128, v128
    v_exp_f32 v129, v129
    v_exp_f32 v130, v130
    v_exp_f32 v131, v131
    v_cvt_pk_bf16_f32 v144, v128, v129
    v_cvt_pk_bf16_f32 v145, v130, v131
    v_mfma_f32_32x32x16_bf16 v[80:95], v[196:199], v[148:151], v[80:95]
L_ws0_4:
    s_cbranch_execz L_wr0
    ds_read_b64_tr_b16 a[226:227], v206 offset:9216
    buffer_load_dwordx4 v202, s[16:19], 0 offen offset:2048 lds
    buffer_load_dwordx4 v203, s[16:19], 0 offen offset:3072 lds
    v_exp_f32 v132, v132
    v_exp_f32 v133, v133
    v_exp_f32 v134, v134
    v_exp_f32_e64 v135, v135
    v_cvt_pk_bf16_f32 v146, v132, v133
    v_cvt_pk_bf16_f32 v147, v134, v135
    v_mfma_f32_32x32x16_bf16 v[112:127], v[244:247], v[20:23], v[112:127]
    s_add_u32 m0, s57, 20480
    ds_read_b64_tr_b16 a[228:229], v206 offset:8448
    v_exp_f32 v136, v136
    v_exp_f32 v137, v137
    v_exp_f32 v138, v138
    v_exp_f32 v139, v139
    v_cvt_pk_bf16_f32 v148, v136, v137
    v_cvt_pk_bf16_f32 v149, v138, v139
    v_mfma_f32_32x32x16_bf16 v[96:111], v[192:195], v[144:147], v[96:111]
    s_add_u32 s16, s16, 114688
    ds_read_b64_tr_b16 a[230:231], v206 offset:9472
    v_exp_f32 v140, v140
    v_exp_f32 v141, v141
    v_exp_f32 v142, v142
    v_exp_f32 v143, v143
    v_cvt_pk_bf16_f32 v150, v140, v141
    v_cvt_pk_bf16_f32 v151, v142, v143
    v_mfma_f32_32x32x16_bf16 v[128:143], v[240:243], v[24:27], 0
    s_addc_u32 s17, s17, 0
    ds_read_b64_tr_b16 a[232:233], v206 offset:10240
    buffer_load_dwordx4 v200, s[16:19], 0 offen offset:0 lds
    v_exp_f32 v112, v112
    v_exp_f32 v113, v113
    v_exp_f32 v114, v114
    v_exp_f32_e64 v115, v115
    v_cvt_pk_bf16_f32 v144, v112, v113
    v_cvt_pk_bf16_f32 v145, v114, v115
    v_mfma_f32_32x32x16_bf16 v[96:111], v[196:199], v[148:151], v[96:111]
    ds_read_b64_tr_b16 a[234:235], v206 offset:11264
    buffer_load_dwordx4 v201, s[16:19], 0 offen offset:1024 lds
    v_exp_f32 v116, v116
    v_exp_f32 v117, v117
    v_exp_f32 v118, v118
    v_exp_f32 v119, v119
    v_cvt_pk_bf16_f32 v146, v116, v117
    v_cvt_pk_bf16_f32 v147, v118, v119
    v_mfma_f32_32x32x16_bf16 v[128:143], v[244:247], v[28:31], v[128:143]
    ds_read_b64_tr_b16 a[236:237], v206 offset:10496
    buffer_load_dwordx4 v202, s[16:19], 0 offen offset:2048 lds
    v_exp_f32 v120, v120
    v_exp_f32 v121, v121
    v_exp_f32 v122, v122
    v_exp_f32 v123, v123
    v_cvt_pk_bf16_f32 v148, v120, v121
    v_cvt_pk_bf16_f32 v149, v122, v123
    v_mfma_f32_32x32x16_bf16 v[48:63], v[248:251], v[144:147], v[48:63]
    ds_read_b64_tr_b16 a[238:239], v206 offset:11520
    buffer_load_dwordx4 v203, s[16:19], 0 offen offset:3072 lds
    v_exp_f32 v124, v124
    v_exp_f32 v125, v125
    v_exp_f32 v126, v126
    v_exp_f32 v127, v127
    v_cvt_pk_bf16_f32 v150, v124, v125
    v_cvt_pk_bf16_f32 v151, v126, v127
    v_mfma_f32_32x32x16_bf16 v[112:127], v[240:243], v[32:35], 0
    s_xor_b32 s65, s70, 2883584
    v_exp_f32 v128, v128
    v_exp_f32 v129, v129
    v_exp_f32 v130, v130
    v_exp_f32 v131, v131
    v_cvt_pk_bf16_f32 v144, v128, v129
    v_cvt_pk_bf16_f32 v145, v130, v131
    v_mfma_f32_32x32x16_bf16 v[48:63], v[252:255], v[148:151], v[48:63]
    s_add_u32 s44, s40, s65
    v_exp_f32 v132, v132
    v_exp_f32 v133, v133
    v_exp_f32 v134, v134
    v_exp_f32_e64 v135, v135
    v_cvt_pk_bf16_f32 v146, v132, v133
    v_cvt_pk_bf16_f32 v147, v134, v135
    v_mfma_f32_32x32x16_bf16 v[112:127], v[244:247], v[36:39], v[112:127]
    s_addc_u32 s45, s41, 0
    v_exp_f32 v136, v136
    v_exp_f32 v137, v137
    v_exp_f32 v138, v138
    v_exp_f32_e64 v139, v139
    v_cvt_pk_bf16_f32 v148, v136, v137
    v_cvt_pk_bf16_f32 v149, v138, v139
    v_mfma_f32_32x32x16_bf16 v[64:79], v[248:251], v[144:147], v[64:79]
    buffer_load_dwordx4 v[184:187], v213, s[44:47], 0 offen offset:0 sc1
    v_exp_f32 v140, v140
    v_exp_f32 v141, v141
    v_exp_f32 v142, v142
    v_exp_f32 v143, v143
    v_cvt_pk_bf16_f32 v150, v140, v141
    v_cvt_pk_bf16_f32 v151, v142, v143
    v_mfma_f32_32x32x16_bf16 v[128:143], v[240:243], v[40:43], 0
    buffer_load_dwordx4 v[188:191], v213, s[44:47], 0 offen offset:1024 sc1
    v_exp_f32 v112, v112
    v_exp_f32 v113, v113
    v_exp_f32 v114, v114
    v_exp_f32 v115, v115
    v_cvt_pk_bf16_f32 v144, v112, v113
    v_cvt_pk_bf16_f32 v145, v114, v115
    v_mfma_f32_32x32x16_bf16 v[64:79], v[252:255], v[148:151], v[64:79]
    buffer_load_dwordx4 v[192:195], v215, s[44:47], 0 offen sc1
    v_exp_f32 v116, v116
    v_exp_f32 v117, v117
    v_exp_f32 v118, v118
    v_exp_f32 v119, v119
    v_cvt_pk_bf16_f32 v146, v116, v117
    v_cvt_pk_bf16_f32 v147, v118, v119
    v_mfma_f32_32x32x16_bf16 v[128:143], v[244:247], v[44:47], v[128:143]
    buffer_load_dwordx4 v[196:199], v216, s[44:47], 0 offen sc1
    v_exp_f32 v120, v120
    v_exp_f32 v121, v121
    v_exp_f32 v122, v122
    v_exp_f32 v123, v123
    v_cvt_pk_bf16_f32 v148, v120, v121
    v_cvt_pk_bf16_f32 v149, v122, v123
    v_mfma_f32_32x32x16_bf16 v[80:95], v[248:251], v[144:147], v[80:95]
    s_waitcnt vmcnt(16) lgkmcnt(0)
    v_exp_f32 v124, v124
    v_exp_f32 v125, v125
    v_exp_f32 v126, v126
    v_exp_f32_e64 v127, v127
    v_cvt_pk_bf16_f32 v150, v124, v125
    v_cvt_pk_bf16_f32 v151, v126, v127
    v_mfma_f32_32x32x16_bf16 v[112:127], v[152:155], v[16:19], 0
    s_add_u32 m0, s57, 0
    ds_read_b64_tr_b16 a[240:241], v206 offset:12288
    v_exp_f32 v128, v128
    v_exp_f32 v129, v129
    v_exp_f32 v130, v130
    v_exp_f32_e64 v131, v131
    v_cvt_pk_bf16_f32 v144, v128, v129
    v_cvt_pk_bf16_f32 v145, v130, v131
    v_mfma_f32_32x32x16_bf16 v[80:95], v[252:255], v[148:151], v[80:95]
    s_add_u32 s16, s16, 114688
    ds_read_b64_tr_b16 a[242:243], v206 offset:13312
    v_exp_f32 v132, v132
    v_exp_f32 v133, v133
    v_exp_f32 v134, v134
    v_exp_f32 v135, v135
    v_cvt_pk_bf16_f32 v146, v132, v133
    v_cvt_pk_bf16_f32 v147, v134, v135
    v_mfma_f32_32x32x16_bf16 v[112:127], v[156:159], v[20:23], v[112:127]
    s_addc_u32 s17, s17, 0
    ds_read_b64_tr_b16 a[244:245], v206 offset:12544
    buffer_load_dwordx4 v200, s[16:19], 0 offen offset:0 lds
    v_exp_f32 v136, v136
    v_exp_f32 v137, v137
    v_exp_f32 v138, v138
    v_exp_f32_e64 v139, v139
    v_cvt_pk_bf16_f32 v148, v136, v137
    v_cvt_pk_bf16_f32 v149, v138, v139
    v_mfma_f32_32x32x16_bf16 v[96:111], v[248:251], v[144:147], v[96:111]
    ds_read_b64_tr_b16 a[246:247], v206 offset:13568
    buffer_load_dwordx4 v201, s[16:19], 0 offen offset:1024 lds
    v_exp_f32 v140, v140
    v_exp_f32 v141, v141
    v_exp_f32 v142, v142
    v_exp_f32 v143, v143
    v_cvt_pk_bf16_f32 v150, v140, v141
    v_cvt_pk_bf16_f32 v151, v142, v143
    v_mfma_f32_32x32x16_bf16 v[128:143], v[152:155], v[24:27], 0
    ds_read_b64_tr_b16 a[248:249], v206 offset:14336
    buffer_load_dwordx4 v202, s[16:19], 0 offen offset:2048 lds
    v_exp_f32 v112, v112
    v_exp_f32 v113, v113
    v_exp_f32 v114, v114
    v_exp_f32 v115, v115
    v_cvt_pk_bf16_f32 v144, v112, v113
    v_cvt_pk_bf16_f32 v145, v114, v115
    v_mfma_f32_32x32x16_bf16 v[96:111], v[252:255], v[148:151], v[96:111]
    ds_read_b64_tr_b16 a[250:251], v206 offset:15360
    buffer_load_dwordx4 v203, s[16:19], 0 offen offset:3072 lds
    v_exp_f32 v116, v116
    v_exp_f32 v117, v117
    v_exp_f32 v118, v118
    v_exp_f32 v119, v119
    v_cvt_pk_bf16_f32 v146, v116, v117
    v_cvt_pk_bf16_f32 v147, v118, v119
    v_mfma_f32_32x32x16_bf16 v[128:143], v[156:159], v[28:31], v[128:143]
    s_xor_b32 s65, s70, 3145728
    ds_read_b64_tr_b16 a[252:253], v206 offset:14592
    v_exp_f32 v120, v120
    v_exp_f32 v121, v121
    v_exp_f32 v122, v122
    v_exp_f32 v123, v123
    v_cvt_pk_bf16_f32 v148, v120, v121
    v_cvt_pk_bf16_f32 v149, v122, v123
    v_mfma_f32_32x32x16_bf16 v[48:63], v[160:163], v[144:147], v[48:63]
    s_add_u32 s44, s40, s65
    ds_read_b64_tr_b16 a[254:255], v206 offset:15616
    v_exp_f32 v124, v124
    v_exp_f32 v125, v125
    v_exp_f32 v126, v126
    v_exp_f32_e64 v127, v127
    v_cvt_pk_bf16_f32 v150, v124, v125
    v_cvt_pk_bf16_f32 v151, v126, v127
    v_mfma_f32_32x32x16_bf16 v[112:127], v[152:155], v[32:35], 0
    s_addc_u32 s45, s41, 0
    v_exp_f32 v128, v128
    v_exp_f32 v129, v129
    v_exp_f32 v130, v130
    v_exp_f32_e64 v131, v131
    v_cvt_pk_bf16_f32 v144, v128, v129
    v_cvt_pk_bf16_f32 v145, v130, v131
    v_mfma_f32_32x32x16_bf16 v[48:63], v[164:167], v[148:151], v[48:63]
    buffer_load_dwordx4 v[240:243], v213, s[44:47], 0 offen offset:0 sc1
    v_exp_f32 v132, v132
    v_exp_f32 v133, v133
    v_exp_f32 v134, v134
    v_exp_f32 v135, v135
    v_cvt_pk_bf16_f32 v146, v132, v133
    v_cvt_pk_bf16_f32 v147, v134, v135
    v_mfma_f32_32x32x16_bf16 v[112:127], v[156:159], v[36:39], v[112:127]
    buffer_load_dwordx4 v[244:247], v213, s[44:47], 0 offen offset:1024 sc1
    v_exp_f32 v136, v136
    v_exp_f32 v137, v137
    v_exp_f32 v138, v138
    v_exp_f32 v139, v139
    v_cvt_pk_bf16_f32 v148, v136, v137
    v_cvt_pk_bf16_f32 v149, v138, v139
    v_mfma_f32_32x32x16_bf16 v[64:79], v[160:163], v[144:147], v[64:79]
    buffer_load_dwordx4 v[248:251], v215, s[44:47], 0 offen sc1
    v_exp_f32 v140, v140
    v_exp_f32 v141, v141
    v_exp_f32 v142, v142
    v_exp_f32 v143, v143
    v_cvt_pk_bf16_f32 v150, v140, v141
    v_cvt_pk_bf16_f32 v151, v142, v143
    v_mfma_f32_32x32x16_bf16 v[128:143], v[152:155], v[40:43], 0
    buffer_load_dwordx4 v[252:255], v216, s[44:47], 0 offen sc1
    v_exp_f32 v112, v112
    v_exp_f32 v113, v113
    v_exp_f32 v114, v114
    v_exp_f32 v115, v115
    v_cvt_pk_bf16_f32 v144, v112, v113
    v_cvt_pk_bf16_f32 v145, v114, v115
    v_mfma_f32_32x32x16_bf16 v[64:79], v[164:167], v[148:151], v[64:79]
    v_exp_f32 v116, v116
    v_exp_f32 v117, v117
    v_exp_f32 v118, v118
    v_exp_f32 v119, v119
    v_cvt_pk_bf16_f32 v146, v116, v117
    v_cvt_pk_bf16_f32 v147, v118, v119
    v_mfma_f32_32x32x16_bf16 v[128:143], v[156:159], v[44:47], v[128:143]
    v_exp_f32 v120, v120
    v_exp_f32 v121, v121
    v_exp_f32 v122, v122
    v_exp_f32 v123, v123
    v_cvt_pk_bf16_f32 v148, v120, v121
    v_cvt_pk_bf16_f32 v149, v122, v123
    v_mfma_f32_32x32x16_bf16 v[80:95], v[160:163], v[144:147], v[80:95]
    s_waitcnt vmcnt(12) lgkmcnt(0)
    v_exp_f32 v124, v124
    v_exp_f32 v125, v125
    v_exp_f32 v126, v126
    v_exp_f32_e64 v127, v127
    v_cvt_pk_bf16_f32 v150, v124, v125
    v_cvt_pk_bf16_f32 v151, v126, v127
    v_mfma_f32_32x32x16_bf16 v[112:127], v[168:171], v[16:19], 0
    s_add_u32 m0, s57, 4096
    ds_read_b64_tr_b16 a[0:1], v10 offset:16384
    ds_read_b64_tr_b16 a[2:3], v10 offset:16896
    v_exp_f32 v128, v128
    v_exp_f32 v129, v129
    v_exp_f32 v130, v130
    v_exp_f32 v131, v131
    v_cvt_pk_bf16_f32 v144, v128, v129
    v_cvt_pk_bf16_f32 v145, v130, v131
    v_mfma_f32_32x32x16_bf16 v[80:95], v[164:167], v[148:151], v[80:95]
    s_add_u32 s16, s16, 114688
    ds_read_b64_tr_b16 a[4:5], v15 offset:16384
    ds_read_b64_tr_b16 a[6:7], v15 offset:16896
    v_exp_f32 v132, v132
    v_exp_f32 v133, v133
    v_exp_f32 v134, v134
    v_exp_f32 v135, v135
    v_cvt_pk_bf16_f32 v146, v132, v133
    v_cvt_pk_bf16_f32 v147, v134, v135
    v_mfma_f32_32x32x16_bf16 v[112:127], v[172:175], v[20:23], v[112:127]
    s_addc_u32 s17, s17, 0
    ds_read_b64_tr_b16 a[8:9], v10 offset:16640
    ds_read_b64_tr_b16 a[10:11], v10 offset:17152
    buffer_load_dwordx4 v200, s[16:19], 0 offen offset:0 lds
    buffer_load_dwordx4 v201, s[16:19], 0 offen offset:1024 lds
    v_exp_f32 v136, v136
    v_exp_f32 v137, v137
    v_exp_f32 v138, v138
    v_exp_f32_e64 v139, v139
    v_cvt_pk_bf16_f32 v148, v136, v137
    v_cvt_pk_bf16_f32 v149, v138, v139
    v_mfma_f32_32x32x16_bf16 v[96:111], v[160:163], v[144:147], v[96:111]
    ds_read_b64_tr_b16 a[12:13], v15 offset:16640
    buffer_load_dwordx4 v202, s[16:19], 0 offen offset:2048 lds
    buffer_load_dwordx4 v203, s[16:19], 0 offen offset:3072 lds
    v_exp_f32 v140, v140
    v_exp_f32 v141, v141
    v_exp_f32 v142, v142
    v_exp_f32 v143, v143
    v_cvt_pk_bf16_f32 v150, v140, v141
    v_cvt_pk_bf16_f32 v151, v142, v143
    v_mfma_f32_32x32x16_bf16 v[128:143], v[168:171], v[24:27], 0
    s_add_u32 m0, s57, 8192
    ds_read_b64_tr_b16 a[14:15], v15 offset:17152
    v_exp_f32 v112, v112
    v_exp_f32 v113, v113
    v_exp_f32 v114, v114
    v_exp_f32 v115, v115
    v_cvt_pk_bf16_f32 v144, v112, v113
    v_cvt_pk_bf16_f32 v145, v114, v115
    v_mfma_f32_32x32x16_bf16 v[96:111], v[164:167], v[148:151], v[96:111]
    s_add_u32 s16, s16, 114688
    ds_read_b64_tr_b16 a[16:17], v10 offset:20480
    v_exp_f32 v116, v116
    v_exp_f32 v117, v117
    v_exp_f32 v118, v118
    v_exp_f32 v119, v119
    v_cvt_pk_bf16_f32 v146, v116, v117
    v_cvt_pk_bf16_f32 v147, v118, v119
    v_mfma_f32_32x32x16_bf16 v[128:143], v[172:175], v[28:31], v[128:143]
    s_addc_u32 s17, s17, 0
    ds_read_b64_tr_b16 a[18:19], v10 offset:20992
    buffer_load_dwordx4 v200, s[16:19], 0 offen offset:0 lds
    buffer_load_dwordx4 v201, s[16:19], 0 offen offset:1024 lds
    v_exp_f32 v120, v120
    v_exp_f32 v121, v121
    v_exp_f32 v122, v122
    v_exp_f32_e64 v123, v123
    v_cvt_pk_bf16_f32 v148, v120, v121
    v_cvt_pk_bf16_f32 v149, v122, v123
    v_mfma_f32_32x32x16_bf16 v[48:63], v[176:179], v[144:147], v[48:63]
    ds_read_b64_tr_b16 a[20:21], v15 offset:20480
    buffer_load_dwordx4 v202, s[16:19], 0 offen offset:2048 lds
    buffer_load_dwordx4 v203, s[16:19], 0 offen offset:3072 lds
    v_exp_f32 v124, v124
    v_exp_f32 v125, v125
    v_exp_f32 v126, v126
    v_exp_f32 v127, v127
    v_cvt_pk_bf16_f32 v150, v124, v125
    v_cvt_pk_bf16_f32 v151, v126, v127
    v_mfma_f32_32x32x16_bf16 v[112:127], v[168:171], v[32:35], 0
    s_xor_b32 s65, s70, 3407872
    ds_read_b64_tr_b16 a[22:23], v15 offset:20992
    v_exp_f32 v128, v128
    v_exp_f32 v129, v129
    v_exp_f32 v130, v130
    v_exp_f32 v131, v131
    v_cvt_pk_bf16_f32 v144, v128, v129
    v_cvt_pk_bf16_f32 v145, v130, v131
    v_mfma_f32_32x32x16_bf16 v[48:63], v[180:183], v[148:151], v[48:63]
    s_add_u32 s44, s40, s65
    ds_read_b64_tr_b16 a[24:25], v10 offset:20736
    v_exp_f32 v132, v132
    v_exp_f32 v133, v133
    v_exp_f32 v134, v134
    v_exp_f32_e64 v135, v135
    v_cvt_pk_bf16_f32 v146, v132, v133
    v_cvt_pk_bf16_f32 v147, v134, v135
    v_mfma_f32_32x32x16_bf16 v[112:127], v[172:175], v[36:39], v[112:127]
    s_addc_u32 s45, s41, 0
    ds_read_b64_tr_b16 a[26:27], v10 offset:21248
    buffer_load_dwordx4 v[152:155], v213, s[44:47], 0 offen offset:0 sc1
    v_exp_f32 v136, v136
    v_exp_f32 v137, v137
    v_exp_f32 v138, v138
    v_exp_f32_e64 v139, v139
    v_cvt_pk_bf16_f32 v148, v136, v137
    v_cvt_pk_bf16_f32 v149, v138, v139
    v_mfma_f32_32x32x16_bf16 v[64:79], v[176:179], v[144:147], v[64:79]
    ds_read_b64_tr_b16 a[28:29], v15 offset:20736
    buffer_load_dwordx4 v[156:159], v213, s[44:47], 0 offen offset:1024 sc1
    v_exp_f32 v140, v140
    v_exp_f32 v141, v141
    v_exp_f32 v142, v142
    v_exp_f32 v143, v143
    v_cvt_pk_bf16_f32 v150, v140, v141
    v_cvt_pk_bf16_f32 v151, v142, v143
    v_mfma_f32_32x32x16_bf16 v[128:143], v[168:171], v[40:43], 0
    ds_read_b64_tr_b16 a[30:31], v15 offset:21248
    buffer_load_dwordx4 v[160:163], v215, s[44:47], 0 offen sc1
    v_exp_f32 v112, v112
    v_exp_f32 v113, v113
    v_exp_f32 v114, v114
    v_exp_f32 v115, v115
    v_cvt_pk_bf16_f32 v144, v112, v113
    v_cvt_pk_bf16_f32 v145, v114, v115
    v_mfma_f32_32x32x16_bf16 v[64:79], v[180:183], v[148:151], v[64:79]
    buffer_load_dwordx4 v[164:167], v216, s[44:47], 0 offen sc1
    v_exp_f32 v116, v116
    v_exp_f32 v117, v117
    v_exp_f32 v118, v118
    v_exp_f32 v119, v119
    v_cvt_pk_bf16_f32 v146, v116, v117
    v_cvt_pk_bf16_f32 v147, v118, v119
    v_mfma_f32_32x32x16_bf16 v[128:143], v[172:175], v[44:47], v[128:143]
    v_exp_f32 v120, v120
    v_exp_f32 v121, v121
    v_exp_f32 v122, v122
    v_exp_f32 v123, v123
    v_cvt_pk_bf16_f32 v148, v120, v121
    v_cvt_pk_bf16_f32 v149, v122, v123
    v_mfma_f32_32x32x16_bf16 v[80:95], v[176:179], v[144:147], v[80:95]
    s_waitcnt vmcnt(16) lgkmcnt(0)
    v_exp_f32 v124, v124
    v_exp_f32 v125, v125
    v_exp_f32 v126, v126
    v_exp_f32_e64 v127, v127
    v_cvt_pk_bf16_f32 v150, v124, v125
    v_cvt_pk_bf16_f32 v151, v126, v127
    v_mfma_f32_32x32x16_bf16 v[112:127], v[184:187], v[16:19], 0
    s_add_u32 m0, s57, 12288
    ds_read_b64_tr_b16 a[32:33], v10 offset:0
    v_exp_f32 v128, v128
    v_exp_f32 v129, v129
    v_exp_f32 v130, v130
    v_exp_f32 v131, v131
    v_cvt_pk_bf16_f32 v144, v128, v129
    v_cvt_pk_bf16_f32 v145, v130, v131
    v_mfma_f32_32x32x16_bf16 v[80:95], v[180:183], v[148:151], v[80:95]
    s_add_u32 s16, s16, 114688
    ds_read_b64_tr_b16 a[34:35], v10 offset:512
    v_exp_f32 v132, v132
    v_exp_f32 v133, v133
    v_exp_f32 v134, v134
    v_exp_f32 v135, v135
    v_cvt_pk_bf16_f32 v146, v132, v133
    v_cvt_pk_bf16_f32 v147, v134, v135
    v_mfma_f32_32x32x16_bf16 v[112:127], v[188:191], v[20:23], v[112:127]
    s_addc_u32 s17, s17, 0
    ds_read_b64_tr_b16 a[36:37], v15 offset:0
    buffer_load_dwordx4 v200, s[16:19], 0 offen offset:0 lds
    v_exp_f32 v136, v136
    v_exp_f32 v137, v137
    v_exp_f32 v138, v138
    v_exp_f32_e64 v139, v139
    v_cvt_pk_bf16_f32 v148, v136, v137
    v_cvt_pk_bf16_f32 v149, v138, v139
    v_mfma_f32_32x32x16_bf16 v[96:111], v[176:179], v[144:147], v[96:111]
    ds_read_b64_tr_b16 a[38:39], v15 offset:512
    buffer_load_dwordx4 v201, s[16:19], 0 offen offset:1024 lds
    v_exp_f32 v140, v140
    v_exp_f32 v141, v141
    v_exp_f32 v142, v142
    v_exp_f32 v143, v143
    v_cvt_pk_bf16_f32 v150, v140, v141
    v_cvt_pk_bf16_f32 v151, v142, v143
    v_mfma_f32_32x32x16_bf16 v[128:143], v[184:187], v[24:27], 0
    ds_read_b64_tr_b16 a[40:41], v10 offset:256
    buffer_load_dwordx4 v202, s[16:19], 0 offen offset:2048 lds
    v_exp_f32 v112, v112
    v_exp_f32 v113, v113
    v_exp_f32 v114, v114
    v_exp_f32 v115, v115
    v_cvt_pk_bf16_f32 v144, v112, v113
    v_cvt_pk_bf16_f32 v145, v114, v115
    v_mfma_f32_32x32x16_bf16 v[96:111], v[180:183], v[148:151], v[96:111]
    ds_read_b64_tr_b16 a[42:43], v10 offset:768
    buffer_load_dwordx4 v203, s[16:19], 0 offen offset:3072 lds
    v_exp_f32 v116, v116
    v_exp_f32 v117, v117
    v_exp_f32 v118, v118
    v_exp_f32 v119, v119
    v_cvt_pk_bf16_f32 v146, v116, v117
    v_cvt_pk_bf16_f32 v147, v118, v119
    v_mfma_f32_32x32x16_bf16 v[128:143], v[188:191], v[28:31], v[128:143]
    s_xor_b32 s65, s70, 3670016
    ds_read_b64_tr_b16 a[44:45], v15 offset:256
    v_exp_f32 v120, v120
    v_exp_f32 v121, v121
    v_exp_f32 v122, v122
    v_exp_f32 v123, v123
    v_cvt_pk_bf16_f32 v148, v120, v121
    v_cvt_pk_bf16_f32 v149, v122, v123
    v_mfma_f32_32x32x16_bf16 v[48:63], v[192:195], v[144:147], v[48:63]
    s_add_u32 s44, s40, s65
    ds_read_b64_tr_b16 a[46:47], v15 offset:768
    v_exp_f32 v124, v124
    v_exp_f32 v125, v125
    v_exp_f32 v126, v126
    v_exp_f32_e64 v127, v127
    v_cvt_pk_bf16_f32 v150, v124, v125
    v_cvt_pk_bf16_f32 v151, v126, v127
    v_mfma_f32_32x32x16_bf16 v[112:127], v[184:187], v[32:35], 0
    s_addc_u32 s45, s41, 0
    v_exp_f32 v128, v128
    v_exp_f32 v129, v129
    v_exp_f32 v130, v130
    v_exp_f32_e64 v131, v131
    v_cvt_pk_bf16_f32 v144, v128, v129
    v_cvt_pk_bf16_f32 v145, v130, v131
    v_mfma_f32_32x32x16_bf16 v[48:63], v[196:199], v[148:151], v[48:63]
    buffer_load_dwordx4 v[168:171], v213, s[44:47], 0 offen offset:0 sc1
    v_exp_f32 v132, v132
    v_exp_f32 v133, v133
    v_exp_f32 v134, v134
    v_exp_f32 v135, v135
    v_cvt_pk_bf16_f32 v146, v132, v133
    v_cvt_pk_bf16_f32 v147, v134, v135
    v_mfma_f32_32x32x16_bf16 v[112:127], v[188:191], v[36:39], v[112:127]
    buffer_load_dwordx4 v[172:175], v213, s[44:47], 0 offen offset:1024 sc1
    v_exp_f32 v136, v136
    v_exp_f32 v137, v137
    v_exp_f32 v138, v138
    v_exp_f32 v139, v139
    v_cvt_pk_bf16_f32 v148, v136, v137
    v_cvt_pk_bf16_f32 v149, v138, v139
    v_mfma_f32_32x32x16_bf16 v[64:79], v[192:195], v[144:147], v[64:79]
    buffer_load_dwordx4 v[176:179], v215, s[44:47], 0 offen sc1
    v_exp_f32 v140, v140
    v_exp_f32 v141, v141
    v_exp_f32 v142, v142
    v_exp_f32 v143, v143
    v_cvt_pk_bf16_f32 v150, v140, v141
    v_cvt_pk_bf16_f32 v151, v142, v143
    v_mfma_f32_32x32x16_bf16 v[128:143], v[184:187], v[40:43], 0
    buffer_load_dwordx4 v[180:183], v216, s[44:47], 0 offen sc1
    v_exp_f32 v112, v112
    v_exp_f32 v113, v113
    v_exp_f32 v114, v114
    v_exp_f32 v115, v115
    v_cvt_pk_bf16_f32 v144, v112, v113
    v_cvt_pk_bf16_f32 v145, v114, v115
    v_mfma_f32_32x32x16_bf16 v[64:79], v[196:199], v[148:151], v[64:79]
    v_exp_f32 v116, v116
    v_exp_f32 v117, v117
    v_exp_f32 v118, v118
    v_exp_f32 v119, v119
    v_cvt_pk_bf16_f32 v146, v116, v117
    v_cvt_pk_bf16_f32 v147, v118, v119
    v_mfma_f32_32x32x16_bf16 v[128:143], v[188:191], v[44:47], v[128:143]
    v_exp_f32 v120, v120
    v_exp_f32 v121, v121
    v_exp_f32 v122, v122
    v_exp_f32 v123, v123
    v_cvt_pk_bf16_f32 v148, v120, v121
    v_cvt_pk_bf16_f32 v149, v122, v123
    v_mfma_f32_32x32x16_bf16 v[80:95], v[192:195], v[144:147], v[80:95]
    s_waitcnt vmcnt(12) lgkmcnt(0)
    v_exp_f32 v124, v124
    v_exp_f32 v125, v125
    v_exp_f32 v126, v126
    v_exp_f32_e64 v127, v127
    v_cvt_pk_bf16_f32 v150, v124, v125
    v_cvt_pk_bf16_f32 v151, v126, v127
    v_mfma_f32_32x32x16_bf16 v[112:127], v[240:243], v[16:19], 0
    s_add_u32 m0, s57, 16384
    ds_read_b64_tr_b16 a[48:49], v10 offset:4096
    ds_read_b64_tr_b16 a[50:51], v10 offset:4608
    v_exp_f32 v128, v128
    v_exp_f32 v129, v129
    v_exp_f32 v130, v130
    v_exp_f32 v131, v131
    v_cvt_pk_bf16_f32 v144, v128, v129
    v_cvt_pk_bf16_f32 v145, v130, v131
    v_mfma_f32_32x32x16_bf16 v[80:95], v[196:199], v[148:151], v[80:95]
    s_add_u32 s16, s16, 114688
    ds_read_b64_tr_b16 a[52:53], v15 offset:4096
    ds_read_b64_tr_b16 a[54:55], v15 offset:4608
    v_exp_f32 v132, v132
    v_exp_f32 v133, v133
    v_exp_f32 v134, v134
    v_exp_f32 v135, v135
    v_cvt_pk_bf16_f32 v146, v132, v133
    v_cvt_pk_bf16_f32 v147, v134, v135
    v_mfma_f32_32x32x16_bf16 v[112:127], v[244:247], v[20:23], v[112:127]
    s_addc_u32 s17, s17, 0
    ds_read_b64_tr_b16 a[56:57], v10 offset:4352
    ds_read_b64_tr_b16 a[58:59], v10 offset:4864
    buffer_load_dwordx4 v200, s[16:19], 0 offen offset:0 lds
    v_exp_f32 v136, v136
    v_exp_f32 v137, v137
    v_exp_f32 v138, v138
    v_exp_f32_e64 v139, v139
    v_cvt_pk_bf16_f32 v148, v136, v137
    v_cvt_pk_bf16_f32 v149, v138, v139
    v_mfma_f32_32x32x16_bf16 v[96:111], v[192:195], v[144:147], v[96:111]
    ds_read_b64_tr_b16 a[60:61], v15 offset:4352
    buffer_load_dwordx4 v201, s[16:19], 0 offen offset:1024 lds
    v_exp_f32 v140, v140
    v_exp_f32 v141, v141
    v_exp_f32 v142, v142
    v_exp_f32 v143, v143
    v_cvt_pk_bf16_f32 v150, v140, v141
    v_cvt_pk_bf16_f32 v151, v142, v143
    v_mfma_f32_32x32x16_bf16 v[128:143], v[240:243], v[24:27], 0
    ds_read_b64_tr_b16 a[62:63], v15 offset:4864
    buffer_load_dwordx4 v202, s[16:19], 0 offen offset:2048 lds
    v_exp_f32 v112, v112
    v_exp_f32 v113, v113
    v_exp_f32 v114, v114
    v_exp_f32 v115, v115
    v_cvt_pk_bf16_f32 v144, v112, v113
    v_cvt_pk_bf16_f32 v145, v114, v115
    v_mfma_f32_32x32x16_bf16 v[96:111], v[196:199], v[148:151], v[96:111]
    ds_read_b64_tr_b16 a[64:65], v10 offset:8192
    buffer_load_dwordx4 v203, s[16:19], 0 offen offset:3072 lds
    v_exp_f32 v116, v116
    v_exp_f32 v117, v117
    v_exp_f32 v118, v118
    v_exp_f32 v119, v119
    v_cvt_pk_bf16_f32 v146, v116, v117
    v_cvt_pk_bf16_f32 v147, v118, v119
    v_mfma_f32_32x32x16_bf16 v[128:143], v[244:247], v[28:31], v[128:143]
    s_xor_b32 s65, s70, 3932160
    ds_read_b64_tr_b16 a[66:67], v10 offset:8704
    v_exp_f32 v120, v120
    v_exp_f32 v121, v121
    v_exp_f32 v122, v122
    v_exp_f32 v123, v123
    v_cvt_pk_bf16_f32 v148, v120, v121
    v_cvt_pk_bf16_f32 v149, v122, v123
    v_mfma_f32_32x32x16_bf16 v[48:63], v[248:251], v[144:147], v[48:63]
    s_add_u32 s44, s40, s65
    ds_read_b64_tr_b16 a[68:69], v15 offset:8192
    v_exp_f32 v124, v124
    v_exp_f32 v125, v125
    v_exp_f32 v126, v126
    v_exp_f32_e64 v127, v127
    v_cvt_pk_bf16_f32 v150, v124, v125
    v_cvt_pk_bf16_f32 v151, v126, v127
    v_mfma_f32_32x32x16_bf16 v[112:127], v[240:243], v[32:35], 0
    s_addc_u32 s45, s41, 0
    ds_read_b64_tr_b16 a[70:71], v15 offset:8704
    buffer_load_dwordx4 v[184:187], v213, s[44:47], 0 offen offset:0 sc1
    v_exp_f32 v128, v128
    v_exp_f32 v129, v129
    v_exp_f32 v130, v130
    v_exp_f32_e64 v131, v131
    v_cvt_pk_bf16_f32 v144, v128, v129
    v_cvt_pk_bf16_f32 v145, v130, v131
    v_mfma_f32_32x32x16_bf16 v[48:63], v[252:255], v[148:151], v[48:63]
    ds_read_b64_tr_b16 a[72:73], v10 offset:8448
    buffer_load_dwordx4 v[188:191], v213, s[44:47], 0 offen offset:1024 sc1
    v_exp_f32 v132, v132
    v_exp_f32 v133, v133
    v_exp_f32 v134, v134
    v_exp_f32 v135, v135
    v_cvt_pk_bf16_f32 v146, v132, v133
    v_cvt_pk_bf16_f32 v147, v134, v135
    v_mfma_f32_32x32x16_bf16 v[112:127], v[244:247], v[36:39], v[112:127]
    ds_read_b64_tr_b16 a[74:75], v10 offset:8960
    buffer_load_dwordx4 v[192:195], v215, s[44:47], 0 offen sc1
    v_exp_f32 v136, v136
    v_exp_f32 v137, v137
    v_exp_f32 v138, v138
    v_exp_f32 v139, v139
    v_cvt_pk_bf16_f32 v148, v136, v137
    v_cvt_pk_bf16_f32 v149, v138, v139
    v_mfma_f32_32x32x16_bf16 v[64:79], v[248:251], v[144:147], v[64:79]
    ds_read_b64_tr_b16 a[76:77], v15 offset:8448
    buffer_load_dwordx4 v[196:199], v216, s[44:47], 0 offen sc1
    v_exp_f32 v140, v140
    v_exp_f32 v141, v141
    v_exp_f32 v142, v142
    v_exp_f32 v143, v143
    v_cvt_pk_bf16_f32 v150, v140, v141
    v_cvt_pk_bf16_f32 v151, v142, v143
    v_mfma_f32_32x32x16_bf16 v[128:143], v[240:243], v[40:43], 0
L_ws1_1:
    s_cbranch_execz L_ws1_5
    ds_read_b64_tr_b16 a[78:79], v15 offset:8960
    v_exp_f32 v112, v112
    v_exp_f32 v113, v113
    v_exp_f32 v114, v114
    v_exp_f32_e64 v115, v115
    v_cvt_pk_bf16_f32 v144, v112, v113
    v_cvt_pk_bf16_f32 v145, v114, v115
    v_mfma_f32_32x32x16_bf16 v[64:79], v[252:255], v[148:151], v[64:79]
    v_exp_f32 v116, v116
    v_exp_f32 v117, v117
    v_exp_f32 v118, v118
    v_exp_f32 v119, v119
    v_cvt_pk_bf16_f32 v146, v116, v117
    v_cvt_pk_bf16_f32 v147, v118, v119
    v_mfma_f32_32x32x16_bf16 v[128:143], v[244:247], v[44:47], v[128:143]
    v_exp_f32 v120, v120
    v_exp_f32 v121, v121
    v_exp_f32 v122, v122
    v_exp_f32 v123, v123
    v_cvt_pk_bf16_f32 v148, v120, v121
    v_cvt_pk_bf16_f32 v149, v122, v123
    v_mfma_f32_32x32x16_bf16 v[80:95], v[248:251], v[144:147], v[80:95]
    s_waitcnt vmcnt(12) lgkmcnt(0)
    v_exp_f32 v124, v124
    v_exp_f32 v125, v125
    v_exp_f32 v126, v126
    v_exp_f32_e64 v127, v127
    v_cvt_pk_bf16_f32 v150, v124, v125
    v_cvt_pk_bf16_f32 v151, v126, v127
    v_mfma_f32_32x32x16_bf16 v[112:127], v[152:155], v[16:19], 0
    s_add_u32 m0, s57, 20480
    ds_read_b64_tr_b16 a[80:81], v10 offset:12288
    v_exp_f32 v128, v128
    v_exp_f32 v129, v129
    v_exp_f32 v130, v130
    v_exp_f32 v131, v131
    v_cvt_pk_bf16_f32 v144, v128, v129
    v_cvt_pk_bf16_f32 v145, v130, v131
    v_mfma_f32_32x32x16_bf16 v[80:95], v[252:255], v[148:151], v[80:95]
    s_add_u32 s16, s16, 114688
    ds_read_b64_tr_b16 a[82:83], v10 offset:12800
    v_exp_f32 v132, v132
    v_exp_f32 v133, v133
    v_exp_f32 v134, v134
    v_exp_f32 v135, v135
    v_cvt_pk_bf16_f32 v146, v132, v133
    v_cvt_pk_bf16_f32 v147, v134, v135
    v_mfma_f32_32x32x16_bf16 v[112:127], v[156:159], v[20:23], v[112:127]
    s_addc_u32 s17, s17, 0
    ds_read_b64_tr_b16 a[84:85], v15 offset:12288
    buffer_load_dwordx4 v200, s[16:19], 0 offen offset:0 lds
    buffer_load_dwordx4 v201, s[16:19], 0 offen offset:1024 lds
    v_exp_f32 v136, v136
    v_exp_f32 v137, v137
    v_exp_f32 v138, v138
    v_exp_f32_e64 v139, v139
    v_cvt_pk_bf16_f32 v148, v136, v137
    v_cvt_pk_bf16_f32 v149, v138, v139
    v_mfma_f32_32x32x16_bf16 v[96:111], v[248:251], v[144:147], v[96:111]
    ds_read_b64_tr_b16 a[86:87], v15 offset:12800
    buffer_load_dwordx4 v202, s[16:19], 0 offen offset:2048 lds
    buffer_load_dwordx4 v203, s[16:19], 0 offen offset:3072 lds
    v_exp_f32 v140, v140
    v_exp_f32 v141, v141
    v_exp_f32 v142, v142
    v_exp_f32 v143, v143
    v_cvt_pk_bf16_f32 v150, v140, v141
    v_cvt_pk_bf16_f32 v151, v142, v143
    v_mfma_f32_32x32x16_bf16 v[128:143], v[152:155], v[24:27], 0
    s_add_u32 m0, s57, 0
    ds_read_b64_tr_b16 a[88:89], v10 offset:12544
    v_exp_f32 v112, v112
    v_exp_f32 v113, v113
    v_exp_f32 v114, v114
    v_exp_f32_e64 v115, v115
    v_cvt_pk_bf16_f32 v144, v112, v113
    v_cvt_pk_bf16_f32 v145, v114, v115
    v_mfma_f32_32x32x16_bf16 v[96:111], v[252:255], v[148:151], v[96:111]
    s_add_u32 s16, s16, 114688
    ds_read_b64_tr_b16 a[90:91], v10 offset:13056
    v_exp_f32 v116, v116
    v_exp_f32 v117, v117
    v_exp_f32 v118, v118
    v_exp_f32 v119, v119
    v_cvt_pk_bf16_f32 v146, v116, v117
    v_cvt_pk_bf16_f32 v147, v118, v119
    v_mfma_f32_32x32x16_bf16 v[128:143], v[156:159], v[28:31], v[128:143]
    s_addc_u32 s17, s17, 0
    ds_read_b64_tr_b16 a[92:93], v15 offset:12544
    buffer_load_dwordx4 v200, s[16:19], 0 offen offset:0 lds
    buffer_load_dwordx4 v201, s[16:19], 0 offen offset:1024 lds
    v_exp_f32 v120, v120
    v_exp_f32 v121, v121
    v_exp_f32 v122, v122
    v_exp_f32_e64 v123, v123
    v_cvt_pk_bf16_f32 v148, v120, v121
    v_cvt_pk_bf16_f32 v149, v122, v123
    v_mfma_f32_32x32x16_bf16 v[48:63], v[160:163], v[144:147], v[48:63]
    ds_read_b64_tr_b16 a[94:95], v15 offset:13056
    buffer_load_dwordx4 v202, s[16:19], 0 offen offset:2048 lds
    buffer_load_dwordx4 v203, s[16:19], 0 offen offset:3072 lds
    v_exp_f32 v124, v124
    v_exp_f32 v125, v125
    v_exp_f32 v126, v126
    v_exp_f32 v127, v127
    v_cvt_pk_bf16_f32 v150, v124, v125
    v_cvt_pk_bf16_f32 v151, v126, v127
    v_mfma_f32_32x32x16_bf16 v[112:127], v[152:155], v[32:35], 0
    s_add_u32 m0, s57, 4096
    v_exp_f32 v128, v128
    v_exp_f32 v129, v129
    v_exp_f32 v130, v130
    v_exp_f32 v131, v131
    v_cvt_pk_bf16_f32 v144, v128, v129
    v_cvt_pk_bf16_f32 v145, v130, v131
    v_mfma_f32_32x32x16_bf16 v[48:63], v[164:167], v[148:151], v[48:63]
    s_add_u32 s16, s16, 114688
    v_exp_f32 v132, v132
    v_exp_f32 v133, v133
    v_exp_f32 v134, v134
    v_exp_f32 v135, v135
    v_cvt_pk_bf16_f32 v146, v132, v133
    v_cvt_pk_bf16_f32 v147, v134, v135
    v_mfma_f32_32x32x16_bf16 v[112:127], v[156:159], v[36:39], v[112:127]
    s_addc_u32 s17, s17, 0
    v_exp_f32 v136, v136
    v_exp_f32 v137, v137
    v_exp_f32 v138, v138
    v_exp_f32_e64 v139, v139
    v_cvt_pk_bf16_f32 v148, v136, v137
    v_cvt_pk_bf16_f32 v149, v138, v139
    v_mfma_f32_32x32x16_bf16 v[64:79], v[160:163], v[144:147], v[64:79]
    buffer_load_dwordx4 v200, s[16:19], 0 offen offset:0 lds
    v_exp_f32 v140, v140
    v_exp_f32 v141, v141
    v_exp_f32 v142, v142
    v_exp_f32 v143, v143
    v_cvt_pk_bf16_f32 v150, v140, v141
    v_cvt_pk_bf16_f32 v151, v142, v143
    v_mfma_f32_32x32x16_bf16 v[128:143], v[152:155], v[40:43], 0
    buffer_load_dwordx4 v201, s[16:19], 0 offen offset:1024 lds
    v_exp_f32 v112, v112
    v_exp_f32 v113, v113
    v_exp_f32 v114, v114
    v_exp_f32 v115, v115
    v_cvt_pk_bf16_f32 v144, v112, v113
    v_cvt_pk_bf16_f32 v145, v114, v115
    v_mfma_f32_32x32x16_bf16 v[64:79], v[164:167], v[148:151], v[64:79]
    buffer_load_dwordx4 v202, s[16:19], 0 offen offset:2048 lds
    v_exp_f32 v116, v116
    v_exp_f32 v117, v117
    v_exp_f32 v118, v118
    v_exp_f32 v119, v119
    v_cvt_pk_bf16_f32 v146, v116, v117
    v_cvt_pk_bf16_f32 v147, v118, v119
    v_mfma_f32_32x32x16_bf16 v[128:143], v[156:159], v[44:47], v[128:143]
    buffer_load_dwordx4 v203, s[16:19], 0 offen offset:3072 lds
    v_exp_f32 v120, v120
    v_exp_f32 v121, v121
    v_exp_f32 v122, v122
    v_exp_f32 v123, v123
    v_cvt_pk_bf16_f32 v148, v120, v121
    v_cvt_pk_bf16_f32 v149, v122, v123
    v_mfma_f32_32x32x16_bf16 v[80:95], v[160:163], v[144:147], v[80:95]
    s_waitcnt vmcnt(20) lgkmcnt(0)
    v_exp_f32 v124, v124
    v_exp_f32 v125, v125
    v_exp_f32 v126, v126
    v_exp_f32_e64 v127, v127
    v_cvt_pk_bf16_f32 v150, v124, v125
    v_cvt_pk_bf16_f32 v151, v126, v127
    v_mfma_f32_32x32x16_bf16 v[112:127], v[168:171], v[16:19], 0
    s_add_u32 m0, s57, 8192
    v_exp_f32 v128, v128
    v_exp_f32 v129, v129
    v_exp_f32 v130, v130
    v_exp_f32 v131, v131
    v_cvt_pk_bf16_f32 v144, v128, v129
    v_cvt_pk_bf16_f32 v145, v130, v131
    v_mfma_f32_32x32x16_bf16 v[80:95], v[164:167], v[148:151], v[80:95]
    s_add_u32 s16, s16, 114688
    v_exp_f32 v132, v132
    v_exp_f32 v133, v133
    v_exp_f32 v134, v134
    v_exp_f32 v135, v135
    v_cvt_pk_bf16_f32 v146, v132, v133
    v_cvt_pk_bf16_f32 v147, v134, v135
    v_mfma_f32_32x32x16_bf16 v[112:127], v[172:175], v[20:23], v[112:127]
    s_addc_u32 s17, s17, 0
    v_exp_f32 v136, v136
    v_exp_f32 v137, v137
    v_exp_f32 v138, v138
    v_exp_f32_e64 v139, v139
    v_cvt_pk_bf16_f32 v148, v136, v137
    v_cvt_pk_bf16_f32 v149, v138, v139
    v_mfma_f32_32x32x16_bf16 v[96:111], v[160:163], v[144:147], v[96:111]
    buffer_load_dwordx4 v200, s[16:19], 0 offen offset:0 lds
    buffer_load_dwordx4 v201, s[16:19], 0 offen offset:1024 lds
    v_exp_f32 v140, v140
    v_exp_f32 v141, v141
    v_exp_f32 v142, v142
    v_exp_f32 v143, v143
    v_cvt_pk_bf16_f32 v150, v140, v141
    v_cvt_pk_bf16_f32 v151, v142, v143
    v_mfma_f32_32x32x16_bf16 v[128:143], v[168:171], v[24:27], 0
    buffer_load_dwordx4 v202, s[16:19], 0 offen offset:2048 lds
    v_exp_f32 v112, v112
    v_exp_f32 v113, v113
    v_exp_f32 v114, v114
    v_exp_f32 v115, v115
    v_cvt_pk_bf16_f32 v144, v112, v113
    v_cvt_pk_bf16_f32 v145, v114, v115
    v_mfma_f32_32x32x16_bf16 v[96:111], v[164:167], v[148:151], v[96:111]
    buffer_load_dwordx4 v203, s[16:19], 0 offen offset:3072 lds
    v_exp_f32 v116, v116
    v_exp_f32 v117, v117
    v_exp_f32 v118, v118
    v_exp_f32 v119, v119
    v_cvt_pk_bf16_f32 v146, v116, v117
    v_cvt_pk_bf16_f32 v147, v118, v119
    v_mfma_f32_32x32x16_bf16 v[128:143], v[172:175], v[28:31], v[128:143]
    s_add_u32 m0, s57, 12288
    v_exp_f32 v120, v120
    v_exp_f32 v121, v121
    v_exp_f32 v122, v122
    v_exp_f32 v123, v123
    v_cvt_pk_bf16_f32 v148, v120, v121
    v_cvt_pk_bf16_f32 v149, v122, v123
    v_mfma_f32_32x32x16_bf16 v[48:63], v[176:179], v[144:147], v[48:63]
    s_add_u32 s16, s16, 114688
    v_exp_f32 v124, v124
    v_exp_f32 v125, v125
    v_exp_f32 v126, v126
    v_exp_f32 v127, v127
    v_cvt_pk_bf16_f32 v150, v124, v125
    v_cvt_pk_bf16_f32 v151, v126, v127
    v_mfma_f32_32x32x16_bf16 v[112:127], v[168:171], v[32:35], 0
    s_addc_u32 s17, s17, 0
    v_exp_f32 v128, v128
    v_exp_f32 v129, v129
    v_exp_f32 v130, v130
    v_exp_f32_e64 v131, v131
    v_cvt_pk_bf16_f32 v144, v128, v129
    v_cvt_pk_bf16_f32 v145, v130, v131
    v_mfma_f32_32x32x16_bf16 v[48:63], v[180:183], v[148:151], v[48:63]
    buffer_load_dwordx4 v200, s[16:19], 0 offen offset:0 lds
    v_exp_f32 v132, v132
    v_exp_f32 v133, v133
    v_exp_f32 v134, v134
    v_exp_f32 v135, v135
    v_cvt_pk_bf16_f32 v146, v132, v133
    v_cvt_pk_bf16_f32 v147, v134, v135
    v_mfma_f32_32x32x16_bf16 v[112:127], v[172:175], v[36:39], v[112:127]
    buffer_load_dwordx4 v201, s[16:19], 0 offen offset:1024 lds
    v_exp_f32 v136, v136
    v_exp_f32 v137, v137
    v_exp_f32 v138, v138
    v_exp_f32 v139, v139
    v_cvt_pk_bf16_f32 v148, v136, v137
    v_cvt_pk_bf16_f32 v149, v138, v139
    v_mfma_f32_32x32x16_bf16 v[64:79], v[176:179], v[144:147], v[64:79]
    buffer_load_dwordx4 v202, s[16:19], 0 offen offset:2048 lds
    v_exp_f32 v140, v140
    v_exp_f32 v141, v141
    v_exp_f32 v142, v142
    v_exp_f32 v143, v143
    v_cvt_pk_bf16_f32 v150, v140, v141
    v_cvt_pk_bf16_f32 v151, v142, v143
    v_mfma_f32_32x32x16_bf16 v[128:143], v[168:171], v[40:43], 0
    buffer_load_dwordx4 v203, s[16:19], 0 offen offset:3072 lds
    v_exp_f32 v112, v112
    v_exp_f32 v113, v113
    v_exp_f32 v114, v114
    v_exp_f32 v115, v115
    v_cvt_pk_bf16_f32 v144, v112, v113
    v_cvt_pk_bf16_f32 v145, v114, v115
    v_mfma_f32_32x32x16_bf16 v[64:79], v[180:183], v[148:151], v[64:79]
    buffer_load_dwordx2 v[224:225], v208, s[28:31], s61 offen offset:0
    v_exp_f32 v116, v116
    v_exp_f32 v117, v117
    v_exp_f32 v118, v118
    v_exp_f32 v119, v119
    v_cvt_pk_bf16_f32 v146, v116, v117
    v_cvt_pk_bf16_f32 v147, v118, v119
    v_mfma_f32_32x32x16_bf16 v[128:143], v[172:175], v[44:47], v[128:143]
    buffer_load_ushort v11, v209, s[32:35], s62 offen
    v_exp_f32 v120, v120
    v_exp_f32 v121, v121
    v_exp_f32 v122, v122
    v_exp_f32 v123, v123
    v_cvt_pk_bf16_f32 v148, v120, v121
    v_cvt_pk_bf16_f32 v149, v122, v123
    v_mfma_f32_32x32x16_bf16 v[80:95], v[176:179], v[144:147], v[80:95]
    s_waitcnt vmcnt(22)
    v_exp_f32 v124, v124
    v_exp_f32 v125, v125
    v_exp_f32 v126, v126
    v_exp_f32_e64 v127, v127
    v_cvt_pk_bf16_f32 v150, v124, v125
    v_cvt_pk_bf16_f32 v151, v126, v127
    v_mfma_f32_32x32x16_bf16 v[112:127], v[184:187], v[16:19], 0
    buffer_store_dword v218, v214, s[40:43], s60 offen sc1
    v_exp_f32 v128, v128
    v_exp_f32 v129, v129
    v_exp_f32 v130, v130
    v_exp_f32 v131, v131
    v_cvt_pk_bf16_f32 v144, v128, v129
    v_cvt_pk_bf16_f32 v145, v130, v131
    v_mfma_f32_32x32x16_bf16 v[80:95], v[180:183], v[148:151], v[80:95]
    buffer_load_dwordx2 v[232:233], v207, s[4:7], s73 offen offset:0
    v_exp_f32 v132, v132
    v_exp_f32 v133, v133
    v_exp_f32 v134, v134
    v_exp_f32 v135, v135
    v_cvt_pk_bf16_f32 v146, v132, v133
    v_cvt_pk_bf16_f32 v147, v134, v135
    v_mfma_f32_32x32x16_bf16 v[112:127], v[188:191], v[20:23], v[112:127]
    buffer_load_dwordx2 v[234:235], v207, s[4:7], s73 offen offset:16
    v_exp_f32 v136, v136
    v_exp_f32 v137, v137
    v_exp_f32 v138, v138
    v_exp_f32 v139, v139
    v_cvt_pk_bf16_f32 v148, v136, v137
    v_cvt_pk_bf16_f32 v149, v138, v139
    v_mfma_f32_32x32x16_bf16 v[96:111], v[176:179], v[144:147], v[96:111]
    buffer_load_dwordx2 v[236:237], v207, s[4:7], s73 offen offset:32
    v_exp_f32 v140, v140
    v_exp_f32 v141, v141
    v_exp_f32 v142, v142
    v_exp_f32 v143, v143
    v_cvt_pk_bf16_f32 v150, v140, v141
    v_cvt_pk_bf16_f32 v151, v142, v143
    v_mfma_f32_32x32x16_bf16 v[128:143], v[184:187], v[24:27], 0
    buffer_load_dwordx2 v[238:239], v207, s[4:7], s73 offen offset:48
    v_exp_f32 v112, v112
    v_exp_f32 v113, v113
    v_exp_f32 v114, v114
    v_exp_f32 v115, v115
    v_cvt_pk_bf16_f32 v144, v112, v113
    v_cvt_pk_bf16_f32 v145, v114, v115
    v_mfma_f32_32x32x16_bf16 v[96:111], v[180:183], v[148:151], v[96:111]
    s_mov_b32 s67, 0
    v_exp_f32 v116, v116
    v_exp_f32 v117, v117
    v_exp_f32 v118, v118
    v_exp_f32_e64 v119, v119
    v_cvt_pk_bf16_f32 v146, v116, v117
    v_cvt_pk_bf16_f32 v147, v118, v119
    v_mfma_f32_32x32x16_bf16 v[128:143], v[188:191], v[28:31], v[128:143]
    buffer_load_dword v211, v204, s[20:23], s67 offen
    v_exp_f32 v120, v120
    v_exp_f32 v121, v121
    v_exp_f32 v122, v122
    v_exp_f32 v123, v123
    v_cvt_pk_bf16_f32 v148, v120, v121
    v_cvt_pk_bf16_f32 v149, v122, v123
    v_mfma_f32_32x32x16_bf16 v[48:63], v[192:195], v[144:147], v[48:63]
    v_exp_f32 v124, v124
    v_exp_f32 v125, v125
    v_exp_f32 v126, v126
    v_exp_f32 v127, v127
    v_cvt_pk_bf16_f32 v150, v124, v125
    v_cvt_pk_bf16_f32 v151, v126, v127
    v_mfma_f32_32x32x16_bf16 v[112:127], v[184:187], v[32:35], 0
    v_exp_f32 v128, v128
    v_exp_f32 v129, v129
    v_exp_f32 v130, v130
    v_exp_f32 v131, v131
    v_cvt_pk_bf16_f32 v144, v128, v129
    v_cvt_pk_bf16_f32 v145, v130, v131
    v_mfma_f32_32x32x16_bf16 v[48:63], v[196:199], v[148:151], v[48:63]
    v_exp_f32 v132, v132
    v_exp_f32 v133, v133
    v_exp_f32 v134, v134
    v_exp_f32 v135, v135
    v_cvt_pk_bf16_f32 v146, v132, v133
    v_cvt_pk_bf16_f32 v147, v134, v135
    v_mfma_f32_32x32x16_bf16 v[112:127], v[188:191], v[36:39], v[112:127]
    v_exp_f32 v136, v136
    v_exp_f32 v137, v137
    v_exp_f32 v138, v138
    v_exp_f32 v139, v139
    v_cvt_pk_bf16_f32 v148, v136, v137
    v_cvt_pk_bf16_f32 v149, v138, v139
    v_mfma_f32_32x32x16_bf16 v[64:79], v[192:195], v[144:147], v[64:79]
    ds_write_b128 v8, v[48:51] offset:0
    v_exp_f32 v140, v140
    v_exp_f32 v141, v141
    v_exp_f32 v142, v142
    v_exp_f32 v143, v143
    v_cvt_pk_bf16_f32 v150, v140, v141
    v_cvt_pk_bf16_f32 v151, v142, v143
    v_mfma_f32_32x32x16_bf16 v[128:143], v[184:187], v[40:43], 0
    ds_write_b128 v8, v[52:55] offset:1024
    v_exp_f32 v112, v112
    v_exp_f32 v113, v113
    v_exp_f32 v114, v114
    v_exp_f32 v115, v115
    v_cvt_pk_bf16_f32 v144, v112, v113
    v_cvt_pk_bf16_f32 v145, v114, v115
    v_mfma_f32_32x32x16_bf16 v[64:79], v[196:199], v[148:151], v[64:79]
    ds_write_b128 v8, v[56:59] offset:2048
    v_exp_f32 v116, v116
    v_exp_f32 v117, v117
    v_exp_f32 v118, v118
    v_exp_f32 v119, v119
    v_cvt_pk_bf16_f32 v146, v116, v117
    v_cvt_pk_bf16_f32 v147, v118, v119
    v_mfma_f32_32x32x16_bf16 v[128:143], v[188:191], v[44:47], v[128:143]
    ds_write_b128 v8, v[60:63] offset:3072
    v_exp_f32 v120, v120
    v_exp_f32 v121, v121
    v_exp_f32 v122, v122
    v_exp_f32 v123, v123
    v_cvt_pk_bf16_f32 v148, v120, v121
    v_cvt_pk_bf16_f32 v149, v122, v123
    v_mfma_f32_32x32x16_bf16 v[80:95], v[192:195], v[144:147], v[80:95]
    ds_write_b128 v7, v[64:67] offset:0
    ds_write_b128 v7, v[68:71] offset:1024
    v_exp_f32 v124, v124
    v_exp_f32 v125, v125
    v_exp_f32 v126, v126
    v_exp_f32 v127, v127
    v_cvt_pk_bf16_f32 v150, v124, v125
    v_cvt_pk_bf16_f32 v151, v126, v127
    v_exp_f32 v128, v128
    v_exp_f32 v129, v129
    v_exp_f32 v130, v130
    v_exp_f32 v131, v131
    v_cvt_pk_bf16_f32 v144, v128, v129
    v_cvt_pk_bf16_f32 v145, v130, v131
    v_mfma_f32_32x32x16_bf16 v[80:95], v[196:199], v[148:151], v[80:95]
    ds_write_b128 v7, v[72:75] offset:2048
    ds_write_b128 v7, v[76:79] offset:3072
    v_exp_f32 v132, v132
    v_exp_f32 v133, v133
    v_exp_f32 v134, v134
    v_exp_f32 v135, v135
    v_cvt_pk_bf16_f32 v146, v132, v133
    v_cvt_pk_bf16_f32 v147, v134, v135
    v_exp_f32 v136, v136
    v_exp_f32 v137, v137
    v_exp_f32 v138, v138
    v_exp_f32 v139, v139
    v_cvt_pk_bf16_f32 v148, v136, v137
    v_cvt_pk_bf16_f32 v149, v138, v139
    v_mfma_f32_32x32x16_bf16 v[96:111], v[192:195], v[144:147], v[96:111]
    ds_write_b128 v6, v[80:83] offset:0
    ds_write_b128 v6, v[84:87] offset:1024
    ds_write_b128 v6, v[88:91] offset:2048
    ds_write_b128 v6, v[92:95] offset:3072
    v_exp_f32 v140, v140
    v_exp_f32 v141, v141
    v_exp_f32 v142, v142
    v_exp_f32 v143, v143
    v_cvt_pk_bf16_f32 v150, v140, v141
    v_cvt_pk_bf16_f32 v151, v142, v143
    s_nop 1
    v_mfma_f32_32x32x16_bf16 v[96:111], v[196:199], v[148:151], v[96:111]
L_red:
    s_waitcnt lgkmcnt(0)
    s_barrier
    ds_read_b128 v[252:255], v9 offset:11264
    ds_read_b128 v[180:183], v9 offset:7168
    ds_read_b128 v[164:167], v9 offset:3072
    ds_read_b128 v[248:251], v9 offset:10240
    ds_read_b128 v[176:179], v9 offset:6144
    ds_read_b128 v[160:163], v9 offset:2048
    ds_read_b128 v[244:247], v9 offset:9216
    ds_read_b128 v[172:175], v9 offset:5120
    ds_read_b128 v[156:159], v9 offset:1024
    ds_read_b128 v[240:243], v9 offset:8192
    ds_read_b128 v[168:171], v9 offset:4096
    ds_read_b128 v[152:155], v9 offset:0
    s_waitcnt lgkmcnt(9)
    v_pk_add_f32 v[108:109], v[108:109], v[252:253]
    v_pk_add_f32 v[110:111], v[110:111], v[254:255]
    v_pk_add_f32 v[108:109], v[108:109], v[180:181]
    v_pk_add_f32 v[110:111], v[110:111], v[182:183]
    v_pk_add_f32 v[108:109], v[108:109], v[164:165]
    v_pk_add_f32 v[110:111], v[110:111], v[166:167]
    v_mov_b32_e64 v4, v108
    v_mov_b32 v14, v108
    s_waitcnt lgkmcnt(6)
    v_pk_add_f32 v[104:105], v[104:105], v[248:249]
    v_pk_add_f32 v[106:107], v[106:107], v[250:251]
    v_permlane32_swap_b32 v4, v14
    v_rcp_f32 v4, v14
    v_pk_add_f32 v[104:105], v[104:105], v[176:177]
    v_pk_add_f32 v[106:107], v[106:107], v[178:179]
    v_pk_add_f32 v[104:105], v[104:105], v[160:161]
    v_pk_add_f32 v[106:107], v[106:107], v[162:163]
    v_and_b32_e64 v5, v4, v219
    v_pk_mul_f32 v[104:105], v[104:105], v[4:5] op_sel_hi:[1,0]
    v_pk_mul_f32 v[106:107], v[106:107], v[4:5] op_sel_hi:[1,0]
    v_pk_mul_f32 v[108:109], v[108:109], v[4:5] op_sel:[0,1]
    v_pk_mul_f32 v[110:111], v[110:111], v[4:5] op_sel:[0,1]
    v_cvt_pk_bf16_f32 v52, v104, v105
    v_cvt_pk_bf16_f32 v53, v106, v107
    v_cvt_pk_bf16_f32 v54, v108, v109
    v_cvt_pk_bf16_f32 v55, v110, v111
    buffer_store_dwordx4 v[52:55], v1, s[40:43], s59 offen offset:1024 sc1
    s_waitcnt lgkmcnt(3)
    v_pk_add_f32 v[100:101], v[100:101], v[244:245]
    v_pk_add_f32 v[102:103], v[102:103], v[246:247]
    v_pk_add_f32 v[100:101], v[100:101], v[172:173]
    v_pk_add_f32 v[102:103], v[102:103], v[174:175]
    v_pk_add_f32 v[100:101], v[100:101], v[156:157]
    v_pk_add_f32 v[102:103], v[102:103], v[158:159]
    s_waitcnt lgkmcnt(0)
    v_pk_add_f32 v[96:97], v[96:97], v[240:241]
    v_pk_add_f32 v[98:99], v[98:99], v[242:243]
    v_pk_add_f32 v[96:97], v[96:97], v[168:169]
    v_pk_add_f32 v[98:99], v[98:99], v[170:171]
    v_pk_add_f32 v[96:97], v[96:97], v[152:153]
    v_pk_add_f32 v[98:99], v[98:99], v[154:155]
    v_pk_mul_f32 v[96:97], v[96:97], v[4:5] op_sel_hi:[1,0]
    v_pk_mul_f32 v[98:99], v[98:99], v[4:5] op_sel_hi:[1,0]
    v_pk_mul_f32 v[100:101], v[100:101], v[4:5] op_sel_hi:[1,0]
    v_pk_mul_f32 v[102:103], v[102:103], v[4:5] op_sel_hi:[1,0]
    v_cvt_pk_bf16_f32 v48, v96, v97
    v_cvt_pk_bf16_f32 v49, v98, v99
    v_cvt_pk_bf16_f32 v50, v100, v101
    v_cvt_pk_bf16_f32 v51, v102, v103
    buffer_store_dwordx4 v[48:51], v1, s[40:43], s59 offen offset:0 sc1
    v_subrev_u32 v5, 0x2b800000, v14
    v_cmp_le_u32 vcc, 0x28000000, v5
    v_mov_b32 v13, 156160
    s_cbranch_vccnz L_rare_18
L_back_19:
    s_waitcnt lgkmcnt(0)
    s_barrier
    ds_read_b32 v5, v13
    s_waitcnt lgkmcnt(0)
    v_cmp_gt_u32 vcc, v5, s55
    s_cbranch_vccnz L_slow
    ds_read_b64_tr_b16 a[96:97], v10 offset:16384
    ds_read_b64_tr_b16 a[98:99], v10 offset:16896
    ds_read_b64_tr_b16 a[100:101], v15 offset:16384
    ds_read_b64_tr_b16 a[102:103], v15 offset:16896
    ds_read_b64_tr_b16 a[104:105], v10 offset:16640
    ds_read_b64_tr_b16 a[106:107], v10 offset:17152
    ds_read_b64_tr_b16 a[108:109], v15 offset:16640
    ds_read_b64_tr_b16 a[110:111], v15 offset:17152
    s_waitcnt vmcnt(26)
    ds_read_b64_tr_b16 a[112:113], v10 offset:20480
    ds_read_b64_tr_b16 a[114:115], v10 offset:20992
    ds_read_b64_tr_b16 a[116:117], v15 offset:20480
    ds_read_b64_tr_b16 a[118:119], v15 offset:20992
    ds_read_b64_tr_b16 a[120:121], v10 offset:20736
    ds_read_b64_tr_b16 a[122:123], v10 offset:21248
    ds_read_b64_tr_b16 a[124:125], v15 offset:20736
    ds_read_b64_tr_b16 a[126:127], v15 offset:21248
    s_waitcnt lgkmcnt(8)
    s_add_u32 m0, s57, 16384
    s_mov_b32 s67, 0
    buffer_load_dwordx4 v12, s[20:23], s67 offen offset:0 lds
    s_mov_b32 s67, 63488
    buffer_load_dwordx4 v12, s[20:23], s67 offen offset:2048 lds
    s_mov_b32 s67, 31744
    v_xor_b32_e64 v12, 32, v12
    buffer_load_dwordx4 v12, s[20:23], s67 offen offset:1024 lds
    s_mov_b32 s67, 95232
    buffer_load_dwordx4 v12, s[20:23], s67 offen offset:3072 lds
    s_waitcnt vmcnt(26)
    ds_read_b64_tr_b16 a[128:129], v10 offset:0
    ds_read_b64_tr_b16 a[130:131], v10 offset:512
    ds_read_b64_tr_b16 a[132:133], v15 offset:0
    ds_read_b64_tr_b16 a[134:135], v15 offset:512
    ds_read_b64_tr_b16 a[136:137], v10 offset:256
    ds_read_b64_tr_b16 a[138:139], v10 offset:768
    ds_read_b64_tr_b16 a[140:141], v15 offset:256
    ds_read_b64_tr_b16 a[142:143], v15 offset:768
    s_waitcnt lgkmcnt(8)
    s_add_u32 m0, s57, 20480
    s_mov_b32 s67, 162816
    buffer_load_dwordx4 v12, s[20:23], s67 offen offset:1024 lds
    s_mov_b32 s67, 226304
    buffer_load_dwordx4 v12, s[20:23], s67 offen offset:3072 lds
    s_mov_b32 s67, 131072
    v_xor_b32_e64 v12, 32, v12
    buffer_load_dwordx4 v12, s[20:23], s67 offen offset:0 lds
    s_mov_b32 s67, 194560
    buffer_load_dwordx4 v12, s[20:23], s67 offen offset:2048 lds
    s_waitcnt vmcnt(8)
    s_barrier
    s_cmp_lg_u32 s48, 0
    s_cbranch_scc1 L_nw0_20
    s_mov_b64 exec, 1
    v_mov_b32 v2, 1
    buffer_store_dword v2, off, s[40:43], s58 sc1
    s_mov_b64 exec, -1
L_nw0_20:
    s_cmp_eq_u32 s51, 7
    s_cbranch_scc1 L_idle
    s_lshr_b32 s72, s52, 1
    s_lshl2_add_u32 s72, s72, s48
    s_lshl_b32 s72, s72, 10
    s_add_u32 s72, s72, 65536
    v_lshrrev_b32 v3, 4, v0
    v_lshlrev_b32 v3, 8, v3
    ds_read_b64_tr_b16 a[144:145], v10 offset:4096
    ds_read_b64_tr_b16 a[146:147], v10 offset:4608
    ds_read_b64_tr_b16 a[148:149], v15 offset:4096
    ds_read_b64_tr_b16 a[150:151], v15 offset:4608
    ds_read_b64_tr_b16 a[152:153], v10 offset:4352
    ds_read_b64_tr_b16 a[154:155], v10 offset:4864
    ds_read_b64_tr_b16 a[156:157], v15 offset:4352
    ds_read_b64_tr_b16 a[158:159], v15 offset:4864
    s_waitcnt lgkmcnt(8)
    s_add_u32 m0, s57, 0
    s_add_u32 s16, s16, 114688
    s_addc_u32 s17, s17, 0
    buffer_load_dwordx4 v200, s[16:19], 0 offen offset:0 lds
    buffer_load_dwordx4 v201, s[16:19], 0 offen offset:1024 lds
    buffer_load_dwordx4 v202, s[16:19], 0 offen offset:2048 lds
    buffer_load_dwordx4 v203, s[16:19], 0 offen offset:3072 lds
    ds_read_b64_tr_b16 a[160:161], v10 offset:8192
    ds_read_b64_tr_b16 a[162:163], v10 offset:8704
    ds_read_b64_tr_b16 a[164:165], v15 offset:8192
    ds_read_b64_tr_b16 a[166:167], v15 offset:8704
    ds_read_b64_tr_b16 a[168:169], v10 offset:8448
    ds_read_b64_tr_b16 a[170:171], v10 offset:8960
    ds_read_b64_tr_b16 a[172:173], v15 offset:8448
    ds_read_b64_tr_b16 a[174:175], v15 offset:8960
    s_waitcnt lgkmcnt(8)
    s_add_u32 m0, s57, 4096
    s_add_u32 s16, s16, 114688
    s_addc_u32 s17, s17, 0
    buffer_load_dwordx4 v200, s[16:19], 0 offen offset:0 lds
    buffer_load_dwordx4 v201, s[16:19], 0 offen offset:1024 lds
    buffer_load_dwordx4 v202, s[16:19], 0 offen offset:2048 lds
    buffer_load_dwordx4 v203, s[16:19], 0 offen offset:3072 lds
    ds_read_b64_tr_b16 a[176:177], v10 offset:12288
    ds_read_b64_tr_b16 a[178:179], v10 offset:12800
    ds_read_b64_tr_b16 a[180:181], v15 offset:12288
    ds_read_b64_tr_b16 a[182:183], v15 offset:12800
    ds_read_b64_tr_b16 a[184:185], v10 offset:12544
    ds_read_b64_tr_b16 a[186:187], v10 offset:13056
    ds_read_b64_tr_b16 a[188:189], v15 offset:12544
L_ws1_2:
    s_cbranch_execz L_wr1
    ds_read_b64_tr_b16 a[190:191], v15 offset:13056
    s_waitcnt lgkmcnt(8)
    s_add_u32 m0, s57, 8192
    s_add_u32 s16, s16, 114688
    s_addc_u32 s17, s17, 0
    buffer_load_dwordx4 v200, s[16:19], 0 offen offset:0 lds
    buffer_load_dwordx4 v201, s[16:19], 0 offen offset:1024 lds
    buffer_load_dwordx4 v202, s[16:19], 0 offen offset:2048 lds
    buffer_load_dwordx4 v203, s[16:19], 0 offen offset:3072 lds
    s_waitcnt lgkmcnt(0)
    s_add_u32 m0, s57, 12288
    s_add_u32 s16, s16, 114688
    s_addc_u32 s17, s17, 0
    buffer_load_dwordx4 v200, s[16:19], 0 offen offset:0 lds
    buffer_load_dwordx4 v201, s[16:19], 0 offen offset:1024 lds
    buffer_load_dwordx4 v202, s[16:19], 0 offen offset:2048 lds
    buffer_load_dwordx4 v203, s[16:19], 0 offen offset:3072 lds
    s_and_b32 s59, s3, 1
    s_lshl_b32 s60, s52, 1
    s_add_u32 s59, s59, s60
    s_lshl_b32 s59, s59, 15
    s_lshl_b32 s60, s48, 13
    s_add_u32 s59, s59, s60
    s_add_u32 s65, s59, 5242880
    s_xor_b32 s64, s65, 32768
    v_lshlrev_b32_e64 v16, 16, v232
    v_and_b32 v17, 0xffff0000, v232
    v_lshlrev_b32_e64 v32, 16, v224
    v_and_b32 v33, 0xffff0000, v224
    v_lshlrev_b32_e64 v18, 16, v233
    v_and_b32 v19, 0xffff0000, v233
    v_lshlrev_b32_e64 v34, 16, v225
    v_and_b32 v35, 0xffff0000, v225
    v_lshlrev_b32_e64 v20, 16, v234
    v_and_b32 v21, 0xffff0000, v234
    v_lshlrev_b32_e64 v22, 16, v235
    v_and_b32 v23, 0xffff0000, v235
    v_lshlrev_b32_e64 v24, 16, v236
    v_and_b32 v25, 0xffff0000, v236
    v_lshlrev_b32_e64 v26, 16, v237
    v_and_b32 v27, 0xffff0000, v237
    v_lshlrev_b32_e64 v28, 16, v238
    v_and_b32 v29, 0xffff0000, v238
    v_lshlrev_b32_e64 v30, 16, v239
    v_and_b32 v31, 0xffff0000, v239
    v_and_b32 v4, 15, v0
    v_lshrrev_b32 v5, 5, v0
    v_lshl_add_u32 v4, v5, 4, v4
    v_bfe_u32 v5, v0, 4, 1
    s_cmp_eq_u32 s56, 7
    s_cselect_b32 s59, 1, 0
    v_or_b32_e64 v5, s59, v5
    v_lshl_add_u32 v4, v5, 26, v4
    v_lshlrev_b32 v46, 4, v4
    s_and_b32 s61, s3, 1
    s_lshr_b32 s63, s3, 1
    s_lshl1_add_u32 s61, s61, s63
    s_mul_i32 s58, s51, 112
    s_add_u32 s58, s58, s53
    s_lshl2_add_u32 s58, s58, s61
    s_lshl_b32 s58, s58, 9
    s_add_u32 s39, s58, 9437184
    v_mov_b32 v40, -1
    v_mov_b32 v41, -1
    v_mov_b32 v42, -1
    v_mov_b32_e64 v43, -1
    s_and_b32 s61, s3, 1
    s_lshl1_add_u32 s63, s52, s61
    s_lshr_b32 s61, s3, 1
    s_lshl4_add_u32 s63, s63, s61
    s_lshl1_add_u32 s63, s51, s63
    s_lshl_b32 s63, s63, 8
    s_add_u32 s63, s63, 786432
    s_xor_b32 s71, s63, 0x80000
    v_and_b32 v4, 15, v0
    v_lshrrev_b32 v5, 4, v0
    v_lshl_add_u32 v4, v4, 2, v5
    v_lshlrev_b32_e64 v4, 2, v4
    s_waitcnt lgkmcnt(0)
    s_mov_b32 s66, 0
L_poll_21:
    buffer_load_dword v2, v3, s[40:43], s72 offen sc1
    s_add_u32 s66, s66, 1
    s_cmp_gt_u32 s66, 0x100000
    s_cbranch_scc1 L_polld_22
    s_waitcnt vmcnt(0)
    v_cmp_gt_u32 vcc, 1, v2
    s_cbranch_vccnz L_poll_21
L_polld_22:
    s_waitcnt vmcnt(0)
    buffer_load_dwordx4 v[112:115], v1, s[40:43], s64 offen offset:0 sc1
    buffer_load_dwordx4 v[116:119], v1, s[40:43], s64 offen offset:1024 sc1
    buffer_load_dwordx4 v[120:123], v1, s[40:43], s64 offen offset:2048 sc1
    buffer_load_dwordx4 v[124:127], v1, s[40:43], s64 offen offset:3072 sc1
    s_add_u32 s64, s64, 4096
    buffer_load_dwordx4 v[128:131], v1, s[40:43], s64 offen offset:0 sc1
    buffer_load_dwordx4 v[132:135], v1, s[40:43], s64 offen offset:1024 sc1
    buffer_load_dwordx4 v[136:139], v1, s[40:43], s64 offen offset:2048 sc1
    buffer_load_dwordx4 v[140:143], v1, s[40:43], s64 offen offset:3072 sc1
    buffer_load_dwordx4 v[144:147], v1, s[40:43], s65 offen offset:0 sc1
    buffer_load_dwordx4 v[148:151], v1, s[40:43], s65 offen offset:1024 sc1
    buffer_load_dwordx4 v[152:155], v1, s[40:43], s65 offen offset:2048 sc1
    s_waitcnt vmcnt(10)
    v_mfma_f32_32x32x16_bf16 v[48:63], a[192:195], v[112:115], 0
    buffer_load_dwordx4 v[156:159], v1, s[40:43], s65 offen offset:3072 sc1
    ds_read_b64_tr_b16 v[160:161], v10 offset:16384
    v_mfma_f32_32x32x16_bf16 v[64:79], a[196:199], v[112:115], 0
    ds_read_b64_tr_b16 v[162:163], v10 offset:16896
    ds_read_b64_tr_b16 v[164:165], v15 offset:16384
    ds_read_b64_tr_b16 v[166:167], v15 offset:16896
    ds_read_b64_tr_b16 v[168:169], v10 offset:16640
    s_waitcnt vmcnt(10)
    v_mfma_f32_32x32x16_bf16 v[48:63], a[200:203], v[116:119], v[48:63]
    s_add_u32 s65, s65, 4096
    buffer_load_dwordx4 v[112:115], v1, s[40:43], s65 offen offset:0 sc1
    ds_read_b64_tr_b16 v[170:171], v10 offset:17152
    ds_read_b64_tr_b16 v[172:173], v15 offset:16640
    v_mfma_f32_32x32x16_bf16 v[64:79], a[204:207], v[116:119], v[64:79]
    ds_read_b64_tr_b16 v[174:175], v15 offset:17152
    ds_read_b64_tr_b16 v[176:177], v10 offset:20480
    ds_read_b64_tr_b16 v[178:179], v10 offset:20992
    s_waitcnt vmcnt(10)
    v_mfma_f32_32x32x16_bf16 v[48:63], a[208:211], v[120:123], v[48:63]
    buffer_load_dwordx4 v[116:119], v1, s[40:43], s65 offen offset:1024 sc1
    ds_read_b64_tr_b16 v[180:181], v15 offset:20480
    ds_read_b64_tr_b16 v[182:183], v15 offset:20992
    v_mfma_f32_32x32x16_bf16 v[64:79], a[212:215], v[120:123], v[64:79]
    ds_read_b64_tr_b16 v[184:185], v10 offset:20736
    ds_read_b64_tr_b16 v[186:187], v10 offset:21248
    ds_read_b64_tr_b16 v[188:189], v15 offset:20736
    ds_read_b64_tr_b16 v[190:191], v15 offset:21248
    s_waitcnt vmcnt(10)
    v_mfma_f32_32x32x16_bf16 v[48:63], a[216:219], v[124:127], v[48:63]
    buffer_load_dwordx4 v[120:123], v1, s[40:43], s65 offen offset:2048 sc1
    v_mfma_f32_32x32x16_bf16 v[64:79], a[220:223], v[124:127], v[64:79]
    s_waitcnt vmcnt(10)
    v_mfma_f32_32x32x16_bf16 v[48:63], a[224:227], v[128:131], v[48:63]
    buffer_load_dwordx4 v[124:127], v1, s[40:43], s65 offen offset:3072 sc1
    v_mfma_f32_32x32x16_bf16 v[64:79], a[228:231], v[128:131], v[64:79]
    s_waitcnt vmcnt(10)
    v_mfma_f32_32x32x16_bf16 v[48:63], a[232:235], v[132:135], v[48:63]
    v_mfma_f32_32x32x16_bf16 v[64:79], a[236:239], v[132:135], v[64:79]
    s_waitcnt vmcnt(9)
    v_mfma_f32_32x32x16_bf16 v[48:63], a[240:243], v[136:139], v[48:63]
    v_mfma_f32_32x32x16_bf16 v[64:79], a[244:247], v[136:139], v[64:79]
    s_waitcnt vmcnt(8)
    v_mfma_f32_32x32x16_bf16 v[48:63], a[248:251], v[140:143], v[48:63]
    v_mfma_f32_32x32x16_bf16 v[64:79], a[252:255], v[140:143], v[64:79]
    s_waitcnt vmcnt(7)
    v_mfma_f32_32x32x16_bf16 v[80:95], a[192:195], v[144:147], 0
    s_nop 6
    s_waitcnt vmcnt(6)
    v_mfma_f32_32x32x16_bf16 v[80:95], a[200:203], v[148:151], v[80:95]
    ds_write_b128 v8, v[48:51] offset:0
    ds_write_b128 v8, v[52:55] offset:1024
    s_waitcnt vmcnt(5)
    v_mfma_f32_32x32x16_bf16 v[80:95], a[208:211], v[152:155], v[80:95]
    ds_write_b128 v8, v[56:59] offset:2048
    ds_write_b128 v8, v[60:63] offset:3072
    s_waitcnt vmcnt(4)
    v_mfma_f32_32x32x16_bf16 v[80:95], a[216:219], v[156:159], v[80:95]
    ds_write_b128 v6, v[64:67] offset:0
    ds_write_b128 v6, v[68:71] offset:1024
    s_waitcnt vmcnt(3)
    v_mfma_f32_32x32x16_bf16 v[80:95], a[224:227], v[112:115], v[80:95]
    ds_write_b128 v6, v[72:75] offset:2048
    ds_write_b128 v6, v[76:79] offset:3072
    s_waitcnt vmcnt(2)
    v_mfma_f32_32x32x16_bf16 v[80:95], a[232:235], v[116:119], v[80:95]
    s_add_u32 s58, s39, 0
    buffer_store_dwordx4 v[40:43], v46, s[40:43], s58 offen sc1
    s_add_u32 s58, s39, 57344
    buffer_store_dwordx4 v[40:43], v46, s[40:43], s58 offen sc1
    s_waitcnt vmcnt(3)
    v_mfma_f32_32x32x16_bf16 v[80:95], a[240:243], v[120:123], v[80:95]
    s_add_u32 s58, s39, 114688
    buffer_store_dwordx4 v[40:43], v46, s[40:43], s58 offen sc1
    s_add_u32 s58, s39, 172032
    buffer_store_dwordx4 v[40:43], v46, s[40:43], s58 offen sc1
    s_waitcnt vmcnt(4)
    v_mfma_f32_32x32x16_bf16 v[80:95], a[248:251], v[124:127], v[80:95]
    v_mfma_f32_32x32x16_bf16 v[96:111], a[196:199], v[144:147], v[16:31]
    s_waitcnt lgkmcnt(15)
    s_add_u32 m0, s57, 16384
    s_mov_b32 s67, 262144
    buffer_load_dwordx4 v12, s[20:23], s67 offen offset:0 lds
    s_waitcnt lgkmcnt(0)
    s_barrier
    ds_read_b128 v[48:51], v9 offset:8192
    ds_read_b128 v[52:55], v9 offset:9216
    ds_read_b128 v[56:59], v9 offset:10240
    v_mfma_f32_32x32x16_bf16 v[96:111], a[204:207], v[148:151], v[96:111]
    s_mov_b32 s67, 325632
    buffer_load_dwordx4 v12, s[20:23], s67 offen offset:2048 lds
    ds_read_b128 v[60:63], v9 offset:11264
    ds_read_b128 v[64:67], v9 offset:0
    ds_read_b128 v[68:71], v9 offset:1024
    ds_read_b128 v[72:75], v9 offset:2048
    v_mfma_f32_32x32x16_bf16 v[96:111], a[212:215], v[152:155], v[96:111]
    s_mov_b32 s67, 293888
    v_xor_b32 v12, 32, v12
    buffer_load_dwordx4 v12, s[20:23], s67 offen offset:1024 lds
    ds_read_b128 v[76:79], v9 offset:3072
    v_mfma_f32_32x32x16_bf16 v[96:111], a[220:223], v[156:159], v[96:111]
    s_mov_b32 s67, 357376
    buffer_load_dwordx4 v12, s[20:23], s67 offen offset:3072 lds
    ds_write_b128 v7, v[80:83] offset:0
    v_mfma_f32_32x32x16_bf16 v[96:111], a[228:231], v[112:115], v[96:111]
    s_add_u32 m0, s57, 20480
    s_mov_b32 s67, 424960
    buffer_load_dwordx4 v12, s[20:23], s67 offen offset:1024 lds
    ds_write_b128 v7, v[84:87] offset:1024
    v_mfma_f32_32x32x16_bf16 v[96:111], a[236:239], v[116:119], v[96:111]
    s_mov_b32 s67, 488448
    buffer_load_dwordx4 v12, s[20:23], s67 offen offset:3072 lds
    ds_write_b128 v7, v[88:91] offset:2048
    v_mfma_f32_32x32x16_bf16 v[96:111], a[244:247], v[120:123], v[96:111]
    s_mov_b32 s67, 393216
    v_xor_b32_e64 v12, 32, v12
    buffer_load_dwordx4 v12, s[20:23], s67 offen offset:0 lds
    ds_write_b128 v7, v[92:95] offset:3072
    s_waitcnt lgkmcnt(7)
    v_mfma_f32_32x32x16_bf16 v[96:111], a[252:255], v[124:127], v[96:111]
    s_mov_b32 s67, 456704
    buffer_load_dwordx4 v12, s[20:23], s67 offen offset:2048 lds
    v_add_f32 v48, v48, v64
    v_add_f32 v49, v49, v65
    v_add_f32 v50, v50, v66
    v_add_f32 v51, v51, v67
    s_waitcnt lgkmcnt(6)
    v_add_f32 v52, v52, v68
    v_add_f32 v53, v53, v69
    v_add_f32 v54, v54, v70
    v_add_f32 v55, v55, v71
    s_waitcnt lgkmcnt(0)
    s_barrier
    ds_read_b128 v[80:83], v9 offset:4096
    ds_read_b128 v[84:87], v9 offset:5120
    ds_read_b128 v[88:91], v9 offset:6144
    ds_read_b128 v[92:95], v9 offset:7168
    v_add_f32 v56, v56, v72
    v_add_f32 v57, v57, v73
    v_add_f32 v58, v58, v74
    v_add_f32 v59, v59, v75
    v_add_f32 v60, v60, v76
    v_add_f32 v61, v61, v77
    v_add_f32 v62, v62, v78
    v_add_f32 v63, v63, v79
    v_pk_add_f32 v[96:97], v[96:97], v[48:49]
    v_pk_add_f32 v[98:99], v[98:99], v[50:51]
    v_pk_add_f32 v[100:101], v[100:101], v[52:53]
    v_pk_add_f32 v[102:103], v[102:103], v[54:55]
    v_pk_add_f32 v[104:105], v[104:105], v[56:57]
    v_pk_add_f32 v[106:107], v[106:107], v[58:59]
    v_pk_add_f32 v[108:109], v[108:109], v[60:61]
    v_pk_add_f32 v[110:111], v[110:111], v[62:63]
    s_waitcnt lgkmcnt(3)
    v_pk_add_f32 v[96:97], v[96:97], v[80:81]
    v_pk_add_f32 v[98:99], v[98:99], v[82:83]
    s_waitcnt lgkmcnt(2)
    v_pk_add_f32 v[100:101], v[100:101], v[84:85]
    v_pk_add_f32 v[102:103], v[102:103], v[86:87]
    s_waitcnt lgkmcnt(1)
    v_pk_add_f32 v[104:105], v[104:105], v[88:89]
    v_pk_add_f32 v[106:107], v[106:107], v[90:91]
    s_waitcnt lgkmcnt(0)
    v_pk_add_f32 v[108:109], v[108:109], v[92:93]
    v_pk_add_f32 v[110:111], v[110:111], v[94:95]
    v_pk_add_f32 v[72:73], v[96:97], v[98:99]
    v_pk_mul_f32 v[74:75], v[96:97], v[96:97]
    v_pk_fma_f32 v[74:75], v[98:99], v[98:99], v[74:75]
    v_pk_add_f32 v[72:73], v[72:73], v[100:101]
    v_pk_fma_f32 v[74:75], v[100:101], v[100:101], v[74:75]
    v_pk_add_f32 v[72:73], v[72:73], v[102:103]
    v_pk_fma_f32 v[74:75], v[102:103], v[102:103], v[74:75]
    v_pk_add_f32 v[72:73], v[72:73], v[104:105]
    v_pk_fma_f32 v[74:75], v[104:105], v[104:105], v[74:75]
    v_pk_add_f32 v[72:73], v[72:73], v[106:107]
    v_pk_fma_f32 v[74:75], v[106:107], v[106:107], v[74:75]
    v_pk_add_f32 v[72:73], v[72:73], v[108:109]
    v_pk_fma_f32 v[74:75], v[108:109], v[108:109], v[74:75]
    v_pk_add_f32 v[72:73], v[72:73], v[110:111]
    v_pk_fma_f32 v[74:75], v[110:111], v[110:111], v[74:75]
    v_add_f32 v72, v72, v73
    v_add_f32 v74, v74, v75
    s_nop 1
    v_permlane32_swap_b32 v72, v74
    v_add_f32_e64 v72, v72, v74
    buffer_store_dword v72, v4, s[40:43], s63 offen sc1
    s_and_b32 s63, s63, 0xfffff000
    ds_read_b64_tr_b16 a[192:193], v10 offset:0
    ds_read_b64_tr_b16 a[194:195], v10 offset:512
    ds_read_b64_tr_b16 a[196:197], v15 offset:0
    ds_read_b64_tr_b16 a[198:199], v15 offset:512
    ds_read_b64_tr_b16 a[200:201], v10 offset:256
    ds_read_b64_tr_b16 a[202:203], v10 offset:768
    ds_read_b64_tr_b16 a[204:205], v15 offset:256
    ds_read_b64_tr_b16 a[206:207], v15 offset:768
    ds_read_b64_tr_b16 a[208:209], v10 offset:4096
    ds_read_b64_tr_b16 a[210:211], v10 offset:4608
    ds_read_b64_tr_b16 a[212:213], v15 offset:4096
    ds_read_b64_tr_b16 a[214:215], v15 offset:4608
    ds_read_b64_tr_b16 a[216:217], v10 offset:4352
    ds_read_b64_tr_b16 a[218:219], v10 offset:4864
    ds_read_b64_tr_b16 a[220:221], v15 offset:4352
    ds_read_b64_tr_b16 a[222:223], v15 offset:4864
    s_waitcnt lgkmcnt(8)
    s_add_u32 m0, s57, 0
    s_mov_b32 s67, 524288
    buffer_load_dwordx4 v12, s[20:23], s67 offen offset:0 lds
    s_mov_b32 s67, 587776
    buffer_load_dwordx4 v12, s[20:23], s67 offen offset:2048 lds
    s_mov_b32 s67, 556032
    v_xor_b32_e64 v12, 32, v12
    buffer_load_dwordx4 v12, s[20:23], s67 offen offset:1024 lds
    s_mov_b32 s67, 619520
    buffer_load_dwordx4 v12, s[20:23], s67 offen offset:3072 lds
    ds_read_b64_tr_b16 a[224:225], v10 offset:8192
    ds_read_b64_tr_b16 a[226:227], v10 offset:8704
    ds_read_b64_tr_b16 a[228:229], v15 offset:8192
    ds_read_b64_tr_b16 a[230:231], v15 offset:8704
    ds_read_b64_tr_b16 a[232:233], v10 offset:8448
    ds_read_b64_tr_b16 a[234:235], v10 offset:8960
    ds_read_b64_tr_b16 a[236:237], v15 offset:8448
    ds_read_b64_tr_b16 a[238:239], v15 offset:8960
    s_waitcnt lgkmcnt(8)
    s_add_u32 m0, s57, 4096
    s_mov_b32 s67, 687104
    buffer_load_dwordx4 v12, s[20:23], s67 offen offset:1024 lds
    s_mov_b32 s67, 750592
    buffer_load_dwordx4 v12, s[20:23], s67 offen offset:3072 lds
    s_mov_b32 s67, 655360
    v_xor_b32 v12, 32, v12
    buffer_load_dwordx4 v12, s[20:23], s67 offen offset:0 lds
    s_mov_b32 s67, 718848
    buffer_load_dwordx4 v12, s[20:23], s67 offen offset:2048 lds
    ds_read_b64_tr_b16 a[240:241], v10 offset:12288
    ds_read_b64_tr_b16 a[242:243], v10 offset:12800
    ds_read_b64_tr_b16 a[244:245], v15 offset:12288
    ds_read_b64_tr_b16 a[246:247], v15 offset:12800
    ds_read_b64_tr_b16 a[248:249], v10 offset:12544
    ds_read_b64_tr_b16 a[250:251], v10 offset:13056
    ds_read_b64_tr_b16 a[252:253], v15 offset:12544
    ds_read_b64_tr_b16 a[254:255], v15 offset:13056
    s_waitcnt lgkmcnt(8)
    s_add_u32 m0, s57, 8192
    s_mov_b32 s67, 786432
    buffer_load_dwordx4 v12, s[20:23], s67 offen offset:0 lds
    s_mov_b32 s67, 849920
    buffer_load_dwordx4 v12, s[20:23], s67 offen offset:2048 lds
    s_mov_b32 s67, 818176
    v_xor_b32 v12, 32, v12
    buffer_load_dwordx4 v12, s[20:23], s67 offen offset:1024 lds
    s_mov_b32 s67, 881664
    buffer_load_dwordx4 v12, s[20:23], s67 offen offset:3072 lds
    s_waitcnt vmcnt(17)
    ds_read_b64_tr_b16 v[192:193], v10 offset:16384
    ds_read_b64_tr_b16 v[194:195], v10 offset:16896
    ds_read_b64_tr_b16 v[196:197], v15 offset:16384
    ds_read_b64_tr_b16 v[198:199], v15 offset:16896
    ds_read_b64_tr_b16 v[200:201], v10 offset:16640
    ds_read_b64_tr_b16 v[202:203], v10 offset:17152
    ds_read_b64_tr_b16 v[204:205], v15 offset:16640
    ds_read_b64_tr_b16 v[206:207], v15 offset:17152
    s_waitcnt lgkmcnt(8)
    s_add_u32 m0, s57, 12288
    s_mov_b32 s67, 949248
    buffer_load_dwordx4 v12, s[20:23], s67 offen offset:1024 lds
    s_mov_b32 s67, 1012736
    buffer_load_dwordx4 v12, s[20:23], s67 offen offset:3072 lds
    s_mov_b32 s67, 917504
    v_xor_b32_e64 v12, 32, v12
    buffer_load_dwordx4 v12, s[20:23], s67 offen offset:0 lds
    s_mov_b32 s67, 980992
    buffer_load_dwordx4 v12, s[20:23], s67 offen offset:2048 lds
    s_waitcnt vmcnt(17)
    ds_read_b64_tr_b16 v[208:209], v10 offset:20480
    ds_read_b64_tr_b16 v[210:211], v10 offset:20992
    ds_read_b64_tr_b16 v[212:213], v15 offset:20480
    ds_read_b64_tr_b16 v[214:215], v15 offset:20992
    ds_read_b64_tr_b16 v[216:217], v10 offset:20736
    ds_read_b64_tr_b16 v[218:219], v10 offset:21248
    ds_read_b64_tr_b16 v[220:221], v15 offset:20736
    ds_read_b64_tr_b16 v[222:223], v15 offset:21248
    v_mov_b32 v78, 0x2edbe6ff
    s_lshl_b32 s58, s48, 11
    s_add_u32 s58, s58, 49152
    v_and_b32_e64 v85, 31, v0
    v_lshl_add_u32 v85, v85, 6, s58
    v_bfe_u32 v5, v0, 1, 3
    v_lshrrev_b32 v13, 5, v0
    v_xor_b32 v5, v5, v13
    v_lshl_add_u32 v80, v5, 3, v85
    v_xor_b32 v81, 16, v80
    v_xor_b32 v82, 32, v80
    v_xor_b32_e64 v83, 48, v80
    v_bfe_u32 v5, v0, 2, 2
    v_lshl_add_u32 v13, v13, 3, v5
    v_lshrrev_b32_e64 v5, 1, v13
    v_bfe_u32 v14, v0, 4, 1
    v_and_b32_e64 v85, 3, v0
    v_lshl_add_u32 v14, v14, 2, v85
    v_xor_b32_e64 v14, v14, v5
    v_lshl_add_u32 v13, v13, 6, s58
    v_lshl_add_u32 v84, v14, 3, v13
    v_xor_b32 v85, 16, v84
    s_lshr_b32 s59, s3, 1
    s_lshl1_add_u32 s58, s51, s59
    s_lshl_b32 s58, s58, 6
    s_add_u32 s58, s58, s52
    s_and_b32 s60, s3, 1
    s_lshl1_add_u32 s58, s58, s60
    s_lshl_b32 s58, s58, 10
    s_add_u32 s58, s58, 7344128
    v_and_b32 v4, 15, v0
    v_lshrrev_b32 v5, 5, v0
    v_bfe_u32 v13, v0, 4, 1
    v_lshl_add_u32 v14, v5, 4, v4
    v_lshl_add_u32 v14, v13, 12, v14
    v_lshlrev_b32 v86, 4, v14
    s_lshl_b32 s59, s51, 5
    s_add_u32 s59, s59, s52
    s_lshl_b32 s59, s59, 8
    s_add_u32 s70, s59, 131072
    s_mov_b32 s66, 0
L_sp_23:
    buffer_load_dwordx4 v[48:51], v1, s[40:43], s63 offen offset:0 sc1
    buffer_load_dwordx4 v[52:55], v1, s[40:43], s63 offen offset:1024 sc1
    buffer_load_dwordx4 v[56:59], v1, s[40:43], s63 offen offset:2048 sc1
    buffer_load_dwordx4 v[60:63], v1, s[40:43], s63 offen offset:3072 sc1
    s_add_u32 s66, s66, 1
    s_cmp_gt_u32 s66, 0x100000
    s_waitcnt vmcnt(0)
    s_cbranch_scc1 L_spd_24
    v_max3_u32 v5, v48, v49, 0
    v_max3_u32 v5, v50, v51, v5
    v_max3_u32 v5, v52, v53, v5
    v_max3_u32 v5, v54, v55, v5
    v_max3_u32 v5, v56, v57, v5
    v_max3_u32 v5, v58, v59, v5
    v_max3_u32 v5, v60, v61, v5
    v_max3_u32 v5, v62, v63, v5
    v_cmp_eq_u32 vcc, -1, v5
    s_cbranch_vccnz L_sp_23
L_spd_24:
    s_waitcnt lgkmcnt(0)
    v_pk_add_f32 v[48:49], v[48:49], v[52:53]
    v_pk_add_f32 v[50:51], v[50:51], v[54:55]
    v_pk_add_f32 v[56:57], v[56:57], v[60:61]
    v_pk_add_f32 v[58:59], v[58:59], v[62:63]
    v_pk_add_f32 v[48:49], v[48:49], v[56:57]
    v_pk_add_f32 v[50:51], v[50:51], v[58:59]
    s_nop 1
    v_permlane32_swap_b32 v48, v50
    v_permlane32_swap_b32 v49, v51
    v_pk_add_f32 v[48:49], v[48:49], v[50:51]
    s_nop 1
    v_permlane16_swap_b32 v48, v49
    v_add_f32_e64 v72, v48, v49
    v_mul_f32 v73, 0x3b124925, v72
    v_mul_f32 v72, 0x3b124925, v72
    s_nop 1
    v_permlane32_swap_b32 v72, v73
    v_fma_f32 v73, -v72, v72, v73
    v_max_f32_e64 v73, 0, v73
    v_fmamk_f32 v73, v73, 0x3f800054, v78
    v_rsq_f32 v74, v73
    s_nop 0
    v_mul_f32_e64 v76, v72, v74
    v_pk_fma_f32 v[48:49], v[96:97], v[74:75], v[76:77] op_sel_hi:[1,0,0] neg_lo:[0,0,1] neg_hi:[0,0,1]
    v_pk_fma_f32 v[50:51], v[98:99], v[74:75], v[76:77] op_sel_hi:[1,0,0] neg_lo:[0,0,1] neg_hi:[0,0,1]
    v_cvt_pk_bf16_f32 v64, v48, v49
    v_cvt_pk_bf16_f32 v65, v50, v51
    ds_write_b64 v80, v[64:65]
    v_pk_fma_f32 v[52:53], v[100:101], v[74:75], v[76:77] op_sel_hi:[1,0,0] neg_lo:[0,0,1] neg_hi:[0,0,1]
    v_pk_fma_f32 v[54:55], v[102:103], v[74:75], v[76:77] op_sel_hi:[1,0,0] neg_lo:[0,0,1] neg_hi:[0,0,1]
    v_cvt_pk_bf16_f32 v66, v52, v53
    v_cvt_pk_bf16_f32 v67, v54, v55
    ds_write_b64 v81, v[66:67]
    v_pk_fma_f32 v[56:57], v[104:105], v[74:75], v[76:77] op_sel_hi:[1,0,0] neg_lo:[0,0,1] neg_hi:[0,0,1]
    v_pk_fma_f32 v[58:59], v[106:107], v[74:75], v[76:77] op_sel_hi:[1,0,0] neg_lo:[0,0,1] neg_hi:[0,0,1]
    v_cvt_pk_bf16_f32 v68, v56, v57
    v_cvt_pk_bf16_f32 v69, v58, v59
    ds_write_b64 v82, v[68:69]
    v_pk_fma_f32 v[60:61], v[108:109], v[74:75], v[76:77] op_sel_hi:[1,0,0] neg_lo:[0,0,1] neg_hi:[0,0,1]
    v_pk_fma_f32 v[62:63], v[110:111], v[74:75], v[76:77] op_sel_hi:[1,0,0] neg_lo:[0,0,1] neg_hi:[0,0,1]
    v_cvt_pk_bf16_f32 v70, v60, v61
    v_cvt_pk_bf16_f32 v71, v62, v63
    ds_write_b64 v83, v[70:71]
    ds_read_b64_tr_b16 v[88:89], v84 offset:0
    ds_read_b64_tr_b16 v[90:91], v85 offset:256
    ds_read_b64_tr_b16 v[92:93], v84 offset:1024
    ds_read_b64_tr_b16 v[94:95], v85 offset:1280
    s_waitcnt lgkmcnt(2)
    buffer_store_dwordx4 v[88:91], v86, s[40:43], s58 offen offset:0 sc1
    s_waitcnt lgkmcnt(0)
    buffer_store_dwordx4 v[92:95], v86, s[40:43], s58 offen offset:512 sc1
    s_add_u32 m0, s57, 16384
    s_mov_b32 s67, 1048576
    buffer_load_dwordx4 v12, s[20:23], s67 offen offset:0 lds
    s_mov_b32 s67, 1112064
    buffer_load_dwordx4 v12, s[20:23], s67 offen offset:2048 lds
    s_mov_b32 s67, 1080320
    v_xor_b32_e64 v12, 32, v12
    buffer_load_dwordx4 v12, s[20:23], s67 offen offset:1024 lds
    s_mov_b32 s67, 1143808
    buffer_load_dwordx4 v12, s[20:23], s67 offen offset:3072 lds
    ds_read_b64_tr_b16 v[224:225], v10 offset:0
    ds_read_b64_tr_b16 v[226:227], v10 offset:512
    ds_read_b64_tr_b16 v[228:229], v15 offset:0
    ds_read_b64_tr_b16 v[230:231], v15 offset:512
    ds_read_b64_tr_b16 v[232:233], v10 offset:256
    ds_read_b64_tr_b16 v[234:235], v10 offset:768
    ds_read_b64_tr_b16 v[236:237], v15 offset:256
    ds_read_b64_tr_b16 v[238:239], v15 offset:768
    s_add_u32 m0, s57, 20480
    s_mov_b32 s67, 1211392
    buffer_load_dwordx4 v12, s[20:23], s67 offen offset:1024 lds
    s_mov_b32 s67, 1274880
    buffer_load_dwordx4 v12, s[20:23], s67 offen offset:3072 lds
    s_mov_b32 s67, 1179648
    v_xor_b32_e64 v12, 32, v12
    buffer_load_dwordx4 v12, s[20:23], s67 offen offset:0 lds
    s_mov_b32 s67, 1243136
    buffer_load_dwordx4 v12, s[20:23], s67 offen offset:2048 lds
    ds_read_b64_tr_b16 v[240:241], v10 offset:4096
    ds_read_b64_tr_b16 v[242:243], v10 offset:4608
    ds_read_b64_tr_b16 v[244:245], v15 offset:4096
    ds_read_b64_tr_b16 v[246:247], v15 offset:4608
    ds_read_b64_tr_b16 v[248:249], v10 offset:4352
    ds_read_b64_tr_b16 v[250:251], v10 offset:4864
    ds_read_b64_tr_b16 v[252:253], v15 offset:4352
    ds_read_b64_tr_b16 v[254:255], v15 offset:4864
    v_lshlrev_b32_e64 v14, 16, v11
    v_pk_add_f32 v[16:17], v[96:97], v[14:15] op_sel_hi:[1,0]
    v_pk_add_f32 v[18:19], v[98:99], v[14:15] op_sel_hi:[1,0]
    v_pk_add_f32 v[20:21], v[100:101], v[14:15] op_sel_hi:[1,0]
    v_pk_add_f32 v[22:23], v[102:103], v[14:15] op_sel_hi:[1,0]
    v_pk_add_f32 v[24:25], v[104:105], v[14:15] op_sel_hi:[1,0]
    v_pk_add_f32 v[26:27], v[106:107], v[14:15] op_sel_hi:[1,0]
    v_pk_add_f32 v[28:29], v[108:109], v[14:15] op_sel_hi:[1,0]
    v_pk_add_f32 v[30:31], v[110:111], v[14:15] op_sel_hi:[1,0]
    ds_write_b128 v9, v[16:19] offset:2048
    ds_write_b128 v9, v[20:23] offset:3072
    ds_write_b128 v9, v[24:27] offset:6144
    ds_write_b128 v9, v[28:31] offset:7168
    v_lshrrev_b32_e64 v5, 5, v0
    v_lshl_add_u32 v4, v13, 5, v4
    v_lshl_add_u32 v4, v5, 6, v4
    s_and_b32 s60, s3, 2
    v_lshl_add_u32 v4, s60, 3, v4
    s_xor_b32 s60, s60, s48
    s_mul_i32 s61, s60, 12288
    v_lshl_add_u32 v72, v4, 4, s61
    s_xor_b32 s60, s60, 2
    s_mul_i32 s61, s60, 12288
    v_lshl_add_u32 v73, v4, 4, s61
    s_lshl2_add_u32 s58, s51, s48
    s_lshl_b32 s58, s58, 11
    s_add_u32 s72, s58, 131072
    v_lshrrev_b32 v3, 3, v0
    v_and_b32 v5, 7, v0
    v_xor_b32 v5, v5, v3
    v_mul_u32_u24 v4, 896, v3
    v_lshl_add_u32 v45, v5, 4, v4
    v_lshlrev_b32_e64 v3, 8, v3
    s_and_b32 s61, s3, 1
    s_lshr_b32 s63, s3, 1
    s_lshl1_add_u32 s61, s61, s63
    s_lshl2_add_u32 s59, s52, s61
    s_mul_i32 s59, s59, 14336
    s_lshl_b32 s60, s51, 7
    s_add_u32 s73, s59, s60
    s_add_u32 s38, s73, 7168
    s_lshl_b32 s59, s48, 11
    s_add_u32 s59, s59, 49152
    v_add_u32 v44, s59, v1
    v_and_b32 v4, 15, v0
    v_lshrrev_b32 v5, 5, v0
    v_xor_b32 v5, v5, v4
    v_and_b32 v5, 7, v5
    v_lshl_add_u32 v4, v4, 7, s59
    v_lshl_add_u32 v4, v5, 4, v4
    v_bfe_u32 v5, v0, 4, 1
    v_lshl_add_u32 v40, v5, 3, v4
    v_xor_b32 v41, 32, v40
    v_xor_b32 v42, 64, v40
    v_xor_b32 v43, 96, v40
    s_lshl4_add_u32 s59, s51, s48
    s_mul_i32 s60, s59, 14336
    s_add_u32 s60, s60, 9437184
    s_lshl_b32 s59, s59, 14
    s_add_u32 s62, s59, 7344128
    s_add_u32 s44, s40, s62
    s_addc_u32 s45, s41, 0
    v_mov_b32 v4, 0xbdd2d3e8
L_ws1_3:
    s_cbranch_execz L_wr1
    v_mov_b32 v14, 0xc0135761
    v_lshrrev_b32 v13, 2, v0
    v_lshlrev_b32 v13, 10, v13
    s_waitcnt vmcnt(8) lgkmcnt(0)
    s_barrier
    s_cmp_lg_u32 s48, 0
    s_cbranch_scc1 L_nw0_25
    s_mov_b64 exec, 1
    v_mov_b32_e64 v2, 1
    buffer_store_dword v2, off, s[40:43], s70 sc1
    s_mov_b64 exec, -1
L_nw0_25:
    ds_read_b128 v[16:19], v72 offset:2048
    ds_read_b128 v[20:23], v72 offset:6144
    ds_read_b128 v[24:27], v73 offset:2048
    ds_read_b128 v[28:31], v73 offset:6144
    s_add_u32 m0, s57, 0
    s_mov_b32 s67, 1310720
    buffer_load_dwordx4 v12, s[20:23], s67 offen offset:0 lds
    s_mov_b32 s67, 1374208
    buffer_load_dwordx4 v12, s[20:23], s67 offen offset:2048 lds
    s_mov_b32 s67, 1342464
    v_xor_b32_e64 v12, 32, v12
    buffer_load_dwordx4 v12, s[20:23], s67 offen offset:1024 lds
    s_mov_b32 s67, 1405952
    buffer_load_dwordx4 v12, s[20:23], s67 offen offset:3072 lds
    ds_read_b64_tr_b16 v[80:81], v10 offset:8192
    ds_read_b64_tr_b16 v[82:83], v10 offset:8704
    ds_read_b64_tr_b16 v[84:85], v15 offset:8192
    ds_read_b64_tr_b16 v[86:87], v15 offset:8704
    ds_read_b64_tr_b16 v[88:89], v10 offset:8448
    ds_read_b64_tr_b16 v[90:91], v10 offset:8960
    ds_read_b64_tr_b16 v[92:93], v15 offset:8448
    ds_read_b64_tr_b16 v[94:95], v15 offset:8960
    s_add_u32 m0, s57, 4096
    s_mov_b32 s67, 1473536
    buffer_load_dwordx4 v12, s[20:23], s67 offen offset:1024 lds
    s_mov_b32 s67, 1537024
    buffer_load_dwordx4 v12, s[20:23], s67 offen offset:3072 lds
    s_mov_b32 s67, 1441792
    v_xor_b32_e64 v12, 32, v12
    buffer_load_dwordx4 v12, s[20:23], s67 offen offset:0 lds
    s_mov_b32 s67, 1505280
    buffer_load_dwordx4 v12, s[20:23], s67 offen offset:2048 lds
    ds_read_b64_tr_b16 v[96:97], v10 offset:12288
    ds_read_b64_tr_b16 v[98:99], v10 offset:12800
    ds_read_b64_tr_b16 v[100:101], v15 offset:12288
    ds_read_b64_tr_b16 v[102:103], v15 offset:12800
    ds_read_b64_tr_b16 v[104:105], v10 offset:12544
    ds_read_b64_tr_b16 v[106:107], v10 offset:13056
    ds_read_b64_tr_b16 v[108:109], v15 offset:12544
    ds_read_b64_tr_b16 v[110:111], v15 offset:13056
    s_waitcnt lgkmcnt(8)
    s_add_u32 m0, s57, 8192
    s_mov_b32 s67, 1572864
    buffer_load_dwordx4 v12, s[20:23], s67 offen offset:0 lds
    s_mov_b32 s67, 1636352
    buffer_load_dwordx4 v12, s[20:23], s67 offen offset:2048 lds
    s_mov_b32 s67, 1604608
    v_xor_b32 v12, 32, v12
    buffer_load_dwordx4 v12, s[20:23], s67 offen offset:1024 lds
    s_mov_b32 s67, 1668096
    buffer_load_dwordx4 v12, s[20:23], s67 offen offset:3072 lds
    s_waitcnt lgkmcnt(0)
    s_add_u32 m0, s57, 12288
    s_mov_b32 s67, 1735680
    buffer_load_dwordx4 v12, s[20:23], s67 offen offset:1024 lds
    s_mov_b32 s67, 1799168
    buffer_load_dwordx4 v12, s[20:23], s67 offen offset:3072 lds
    s_mov_b32 s67, 1703936
    v_xor_b32 v12, 32, v12
    buffer_load_dwordx4 v12, s[20:23], s67 offen offset:0 lds
    s_mov_b32 s67, 1767424
    buffer_load_dwordx4 v12, s[20:23], s67 offen offset:2048 lds
    s_waitcnt lgkmcnt(0)
    s_mov_b32 s66, 0
    buffer_load_dwordx4 v[112:115], v1, s[44:47], 0 offen offset:0 sc1
    buffer_load_dwordx4 v[116:119], v1, s[44:47], 0 offen offset:1024 sc1
    buffer_load_dwordx4 v[120:123], v1, s[44:47], 0 offen offset:2048 sc1
    buffer_load_dwordx4 v[124:127], v1, s[44:47], 0 offen offset:3072 sc1
    s_add_u32 s44, s44, 4096
    s_addc_u32 s45, s45, 0
    buffer_load_dwordx4 v[128:131], v1, s[44:47], 0 offen offset:0 sc1
    buffer_load_dwordx4 v[132:135], v1, s[44:47], 0 offen offset:1024 sc1
    buffer_load_dwordx4 v[136:139], v1, s[44:47], 0 offen offset:2048 sc1
    buffer_load_dwordx4 v[140:143], v1, s[44:47], 0 offen offset:3072 sc1
    s_add_u32 s44, s44, 4096
    s_addc_u32 s45, s45, 0
    buffer_load_dwordx4 v[144:147], v1, s[44:47], 0 offen offset:0 sc1
    buffer_load_dwordx4 v[148:151], v1, s[44:47], 0 offen offset:1024 sc1
    buffer_load_dwordx4 v[152:155], v1, s[44:47], 0 offen offset:2048 sc1
    s_waitcnt vmcnt(10)
    v_max3_u32 v47, v112, v113, v114
    v_cmp_u_f32 vcc, v47, v115
    s_cbranch_vccnz L_re0
L_rb0:
    v_mfma_f32_16x16x32_bf16 v[48:51], a[0:3], v[112:115], 0
    buffer_load_dwordx4 v[156:159], v1, s[44:47], 0 offen offset:3072 sc1
    v_mfma_f32_16x16x32_bf16 v[52:55], a[4:7], v[112:115], 0
    s_waitcnt vmcnt(10)
    v_max3_u32 v47, v116, v117, v118
    v_cmp_u_f32 vcc, v47, v119
    v_mfma_f32_16x16x32_bf16 v[56:59], a[8:11], v[112:115], 0
    s_add_u32 s44, s44, 4096
    s_addc_u32 s45, s45, 0
    v_mfma_f32_16x16x32_bf16 v[60:63], a[12:15], v[112:115], v[32:35]
    s_cbranch_vccnz L_re1
L_rb1:
    v_mfma_f32_16x16x32_bf16 v[48:51], a[16:19], v[116:119], v[48:51]
    buffer_load_dwordx4 v[112:115], v1, s[44:47], 0 offen offset:0 sc1
    v_mfma_f32_16x16x32_bf16 v[52:55], a[20:23], v[116:119], v[52:55]
    s_waitcnt vmcnt(10)
    v_max3_u32 v47, v120, v121, v122
    v_cmp_u_f32 vcc, v47, v123
    v_mfma_f32_16x16x32_bf16 v[56:59], a[24:27], v[116:119], v[56:59]
    v_mfma_f32_16x16x32_bf16 v[60:63], a[28:31], v[116:119], v[60:63]
    s_cbranch_vccnz L_re2
L_rb2:
    v_mfma_f32_16x16x32_bf16 v[48:51], a[32:35], v[120:123], v[48:51]
    buffer_load_dwordx4 v[116:119], v1, s[44:47], 0 offen offset:1024 sc1
    v_mfma_f32_16x16x32_bf16 v[52:55], a[36:39], v[120:123], v[52:55]
    s_waitcnt vmcnt(10)
    v_max3_u32 v47, v124, v125, v126
    v_cmp_u_f32 vcc, v47, v127
    v_mfma_f32_16x16x32_bf16 v[56:59], a[40:43], v[120:123], v[56:59]
    v_mfma_f32_16x16x32_bf16 v[60:63], a[44:47], v[120:123], v[60:63]
    s_cbranch_vccnz L_re3
L_rb3:
    v_mfma_f32_16x16x32_bf16 v[48:51], a[48:51], v[124:127], v[48:51]
    buffer_load_dwordx4 v[120:123], v1, s[44:47], 0 offen offset:2048 sc1
    v_mfma_f32_16x16x32_bf16 v[52:55], a[52:55], v[124:127], v[52:55]
    s_waitcnt vmcnt(10)
    v_max3_u32 v47, v128, v129, v130
    v_cmp_u_f32 vcc, v47, v131
    v_mfma_f32_16x16x32_bf16 v[56:59], a[56:59], v[124:127], v[56:59]
    v_mfma_f32_16x16x32_bf16 v[60:63], a[60:63], v[124:127], v[60:63]
    s_cbranch_vccnz L_re4
L_rb4:
    v_mfma_f32_16x16x32_bf16 v[48:51], a[64:67], v[128:131], v[48:51]
    buffer_load_dwordx4 v[124:127], v1, s[44:47], 0 offen offset:3072 sc1
    v_mfma_f32_16x16x32_bf16 v[52:55], a[68:71], v[128:131], v[52:55]
    s_waitcnt vmcnt(10)
    v_max3_u32 v47, v132, v133, v134
    v_cmp_u_f32 vcc, v47, v135
    v_mfma_f32_16x16x32_bf16 v[56:59], a[72:75], v[128:131], v[56:59]
    s_add_u32 s44, s44, 53248
    s_addc_u32 s45, s45, 0
    v_mfma_f32_16x16x32_bf16 v[60:63], a[76:79], v[128:131], v[60:63]
    s_cbranch_vccnz L_re5
L_rb5:
    v_mfma_f32_16x16x32_bf16 v[48:51], a[80:83], v[132:135], v[48:51]
    buffer_load_dwordx4 v[128:131], v1, s[44:47], 0 offen offset:0 sc1
    v_mfma_f32_16x16x32_bf16 v[52:55], a[84:87], v[132:135], v[52:55]
    s_waitcnt vmcnt(10)
    v_max3_u32 v47, v136, v137, v138
    v_cmp_u_f32 vcc, v47, v139
    v_mfma_f32_16x16x32_bf16 v[56:59], a[88:91], v[132:135], v[56:59]
    v_mfma_f32_16x16x32_bf16 v[60:63], a[92:95], v[132:135], v[60:63]
    s_cbranch_vccnz L_re6
L_rb6:
    v_mfma_f32_16x16x32_bf16 v[48:51], a[96:99], v[136:139], v[48:51]
    buffer_load_dwordx4 v[132:135], v1, s[44:47], 0 offen offset:1024 sc1
    v_mfma_f32_16x16x32_bf16 v[52:55], a[100:103], v[136:139], v[52:55]
    s_waitcnt vmcnt(10)
    v_max3_u32 v47, v140, v141, v142
    v_cmp_u_f32 vcc, v47, v143
    v_mfma_f32_16x16x32_bf16 v[56:59], a[104:107], v[136:139], v[56:59]
    v_mfma_f32_16x16x32_bf16 v[60:63], a[108:111], v[136:139], v[60:63]
    s_cbranch_vccnz L_re7
L_rb7:
    v_mfma_f32_16x16x32_bf16 v[48:51], a[112:115], v[140:143], v[48:51]
    buffer_load_dwordx4 v[136:139], v1, s[44:47], 0 offen offset:2048 sc1
    v_mfma_f32_16x16x32_bf16 v[52:55], a[116:119], v[140:143], v[52:55]
    s_waitcnt vmcnt(10)
    v_max3_u32 v47, v144, v145, v146
    v_cmp_u_f32 vcc, v47, v147
    v_mfma_f32_16x16x32_bf16 v[56:59], a[120:123], v[140:143], v[56:59]
    v_mfma_f32_16x16x32_bf16 v[60:63], a[124:127], v[140:143], v[60:63]
    s_cbranch_vccnz L_re8
L_rb8:
    v_mfma_f32_16x16x32_bf16 v[48:51], a[128:131], v[144:147], v[48:51]
    buffer_load_dwordx4 v[140:143], v1, s[44:47], 0 offen offset:3072 sc1
    v_mfma_f32_16x16x32_bf16 v[52:55], a[132:135], v[144:147], v[52:55]
    s_waitcnt vmcnt(10)
    v_max3_u32 v47, v148, v149, v150
    v_cmp_u_f32 vcc, v47, v151
    v_mfma_f32_16x16x32_bf16 v[56:59], a[136:139], v[144:147], v[56:59]
    s_add_u32 s44, s44, 4096
    s_addc_u32 s45, s45, 0
    v_mfma_f32_16x16x32_bf16 v[60:63], a[140:143], v[144:147], v[60:63]
    s_cbranch_vccnz L_re9
L_rb9:
    v_mfma_f32_16x16x32_bf16 v[48:51], a[144:147], v[148:151], v[48:51]
    buffer_load_dwordx4 v[144:147], v1, s[44:47], 0 offen offset:0 sc1
    v_mfma_f32_16x16x32_bf16 v[52:55], a[148:151], v[148:151], v[52:55]
    s_waitcnt vmcnt(10)
    v_max3_u32 v47, v152, v153, v154
    v_cmp_u_f32 vcc, v47, v155
    v_mfma_f32_16x16x32_bf16 v[56:59], a[152:155], v[148:151], v[56:59]
    v_mfma_f32_16x16x32_bf16 v[60:63], a[156:159], v[148:151], v[60:63]
    s_cbranch_vccnz L_re10
L_rb10:
    v_mfma_f32_16x16x32_bf16 v[48:51], a[160:163], v[152:155], v[48:51]
    buffer_load_dword v13, v3, s[40:43], s72 offen sc1
    buffer_load_dwordx4 v[148:151], v1, s[44:47], 0 offen offset:1024 sc1
    v_mfma_f32_16x16x32_bf16 v[52:55], a[164:167], v[152:155], v[52:55]
    s_waitcnt vmcnt(11)
    v_max3_u32 v47, v156, v157, v158
    v_cmp_u_f32 vcc, v47, v159
    v_mfma_f32_16x16x32_bf16 v[56:59], a[168:171], v[152:155], v[56:59]
    v_mfma_f32_16x16x32_bf16 v[60:63], a[172:175], v[152:155], v[60:63]
    s_cbranch_vccnz L_re11
L_rb11:
    v_mfma_f32_16x16x32_bf16 v[48:51], a[176:179], v[156:159], v[48:51]
    buffer_load_dwordx4 v[152:155], v1, s[44:47], 0 offen offset:2048 sc1
    v_mfma_f32_16x16x32_bf16 v[52:55], a[180:183], v[156:159], v[52:55]
    s_waitcnt vmcnt(11)
    v_max3_u32 v47, v112, v113, v114
    v_cmp_u_f32 vcc, v47, v115
    v_mfma_f32_16x16x32_bf16 v[56:59], a[184:187], v[156:159], v[56:59]
    v_mfma_f32_16x16x32_bf16 v[60:63], a[188:191], v[156:159], v[60:63]
    s_cbranch_vccnz L_re12
L_rb12:
    v_mfma_f32_16x16x32_bf16 v[48:51], a[192:195], v[112:115], v[48:51]
    buffer_load_dwordx4 v[156:159], v1, s[44:47], 0 offen offset:3072 sc1
    v_mfma_f32_16x16x32_bf16 v[52:55], a[196:199], v[112:115], v[52:55]
    s_waitcnt vmcnt(11)
    v_max3_u32 v47, v116, v117, v118
    v_cmp_u_f32 vcc, v47, v119
    v_mfma_f32_16x16x32_bf16 v[56:59], a[200:203], v[112:115], v[56:59]
    s_add_u32 s44, s44, 4096
    s_addc_u32 s45, s45, 0
    v_mfma_f32_16x16x32_bf16 v[60:63], a[204:207], v[112:115], v[60:63]
    s_cbranch_vccnz L_re13
L_rb13:
    v_mfma_f32_16x16x32_bf16 v[48:51], a[208:211], v[116:119], v[48:51]
    buffer_load_dwordx4 v[112:115], v1, s[44:47], 0 offen offset:0 sc1
    v_mfma_f32_16x16x32_bf16 v[52:55], a[212:215], v[116:119], v[52:55]
    s_waitcnt vmcnt(11)
    v_max3_u32 v47, v120, v121, v122
    v_cmp_u_f32 vcc, v47, v123
    v_mfma_f32_16x16x32_bf16 v[56:59], a[216:219], v[116:119], v[56:59]
    v_mfma_f32_16x16x32_bf16 v[60:63], a[220:223], v[116:119], v[60:63]
    s_cbranch_vccnz L_re14
L_rb14:
    v_mfma_f32_16x16x32_bf16 v[48:51], a[224:227], v[120:123], v[48:51]
    buffer_load_dwordx4 v[116:119], v1, s[44:47], 0 offen offset:1024 sc1
    v_mfma_f32_16x16x32_bf16 v[52:55], a[228:231], v[120:123], v[52:55]
    s_waitcnt vmcnt(11)
    v_max3_u32 v47, v124, v125, v126
    v_cmp_u_f32 vcc, v47, v127
    v_mfma_f32_16x16x32_bf16 v[56:59], a[232:235], v[120:123], v[56:59]
    v_mfma_f32_16x16x32_bf16 v[60:63], a[236:239], v[120:123], v[60:63]
    s_cbranch_vccnz L_re15
L_rb15:
    v_mfma_f32_16x16x32_bf16 v[48:51], a[240:243], v[124:127], v[48:51]
    buffer_load_dwordx4 v[120:123], v1, s[44:47], 0 offen offset:2048 sc1
    v_mfma_f32_16x16x32_bf16 v[52:55], a[244:247], v[124:127], v[52:55]
    s_waitcnt vmcnt(11)
    v_max3_u32 v47, v128, v129, v130
    v_cmp_u_f32 vcc, v47, v131
    v_mfma_f32_16x16x32_bf16 v[56:59], a[248:251], v[124:127], v[56:59]
    v_mfma_f32_16x16x32_bf16 v[60:63], a[252:255], v[124:127], v[60:63]
    s_cbranch_vccnz L_re16
L_rb16:
    v_mfma_f32_16x16x32_bf16 v[64:67], a[0:3], v[128:131], 0
    buffer_load_dwordx4 v[124:127], v1, s[44:47], 0 offen offset:3072 sc1
    v_mfma_f32_16x16x32_bf16 v[68:71], a[4:7], v[128:131], 0
    s_waitcnt vmcnt(11)
    v_max3_u32 v47, v132, v133, v134
    v_cmp_u_f32 vcc, v47, v135
    v_mfma_f32_16x16x32_bf16 v[72:75], a[8:11], v[128:131], 0
    s_add_u32 s44, s44, 4096
    s_addc_u32 s45, s45, 0
    ds_write_b128 v8, v[48:51] offset:0
    v_mfma_f32_16x16x32_bf16 v[76:79], a[12:15], v[128:131], v[32:35]
    s_cbranch_vccnz L_re17
L_rb17:
    v_mfma_f32_16x16x32_bf16 v[64:67], a[16:19], v[132:135], v[64:67]
    buffer_load_dwordx4 v[128:131], v1, s[44:47], 0 offen offset:0 sc1
    v_mfma_f32_16x16x32_bf16 v[68:71], a[20:23], v[132:135], v[68:71]
    s_waitcnt vmcnt(11)
    v_max3_u32 v47, v136, v137, v138
    v_cmp_u_f32 vcc, v47, v139
    ds_write_b128 v6, v[52:55] offset:0
    v_mfma_f32_16x16x32_bf16 v[72:75], a[24:27], v[132:135], v[72:75]
    v_mfma_f32_16x16x32_bf16 v[76:79], a[28:31], v[132:135], v[76:79]
    s_cbranch_vccnz L_re18
L_rb18:
    v_mfma_f32_16x16x32_bf16 v[64:67], a[32:35], v[136:139], v[64:67]
    buffer_load_dwordx4 v[132:135], v1, s[44:47], 0 offen offset:1024 sc1
    ds_write_b128 v7, v[56:59] offset:0
    v_mfma_f32_16x16x32_bf16 v[68:71], a[36:39], v[136:139], v[68:71]
    s_waitcnt vmcnt(11)
    v_max3_u32 v47, v140, v141, v142
    v_cmp_u_f32 vcc, v47, v143
    v_mfma_f32_16x16x32_bf16 v[72:75], a[40:43], v[136:139], v[72:75]
    v_mfma_f32_16x16x32_bf16 v[76:79], a[44:47], v[136:139], v[76:79]
    s_cbranch_vccnz L_re19
L_rb19:
    v_mfma_f32_16x16x32_bf16 v[64:67], a[48:51], v[140:143], v[64:67]
    buffer_load_dwordx4 v[136:139], v1, s[44:47], 0 offen offset:2048 sc1
    s_waitcnt lgkmcnt(0)
    s_barrier
    v_mfma_f32_16x16x32_bf16 v[68:71], a[52:55], v[140:143], v[68:71]
    s_waitcnt vmcnt(11)
    v_max3_u32 v47, v144, v145, v146
    v_cmp_u_f32 vcc, v47, v147
    ds_read_b128 v[48:51], v9 offset:8192
    v_mfma_f32_16x16x32_bf16 v[72:75], a[56:59], v[140:143], v[72:75]
    ds_read_b128 v[52:55], v9 offset:0
    ds_read_b128 v[56:59], v9 offset:4096
    v_mfma_f32_16x16x32_bf16 v[76:79], a[60:63], v[140:143], v[76:79]
    s_cbranch_vccnz L_re20
L_rb20:
    v_mfma_f32_16x16x32_bf16 v[64:67], a[64:67], v[144:147], v[64:67]
    buffer_load_dwordx4 v[140:143], v1, s[44:47], 0 offen offset:3072 sc1
    v_mfma_f32_16x16x32_bf16 v[68:71], a[68:71], v[144:147], v[68:71]
    s_waitcnt vmcnt(10)
    v_max3_u32 v47, v148, v149, v150
    v_cmp_u_f32 vcc, v47, v151
    v_mfma_f32_16x16x32_bf16 v[72:75], a[72:75], v[144:147], v[72:75]
    s_add_u32 s44, s44, 53248
    s_addc_u32 s45, s45, 0
    v_mfma_f32_16x16x32_bf16 v[76:79], a[76:79], v[144:147], v[76:79]
    s_cbranch_vccnz L_re21
L_rb21:
    s_waitcnt lgkmcnt(0)
    v_mfma_f32_16x16x32_bf16 v[64:67], a[80:83], v[148:151], v[64:67]
    v_cmp_gt_u32 s[70:71], 1, v13
    s_nop 0
    s_cmp_lg_u64 s[70:71], 0
    s_cbranch_scc1 L_late3
L_have3:
    buffer_load_dwordx4 v[144:147], v1, s[44:47], 0 offen offset:0 sc1
    v_add_f32 v60, v60, v48
    v_add_f32 v61, v61, v49
    v_mfma_f32_16x16x32_bf16 v[68:71], a[84:87], v[148:151], v[68:71]
    s_waitcnt vmcnt(10)
    v_max3_u32 v47, v152, v153, v154
    v_cmp_u_f32 vcc, v47, v155
    v_add_f32_e64 v62, v62, v50
    v_mfma_f32_16x16x32_bf16 v[72:75], a[88:91], v[148:151], v[72:75]
    v_add_f32 v63, v63, v51
    v_add_f32 v60, v60, v52
    v_add_f32_e64 v61, v61, v53
    v_mfma_f32_16x16x32_bf16 v[76:79], a[92:95], v[148:151], v[76:79]
    s_cbranch_vccnz L_re22
L_rb22:
    v_add_f32 v62, v62, v54
    v_mfma_f32_16x16x32_bf16 v[64:67], a[96:99], v[152:155], v[64:67]
    buffer_load_dwordx4 v[148:151], v1, s[44:47], 0 offen offset:1024 sc1
    v_add_f32 v63, v63, v55
    v_add_f32 v60, v60, v56
    v_mfma_f32_16x16x32_bf16 v[68:71], a[100:103], v[152:155], v[68:71]
    s_waitcnt vmcnt(10)
    v_max3_u32 v47, v156, v157, v158
    v_cmp_u_f32 vcc, v47, v159
    v_add_f32_e64 v61, v61, v57
    v_mfma_f32_16x16x32_bf16 v[72:75], a[104:107], v[152:155], v[72:75]
    v_add_f32 v62, v62, v58
    v_add_f32 v63, v63, v59
    v_mul_f32_e64 v48, v60, v60
    v_mfma_f32_16x16x32_bf16 v[76:79], a[108:111], v[152:155], v[76:79]
    s_cbranch_vccnz L_re23
L_rb23:
    v_mul_f32 v49, v61, v61
    v_mfma_f32_16x16x32_bf16 v[64:67], a[112:115], v[156:159], v[64:67]
    buffer_load_dwordx4 v[152:155], v1, s[44:47], 0 offen offset:2048 sc1
    v_mul_f32 v50, v62, v62
    v_mul_f32 v51, v63, v63
    v_mfma_f32_16x16x32_bf16 v[68:71], a[116:119], v[156:159], v[68:71]
    s_waitcnt vmcnt(10)
    v_max3_u32 v47, v112, v113, v114
    v_cmp_u_f32 vcc, v47, v115
    v_fma_f32 v48, v48, v4, v14
    v_mfma_f32_16x16x32_bf16 v[72:75], a[120:123], v[156:159], v[72:75]
    v_fma_f32 v49, v49, v4, v14
    v_fma_f32 v50, v50, v4, v14
    v_fma_f32 v51, v51, v4, v14
    v_mfma_f32_16x16x32_bf16 v[76:79], a[124:127], v[156:159], v[76:79]
    s_cbranch_vccnz L_re24
L_rb24:
    v_mul_f32 v48, v48, v60
    v_mfma_f32_16x16x32_bf16 v[64:67], a[128:131], v[112:115], v[64:67]
    buffer_load_dwordx4 v[156:159], v1, s[44:47], 0 offen offset:3072 sc1
    v_mul_f32 v49, v49, v61
    v_mul_f32 v50, v50, v62
    v_mfma_f32_16x16x32_bf16 v[68:71], a[132:135], v[112:115], v[68:71]
    s_waitcnt vmcnt(10)
    v_max3_u32 v47, v116, v117, v118
    v_cmp_u_f32 vcc, v47, v119
    v_mul_f32_e64 v51, v51, v63
    v_mfma_f32_16x16x32_bf16 v[72:75], a[136:139], v[112:115], v[72:75]
    s_add_u32 s44, s44, 4096
    s_addc_u32 s45, s45, 0
    v_exp_f32 v48, v48
    v_mfma_f32_16x16x32_bf16 v[76:79], a[140:143], v[112:115], v[76:79]
    s_cbranch_vccnz L_re25
L_rb25:
    v_exp_f32 v49, v49
    v_mfma_f32_16x16x32_bf16 v[64:67], a[144:147], v[116:119], v[64:67]
    buffer_load_dwordx4 v[112:115], v1, s[44:47], 0 offen offset:0 sc1
    v_exp_f32_e64 v50, v50
    v_mfma_f32_16x16x32_bf16 v[68:71], a[148:151], v[116:119], v[68:71]
    s_waitcnt vmcnt(10)
    v_max3_u32 v47, v120, v121, v122
    v_cmp_u_f32 vcc, v47, v123
    v_exp_f32_e64 v51, v51
    v_mfma_f32_16x16x32_bf16 v[72:75], a[152:155], v[116:119], v[72:75]
    v_add_f32 v48, 1.0, v48
    v_add_f32 v49, 1.0, v49
    v_add_f32_e64 v50, 1.0, v50
    v_mfma_f32_16x16x32_bf16 v[76:79], a[156:159], v[116:119], v[76:79]
    s_cbranch_vccnz L_re26
L_rb26:
    v_add_f32 v51, 1.0, v51
    v_mfma_f32_16x16x32_bf16 v[64:67], a[160:163], v[120:123], v[64:67]
    buffer_load_dwordx4 v[116:119], v1, s[44:47], 0 offen offset:1024 sc1
    v_rcp_f32_e64 v48, v48
    v_mfma_f32_16x16x32_bf16 v[68:71], a[164:167], v[120:123], v[68:71]
    s_waitcnt vmcnt(10)
    v_max3_u32 v47, v124, v125, v126
    v_cmp_u_f32 vcc, v47, v127
    v_rcp_f32_e64 v49, v49
    v_mfma_f32_16x16x32_bf16 v[72:75], a[168:171], v[120:123], v[72:75]
    v_rcp_f32_e64 v50, v50
    v_mfma_f32_16x16x32_bf16 v[76:79], a[172:175], v[120:123], v[76:79]
    s_cbranch_vccnz L_re27
L_rb27:
    v_rcp_f32 v51, v51
    v_mfma_f32_16x16x32_bf16 v[64:67], a[176:179], v[124:127], v[64:67]
    buffer_load_dwordx4 v[120:123], v1, s[44:47], 0 offen offset:2048 sc1
    v_mul_f32 v48, v48, v60
    v_mul_f32 v49, v49, v61
    v_mfma_f32_16x16x32_bf16 v[68:71], a[180:183], v[124:127], v[68:71]
    s_waitcnt vmcnt(10)
    v_max3_u32 v47, v128, v129, v130
    v_cmp_u_f32 vcc, v47, v131
    v_mul_f32_e64 v50, v50, v62
    v_mfma_f32_16x16x32_bf16 v[72:75], a[184:187], v[124:127], v[72:75]
    v_mul_f32_e64 v51, v51, v63
    v_cvt_pk_bf16_f32 v52, v48, v49
    v_cvt_pk_bf16_f32 v54, v48, v49
    v_mfma_f32_16x16x32_bf16 v[76:79], a[188:191], v[124:127], v[76:79]
    s_cbranch_vccnz L_re28
L_rb28:
    v_cvt_pk_bf16_f32 v53, v50, v51
    v_mfma_f32_16x16x32_bf16 v[64:67], a[192:195], v[128:131], v[64:67]
    buffer_load_dwordx4 v[124:127], v1, s[44:47], 0 offen offset:3072 sc1
    v_cvt_pk_bf16_f32 v55, v50, v51
    v_permlane16_swap_b32 v52, v54
    v_mfma_f32_16x16x32_bf16 v[68:71], a[196:199], v[128:131], v[68:71]
    s_waitcnt vmcnt(10)
    v_max3_u32 v47, v132, v133, v134
    v_cmp_u_f32 vcc, v47, v135
    v_permlane16_swap_b32 v53, v55
    v_mfma_f32_16x16x32_bf16 v[72:75], a[200:203], v[128:131], v[72:75]
    s_add_u32 s44, s44, 4096
    s_addc_u32 s45, s45, 0
    buffer_store_dwordx4 v[52:55], v46, s[40:43], s39 offen sc1
    v_mfma_f32_16x16x32_bf16 v[76:79], a[204:207], v[128:131], v[76:79]
    s_cbranch_vccnz L_re29
L_rb29:
    s_add_u32 s39, s39, 57344
    v_mfma_f32_16x16x32_bf16 v[64:67], a[208:211], v[132:135], v[64:67]
    buffer_load_dwordx4 v[128:131], v1, s[44:47], 0 offen offset:0 sc1
    v_mfma_f32_16x16x32_bf16 v[68:71], a[212:215], v[132:135], v[68:71]
    s_waitcnt vmcnt(11)
    v_max3_u32 v47, v136, v137, v138
    v_cmp_u_f32 vcc, v47, v139
    v_mfma_f32_16x16x32_bf16 v[72:75], a[216:219], v[132:135], v[72:75]
    v_mfma_f32_16x16x32_bf16 v[76:79], a[220:223], v[132:135], v[76:79]
    s_cbranch_vccnz L_re30
L_rb30:
    v_mfma_f32_16x16x32_bf16 v[64:67], a[224:227], v[136:139], v[64:67]
    buffer_load_dwordx4 v[132:135], v1, s[44:47], 0 offen offset:1024 sc1
    v_mfma_f32_16x16x32_bf16 v[68:71], a[228:231], v[136:139], v[68:71]
    s_waitcnt vmcnt(11)
    v_max3_u32 v47, v140, v141, v142
    v_cmp_u_f32 vcc, v47, v143
    v_mfma_f32_16x16x32_bf16 v[72:75], a[232:235], v[136:139], v[72:75]
    v_mfma_f32_16x16x32_bf16 v[76:79], a[236:239], v[136:139], v[76:79]
    s_cbranch_vccnz L_re31
L_rb31:
    v_mfma_f32_16x16x32_bf16 v[64:67], a[240:243], v[140:143], v[64:67]
    buffer_load_dwordx4 v[136:139], v1, s[44:47], 0 offen offset:2048 sc1
    v_mfma_f32_16x16x32_bf16 v[68:71], a[244:247], v[140:143], v[68:71]
    v_mfma_f32_16x16x32_bf16 v[72:75], a[248:251], v[140:143], v[72:75]
    v_mfma_f32_16x16x32_bf16 v[76:79], a[252:255], v[140:143], v[76:79]
    s_waitcnt vmcnt(11)
    v_mfma_f32_16x16x32_bf16 v[48:51], a[0:3], v[144:147], 0
    buffer_load_dwordx4 v[140:143], v1, s[44:47], 0 offen offset:3072 sc1
    v_mfma_f32_16x16x32_bf16 v[52:55], a[4:7], v[144:147], 0
    s_add_u32 s44, s44, 4096
    s_addc_u32 s45, s45, 0
    v_mfma_f32_16x16x32_bf16 v[56:59], a[8:11], v[144:147], 0
    ds_write_b128 v8, v[64:67] offset:1024
    v_mfma_f32_16x16x32_bf16 v[60:63], a[12:15], v[144:147], v[32:35]
    s_waitcnt vmcnt(11)
    v_mfma_f32_16x16x32_bf16 v[48:51], a[16:19], v[148:151], v[48:51]
    buffer_load_dwordx4 v[144:147], v1, s[44:47], 0 offen offset:0 sc1
    v_mfma_f32_16x16x32_bf16 v[52:55], a[20:23], v[148:151], v[52:55]
    ds_write_b128 v6, v[68:71] offset:1024
    v_mfma_f32_16x16x32_bf16 v[56:59], a[24:27], v[148:151], v[56:59]
    v_mfma_f32_16x16x32_bf16 v[60:63], a[28:31], v[148:151], v[60:63]
    s_waitcnt vmcnt(11)
    v_mfma_f32_16x16x32_bf16 v[48:51], a[32:35], v[152:155], v[48:51]
    buffer_load_dwordx4 v[148:151], v1, s[44:47], 0 offen offset:1024 sc1
    ds_write_b128 v7, v[72:75] offset:1024
    v_mfma_f32_16x16x32_bf16 v[52:55], a[36:39], v[152:155], v[52:55]
    v_mfma_f32_16x16x32_bf16 v[56:59], a[40:43], v[152:155], v[56:59]
    v_mfma_f32_16x16x32_bf16 v[60:63], a[44:47], v[152:155], v[60:63]
    s_waitcnt vmcnt(11)
    v_mfma_f32_16x16x32_bf16 v[48:51], a[48:51], v[156:159], v[48:51]
    buffer_load_dwordx4 v[152:155], v1, s[44:47], 0 offen offset:2048 sc1
    s_waitcnt lgkmcnt(0)
    s_barrier
    v_mfma_f32_16x16x32_bf16 v[52:55], a[52:55], v[156:159], v[52:55]
    ds_read_b128 v[64:67], v9 offset:9216
    ds_read_b128 v[68:71], v9 offset:1024
    v_mfma_f32_16x16x32_bf16 v[56:59], a[56:59], v[156:159], v[56:59]
    ds_read_b128 v[72:75], v9 offset:5120
    v_mfma_f32_16x16x32_bf16 v[60:63], a[60:63], v[156:159], v[60:63]
    s_waitcnt vmcnt(11)
    v_mfma_f32_16x16x32_bf16 v[48:51], a[64:67], v[112:115], v[48:51]
    buffer_load_dwordx4 v[156:159], v1, s[44:47], 0 offen offset:3072 sc1
    v_mfma_f32_16x16x32_bf16 v[52:55], a[68:71], v[112:115], v[52:55]
    s_add_u32 s44, s44, 53248
    s_addc_u32 s45, s45, 0
    v_mfma_f32_16x16x32_bf16 v[56:59], a[72:75], v[112:115], v[56:59]
    v_mfma_f32_16x16x32_bf16 v[60:63], a[76:79], v[112:115], v[60:63]
    s_waitcnt vmcnt(11)
    s_waitcnt lgkmcnt(0)
    v_add_f32_e64 v76, v76, v64
    v_mfma_f32_16x16x32_bf16 v[48:51], a[80:83], v[116:119], v[48:51]
    buffer_load_dwordx4 v[112:115], v1, s[44:47], 0 offen offset:0 sc1
    v_add_f32_e64 v77, v77, v65
    v_mfma_f32_16x16x32_bf16 v[52:55], a[84:87], v[116:119], v[52:55]
    v_add_f32 v78, v78, v66
    v_add_f32 v79, v79, v67
    v_mfma_f32_16x16x32_bf16 v[56:59], a[88:91], v[116:119], v[56:59]
    v_add_f32 v76, v76, v68
    v_add_f32 v77, v77, v69
    v_mfma_f32_16x16x32_bf16 v[60:63], a[92:95], v[116:119], v[60:63]
    s_waitcnt vmcnt(11)
    v_add_f32 v78, v78, v70
    v_add_f32_e64 v79, v79, v71
    v_mfma_f32_16x16x32_bf16 v[48:51], a[96:99], v[120:123], v[48:51]
    buffer_load_dwordx4 v[116:119], v1, s[44:47], 0 offen offset:1024 sc1
    v_add_f32_e64 v76, v76, v72
    v_mfma_f32_16x16x32_bf16 v[52:55], a[100:103], v[120:123], v[52:55]
    v_add_f32 v77, v77, v73
    v_add_f32 v78, v78, v74
    v_mfma_f32_16x16x32_bf16 v[56:59], a[104:107], v[120:123], v[56:59]
    v_add_f32 v79, v79, v75
    v_mul_f32 v64, v76, v76
    v_mfma_f32_16x16x32_bf16 v[60:63], a[108:111], v[120:123], v[60:63]
    s_waitcnt vmcnt(11)
    v_mul_f32 v65, v77, v77
    v_mul_f32_e64 v66, v78, v78
    v_mfma_f32_16x16x32_bf16 v[48:51], a[112:115], v[124:127], v[48:51]
    buffer_load_dwordx4 v[120:123], v1, s[44:47], 0 offen offset:2048 sc1
    v_mul_f32_e64 v67, v79, v79
    v_mfma_f32_16x16x32_bf16 v[52:55], a[116:119], v[124:127], v[52:55]
    v_fma_f32 v64, v64, v4, v14
    v_fma_f32 v65, v65, v4, v14
    v_mfma_f32_16x16x32_bf16 v[56:59], a[120:123], v[124:127], v[56:59]
    v_fma_f32 v66, v66, v4, v14
    v_fma_f32 v67, v67, v4, v14
    v_mfma_f32_16x16x32_bf16 v[60:63], a[124:127], v[124:127], v[60:63]
    s_waitcnt vmcnt(10)
    v_mul_f32 v64, v64, v76
    v_mul_f32_e64 v65, v65, v77
    v_mfma_f32_16x16x32_bf16 v[48:51], a[128:131], v[128:131], v[48:51]
    buffer_load_dwordx4 v[124:127], v1, s[44:47], 0 offen offset:3072 sc1
    v_mul_f32_e64 v66, v66, v78
    v_mfma_f32_16x16x32_bf16 v[52:55], a[132:135], v[128:131], v[52:55]
    s_add_u32 s44, s44, 4096
    s_addc_u32 s45, s45, 0
    v_mul_f32 v67, v67, v79
    v_mfma_f32_16x16x32_bf16 v[56:59], a[136:139], v[128:131], v[56:59]
    v_exp_f32_e64 v64, v64
    v_mfma_f32_16x16x32_bf16 v[60:63], a[140:143], v[128:131], v[60:63]
    s_waitcnt vmcnt(10)
    v_exp_f32 v65, v65
    v_mfma_f32_16x16x32_bf16 v[48:51], a[144:147], v[132:135], v[48:51]
    buffer_load_dwordx4 v[128:131], v1, s[44:47], 0 offen offset:0 sc1
    v_exp_f32_e64 v66, v66
    v_mfma_f32_16x16x32_bf16 v[52:55], a[148:151], v[132:135], v[52:55]
    v_exp_f32_e64 v67, v67
    v_mfma_f32_16x16x32_bf16 v[56:59], a[152:155], v[132:135], v[56:59]
    v_add_f32 v64, 1.0, v64
    v_add_f32 v65, 1.0, v65
    v_mfma_f32_16x16x32_bf16 v[60:63], a[156:159], v[132:135], v[60:63]
    s_waitcnt vmcnt(10)
    v_add_f32 v66, 1.0, v66
    v_add_f32_e64 v67, 1.0, v67
    v_mfma_f32_16x16x32_bf16 v[48:51], a[160:163], v[136:139], v[48:51]
    buffer_load_dwordx4 v[132:135], v1, s[44:47], 0 offen offset:1024 sc1
    v_rcp_f32_e64 v64, v64
    v_mfma_f32_16x16x32_bf16 v[52:55], a[164:167], v[136:139], v[52:55]
    v_rcp_f32_e64 v65, v65
    v_mfma_f32_16x16x32_bf16 v[56:59], a[168:171], v[136:139], v[56:59]
    v_rcp_f32_e64 v66, v66
    v_mfma_f32_16x16x32_bf16 v[60:63], a[172:175], v[136:139], v[60:63]
    s_waitcnt vmcnt(10)
    v_rcp_f32 v67, v67
    v_mfma_f32_16x16x32_bf16 v[48:51], a[176:179], v[140:143], v[48:51]
    buffer_load_dwordx4 v[136:139], v1, s[44:47], 0 offen offset:2048 sc1
    v_mul_f32_e64 v64, v64, v76
    v_mfma_f32_16x16x32_bf16 v[52:55], a[180:183], v[140:143], v[52:55]
    v_mul_f32 v65, v65, v77
    v_mul_f32 v66, v66, v78
    v_mfma_f32_16x16x32_bf16 v[56:59], a[184:187], v[140:143], v[56:59]
    v_mul_f32_e64 v67, v67, v79
    v_cvt_pk_bf16_f32 v68, v64, v65
    v_mfma_f32_16x16x32_bf16 v[60:63], a[188:191], v[140:143], v[60:63]
    s_waitcnt vmcnt(10)
    v_cvt_pk_bf16_f32 v70, v64, v65
    v_cvt_pk_bf16_f32 v69, v66, v67
    v_mfma_f32_16x16x32_bf16 v[48:51], a[192:195], v[144:147], v[48:51]
    buffer_load_dwordx4 v[140:143], v1, s[44:47], 0 offen offset:3072 sc1
    v_cvt_pk_bf16_f32 v71, v66, v67
    v_mfma_f32_16x16x32_bf16 v[52:55], a[196:199], v[144:147], v[52:55]
    s_add_u32 s44, s44, 4096
    s_addc_u32 s45, s45, 0
    v_permlane16_swap_b32 v68, v70
    v_mfma_f32_16x16x32_bf16 v[56:59], a[200:203], v[144:147], v[56:59]
    v_permlane16_swap_b32 v69, v71
    v_mfma_f32_16x16x32_bf16 v[60:63], a[204:207], v[144:147], v[60:63]
    s_waitcnt vmcnt(10)
    buffer_store_dwordx4 v[68:71], v46, s[40:43], s39 offen sc1
    v_mfma_f32_16x16x32_bf16 v[48:51], a[208:211], v[148:151], v[48:51]
    buffer_load_dwordx4 v[144:147], v1, s[44:47], 0 offen offset:0 sc1
    s_add_u32 s39, s39, 57344
    v_mfma_f32_16x16x32_bf16 v[52:55], a[212:215], v[148:151], v[52:55]
    v_mfma_f32_16x16x32_bf16 v[56:59], a[216:219], v[148:151], v[56:59]
    v_mfma_f32_16x16x32_bf16 v[60:63], a[220:223], v[148:151], v[60:63]
    s_waitcnt vmcnt(11)
    v_mfma_f32_16x16x32_bf16 v[48:51], a[224:227], v[152:155], v[48:51]
    buffer_load_dwordx4 v[148:151], v1, s[44:47], 0 offen offset:1024 sc1
    v_mfma_f32_16x16x32_bf16 v[52:55], a[228:231], v[152:155], v[52:55]
L_ws1_4:
    s_cbranch_execz L_wr1
    v_mfma_f32_16x16x32_bf16 v[56:59], a[232:235], v[152:155], v[56:59]
    v_mfma_f32_16x16x32_bf16 v[60:63], a[236:239], v[152:155], v[60:63]
    s_waitcnt vmcnt(11)
    v_mfma_f32_16x16x32_bf16 v[48:51], a[240:243], v[156:159], v[48:51]
    buffer_load_dwordx4 v[152:155], v1, s[44:47], 0 offen offset:2048 sc1
    v_mfma_f32_16x16x32_bf16 v[52:55], a[244:247], v[156:159], v[52:55]
    v_mfma_f32_16x16x32_bf16 v[56:59], a[248:251], v[156:159], v[56:59]
    v_mfma_f32_16x16x32_bf16 v[60:63], a[252:255], v[156:159], v[60:63]
    s_waitcnt vmcnt(11)
    v_mfma_f32_16x16x32_bf16 v[64:67], a[0:3], v[112:115], 0
    buffer_load_dwordx4 v[156:159], v1, s[44:47], 0 offen offset:3072 sc1
    v_mfma_f32_16x16x32_bf16 v[68:71], a[4:7], v[112:115], 0
    s_add_u32 s44, s44, 4096
    s_addc_u32 s45, s45, 0
    v_mfma_f32_16x16x32_bf16 v[72:75], a[8:11], v[112:115], 0
    ds_write_b128 v8, v[48:51] offset:0
    v_mfma_f32_16x16x32_bf16 v[76:79], a[12:15], v[112:115], v[32:35]
    s_waitcnt vmcnt(11)
    v_mfma_f32_16x16x32_bf16 v[64:67], a[16:19], v[116:119], v[64:67]
    buffer_load_dwordx4 v[112:115], v1, s[44:47], 0 offen offset:0 sc1
    v_mfma_f32_16x16x32_bf16 v[68:71], a[20:23], v[116:119], v[68:71]
    ds_write_b128 v6, v[52:55] offset:0
    v_mfma_f32_16x16x32_bf16 v[72:75], a[24:27], v[116:119], v[72:75]
    v_mfma_f32_16x16x32_bf16 v[76:79], a[28:31], v[116:119], v[76:79]
    s_waitcnt vmcnt(11)
    v_mfma_f32_16x16x32_bf16 v[64:67], a[32:35], v[120:123], v[64:67]
    buffer_load_dwordx4 v[116:119], v1, s[44:47], 0 offen offset:1024 sc1
    ds_write_b128 v7, v[56:59] offset:0
    v_mfma_f32_16x16x32_bf16 v[68:71], a[36:39], v[120:123], v[68:71]
    ds_read_b64_tr_b16 a[0:1], v10 offset:16384
    ds_read_b64_tr_b16 a[2:3], v10 offset:16896
    v_mfma_f32_16x16x32_bf16 v[72:75], a[40:43], v[120:123], v[72:75]
    ds_read_b64_tr_b16 a[4:5], v15 offset:16384
    ds_read_b64_tr_b16 a[6:7], v15 offset:16896
    v_mfma_f32_16x16x32_bf16 v[76:79], a[44:47], v[120:123], v[76:79]
    s_waitcnt vmcnt(11)
    ds_read_b64_tr_b16 a[8:9], v10 offset:16640
    ds_read_b64_tr_b16 a[10:11], v10 offset:17152
    v_mfma_f32_16x16x32_bf16 v[64:67], a[48:51], v[124:127], v[64:67]
    buffer_load_dwordx4 v[120:123], v1, s[44:47], 0 offen offset:2048 sc1
    s_waitcnt lgkmcnt(6)
    s_barrier
    v_mfma_f32_16x16x32_bf16 v[68:71], a[52:55], v[124:127], v[68:71]
    ds_read_b128 v[48:51], v9 offset:8192
    ds_read_b128 v[52:55], v9 offset:0
    v_mfma_f32_16x16x32_bf16 v[72:75], a[56:59], v[124:127], v[72:75]
    ds_read_b128 v[56:59], v9 offset:4096
    v_mfma_f32_16x16x32_bf16 v[76:79], a[60:63], v[124:127], v[76:79]
    s_waitcnt vmcnt(11)
    ds_read_b64_tr_b16 a[12:13], v15 offset:16640
    ds_read_b64_tr_b16 a[14:15], v15 offset:17152
    v_mfma_f32_16x16x32_bf16 v[64:67], a[64:67], v[128:131], v[64:67]
    buffer_load_dwordx4 v[124:127], v1, s[44:47], 0 offen offset:3072 sc1
    v_mfma_f32_16x16x32_bf16 v[68:71], a[68:71], v[128:131], v[68:71]
    s_add_u32 s44, s40, s60
    s_addc_u32 s45, s41, 0
    ds_read_b64_tr_b16 a[16:17], v10 offset:20480
    v_mfma_f32_16x16x32_bf16 v[72:75], a[72:75], v[128:131], v[72:75]
    ds_read_b64_tr_b16 a[18:19], v10 offset:20992
    ds_read_b64_tr_b16 a[20:21], v15 offset:20480
    v_mfma_f32_16x16x32_bf16 v[76:79], a[76:79], v[128:131], v[76:79]
    s_waitcnt vmcnt(11)
    s_waitcnt lgkmcnt(5)
    v_add_f32_e64 v60, v60, v48
    v_mfma_f32_16x16x32_bf16 v[64:67], a[80:83], v[132:135], v[64:67]
    buffer_load_dwordx4 v[128:131], v1, s[44:47], 0 offen offset:0 sc1
    v_add_f32_e64 v61, v61, v49
    v_mfma_f32_16x16x32_bf16 v[68:71], a[84:87], v[132:135], v[68:71]
    v_add_f32 v62, v62, v50
    v_add_f32 v63, v63, v51
    v_mfma_f32_16x16x32_bf16 v[72:75], a[88:91], v[132:135], v[72:75]
    v_add_f32 v60, v60, v52
    v_add_f32 v61, v61, v53
    v_mfma_f32_16x16x32_bf16 v[76:79], a[92:95], v[132:135], v[76:79]
    s_waitcnt vmcnt(11)
    v_add_f32 v62, v62, v54
    v_add_f32_e64 v63, v63, v55
    v_mfma_f32_16x16x32_bf16 v[64:67], a[96:99], v[136:139], v[64:67]
    buffer_load_dwordx4 v[132:135], v1, s[44:47], 0 offen offset:1024 sc1
    v_add_f32_e64 v60, v60, v56
    v_mfma_f32_16x16x32_bf16 v[68:71], a[100:103], v[136:139], v[68:71]
    v_add_f32 v61, v61, v57
    v_add_f32 v62, v62, v58
    v_mfma_f32_16x16x32_bf16 v[72:75], a[104:107], v[136:139], v[72:75]
    v_add_f32 v63, v63, v59
    v_mul_f32 v48, v60, v60
    v_mfma_f32_16x16x32_bf16 v[76:79], a[108:111], v[136:139], v[76:79]
    s_waitcnt vmcnt(11)
    v_mul_f32 v49, v61, v61
    v_mul_f32_e64 v50, v62, v62
    v_mfma_f32_16x16x32_bf16 v[64:67], a[112:115], v[140:143], v[64:67]
    buffer_load_dwordx4 v[136:139], v1, s[44:47], 0 offen offset:2048 sc1
    v_mul_f32_e64 v51, v63, v63
    v_mfma_f32_16x16x32_bf16 v[68:71], a[116:119], v[140:143], v[68:71]
    v_fma_f32 v48, v48, v4, v14
    v_fma_f32 v49, v49, v4, v14
    v_mfma_f32_16x16x32_bf16 v[72:75], a[120:123], v[140:143], v[72:75]
    v_fma_f32 v50, v50, v4, v14
    v_fma_f32 v51, v51, v4, v14
    v_mfma_f32_16x16x32_bf16 v[76:79], a[124:127], v[140:143], v[76:79]
    s_waitcnt vmcnt(10)
    v_mul_f32 v48, v48, v60
    v_mul_f32_e64 v49, v49, v61
    v_mfma_f32_16x16x32_bf16 v[64:67], a[128:131], v[144:147], v[64:67]
    buffer_load_dwordx4 v[140:143], v1, s[44:47], 0 offen offset:3072 sc1
    v_mul_f32_e64 v50, v50, v62
    v_mfma_f32_16x16x32_bf16 v[68:71], a[132:135], v[144:147], v[68:71]
    s_add_u32 s44, s44, 4096
    s_addc_u32 s45, s45, 0
    v_mul_f32 v51, v51, v63
    v_mfma_f32_16x16x32_bf16 v[72:75], a[136:139], v[144:147], v[72:75]
    v_exp_f32_e64 v48, v48
    v_mfma_f32_16x16x32_bf16 v[76:79], a[140:143], v[144:147], v[76:79]
    s_waitcnt vmcnt(10)
    v_exp_f32 v49, v49
    v_mfma_f32_16x16x32_bf16 v[64:67], a[144:147], v[148:151], v[64:67]
    buffer_load_dwordx4 v[144:147], v1, s[44:47], 0 offen offset:0 sc1
    v_exp_f32_e64 v50, v50
    v_mfma_f32_16x16x32_bf16 v[68:71], a[148:151], v[148:151], v[68:71]
    v_exp_f32_e64 v51, v51
    v_mfma_f32_16x16x32_bf16 v[72:75], a[152:155], v[148:151], v[72:75]
    v_add_f32 v48, 1.0, v48
    v_add_f32 v49, 1.0, v49
    v_mfma_f32_16x16x32_bf16 v[76:79], a[156:159], v[148:151], v[76:79]
    s_waitcnt vmcnt(10)
    v_add_f32 v50, 1.0, v50
    v_add_f32_e64 v51, 1.0, v51
    v_mfma_f32_16x16x32_bf16 v[64:67], a[160:163], v[152:155], v[64:67]
    buffer_load_dwordx4 v[148:151], v1, s[44:47], 0 offen offset:1024 sc1
    v_rcp_f32_e64 v48, v48
    v_mfma_f32_16x16x32_bf16 v[68:71], a[164:167], v[152:155], v[68:71]
    v_rcp_f32_e64 v49, v49
    v_mfma_f32_16x16x32_bf16 v[72:75], a[168:171], v[152:155], v[72:75]
    v_rcp_f32_e64 v50, v50
    v_mfma_f32_16x16x32_bf16 v[76:79], a[172:175], v[152:155], v[76:79]
    s_waitcnt vmcnt(10)
    v_rcp_f32 v51, v51
    v_mfma_f32_16x16x32_bf16 v[64:67], a[176:179], v[156:159], v[64:67]
    buffer_load_dwordx4 v[152:155], v1, s[44:47], 0 offen offset:2048 sc1
    v_mul_f32_e64 v48, v48, v60
    v_mfma_f32_16x16x32_bf16 v[68:71], a[180:183], v[156:159], v[68:71]
    v_mul_f32 v49, v49, v61
    v_mul_f32 v50, v50, v62
    v_mfma_f32_16x16x32_bf16 v[72:75], a[184:187], v[156:159], v[72:75]
    v_mul_f32_e64 v51, v51, v63
    v_cvt_pk_bf16_f32 v52, v48, v49
    v_mfma_f32_16x16x32_bf16 v[76:79], a[188:191], v[156:159], v[76:79]
    s_waitcnt vmcnt(10)
    v_cvt_pk_bf16_f32 v54, v48, v49
    v_cvt_pk_bf16_f32 v53, v50, v51
    v_mfma_f32_16x16x32_bf16 v[64:67], a[192:195], v[112:115], v[64:67]
    buffer_load_dwordx4 v[156:159], v1, s[44:47], 0 offen offset:3072 sc1
    v_cvt_pk_bf16_f32 v55, v50, v51
    v_mfma_f32_16x16x32_bf16 v[68:71], a[196:199], v[112:115], v[68:71]
    s_add_u32 s44, s44, 4096
    s_addc_u32 s45, s45, 0
    v_permlane16_swap_b32 v52, v54
    v_mfma_f32_16x16x32_bf16 v[72:75], a[200:203], v[112:115], v[72:75]
    v_permlane16_swap_b32 v53, v55
    v_mfma_f32_16x16x32_bf16 v[76:79], a[204:207], v[112:115], v[76:79]
    s_waitcnt vmcnt(10)
    buffer_store_dwordx4 v[52:55], v46, s[40:43], s39 offen sc1
    v_mfma_f32_16x16x32_bf16 v[64:67], a[208:211], v[116:119], v[64:67]
    buffer_load_dwordx4 v[112:115], v1, s[44:47], 0 offen offset:0 sc1
    s_add_u32 s39, s39, 57344
    v_mfma_f32_16x16x32_bf16 v[68:71], a[212:215], v[116:119], v[68:71]
    ds_read_b64_tr_b16 a[22:23], v15 offset:20992
    ds_read_b64_tr_b16 a[24:25], v10 offset:20736
    v_mfma_f32_16x16x32_bf16 v[72:75], a[216:219], v[116:119], v[72:75]
    ds_read_b64_tr_b16 a[26:27], v10 offset:21248
    ds_read_b64_tr_b16 a[28:29], v15 offset:20736
    v_mfma_f32_16x16x32_bf16 v[76:79], a[220:223], v[116:119], v[76:79]
    s_waitcnt vmcnt(11)
    ds_read_b64_tr_b16 a[30:31], v15 offset:21248
    v_mfma_f32_16x16x32_bf16 v[64:67], a[224:227], v[120:123], v[64:67]
    buffer_load_dwordx4 v[116:119], v1, s[44:47], 0 offen offset:1024 sc1
    ds_read_b64_tr_b16 a[32:33], v10 offset:0
    v_mfma_f32_16x16x32_bf16 v[68:71], a[228:231], v[120:123], v[68:71]
    ds_read_b64_tr_b16 a[34:35], v10 offset:512
    ds_read_b64_tr_b16 a[36:37], v15 offset:0
    v_mfma_f32_16x16x32_bf16 v[72:75], a[232:235], v[120:123], v[72:75]
    ds_read_b64_tr_b16 a[38:39], v15 offset:512
    ds_read_b64_tr_b16 a[40:41], v10 offset:256
    v_mfma_f32_16x16x32_bf16 v[76:79], a[236:239], v[120:123], v[76:79]
    s_waitcnt vmcnt(11)
    ds_read_b64_tr_b16 a[42:43], v10 offset:768
    ds_read_b64_tr_b16 a[44:45], v15 offset:256
    v_mfma_f32_16x16x32_bf16 v[64:67], a[240:243], v[124:127], v[64:67]
    buffer_load_dwordx4 v[120:123], v1, s[44:47], 0 offen offset:2048 sc1
    ds_read_b64_tr_b16 a[46:47], v15 offset:768
    v_mfma_f32_16x16x32_bf16 v[68:71], a[244:247], v[124:127], v[68:71]
    s_waitcnt vmcnt(11)
    v_max3_u32 v47, v128, v129, v130
    v_cmp_u_f32 vcc, v47, v131
    v_mfma_f32_16x16x32_bf16 v[72:75], a[248:251], v[124:127], v[72:75]
    ds_read_b64_tr_b16 a[48:49], v10 offset:4096
    ds_read_b64_tr_b16 a[50:51], v10 offset:4608
    v_mfma_f32_16x16x32_bf16 v[76:79], a[252:255], v[124:127], v[76:79]
    s_cbranch_vccnz L_re64
L_rb64:
    v_mfma_f32_16x16x32_bf16 v[48:51], v[128:131], v[160:163], 0
    buffer_load_dwordx4 v[124:127], v1, s[44:47], 0 offen offset:3072 sc1
    ds_read_b64_tr_b16 a[52:53], v15 offset:4096
    ds_read_b64_tr_b16 a[54:55], v15 offset:4608
    ds_read_b64_tr_b16 a[56:57], v10 offset:4352
    v_mfma_f32_16x16x32_bf16 v[52:55], v[128:131], v[164:167], 0
    s_waitcnt vmcnt(11)
    v_max3_u32 v47, v132, v133, v134
    v_cmp_u_f32 vcc, v47, v135
    ds_read_b64_tr_b16 a[58:59], v10 offset:4864
    ds_read_b64_tr_b16 a[60:61], v15 offset:4352
    v_mfma_f32_16x16x32_bf16 v[56:59], v[128:131], v[168:171], 0
    s_add_u32 s44, s44, 4096
    s_addc_u32 s45, s45, 0
    ds_write_b128 v8, v[64:67] offset:1024
    v_mfma_f32_16x16x32_bf16 v[16:19], v[128:131], v[172:175], v[16:19]
    s_cbranch_vccnz L_re65
L_rb65:
    ds_read_b64_tr_b16 a[62:63], v15 offset:4864
    v_mfma_f32_16x16x32_bf16 v[48:51], v[132:135], v[176:179], v[48:51]
    buffer_load_dwordx4 v[128:131], v1, s[44:47], 0 offen offset:0 sc1
    ds_read_b64_tr_b16 a[64:65], v10 offset:8192
    ds_read_b64_tr_b16 a[66:67], v10 offset:8704
    ds_read_b64_tr_b16 a[68:69], v15 offset:8192
    v_mfma_f32_16x16x32_bf16 v[52:55], v[132:135], v[180:183], v[52:55]
    s_waitcnt vmcnt(11)
    v_max3_u32 v47, v136, v137, v138
    v_cmp_u_f32 vcc, v47, v139
    ds_write_b128 v6, v[68:71] offset:1024
    v_mfma_f32_16x16x32_bf16 v[56:59], v[132:135], v[184:187], v[56:59]
    ds_read_b64_tr_b16 a[70:71], v15 offset:8704
    ds_read_b64_tr_b16 a[72:73], v10 offset:8448
    ds_read_b64_tr_b16 a[74:75], v10 offset:8960
    ds_read_b64_tr_b16 a[76:77], v15 offset:8448
    v_mfma_f32_16x16x32_bf16 v[16:19], v[132:135], v[188:191], v[16:19]
    s_cbranch_vccnz L_re66
L_rb66:
    ds_read_b64_tr_b16 a[78:79], v15 offset:8960
    v_mfma_f32_16x16x32_bf16 v[48:51], v[136:139], v[192:195], v[48:51]
    buffer_load_dwordx4 v[132:135], v1, s[44:47], 0 offen offset:1024 sc1
    ds_write_b128 v7, v[72:75] offset:1024
    v_mfma_f32_16x16x32_bf16 v[52:55], v[136:139], v[196:199], v[52:55]
    s_waitcnt vmcnt(11)
    v_max3_u32 v47, v140, v141, v142
    v_cmp_u_f32 vcc, v47, v143
    ds_read_b64_tr_b16 a[80:81], v10 offset:12288
    ds_read_b64_tr_b16 a[82:83], v10 offset:12800
    v_mfma_f32_16x16x32_bf16 v[56:59], v[136:139], v[200:203], v[56:59]
    s_add_u32 s44, s44, 45056
    s_addc_u32 s45, s45, 0
    ds_read_b64_tr_b16 a[84:85], v15 offset:12288
    ds_read_b64_tr_b16 a[86:87], v15 offset:12800
    ds_read_b64_tr_b16 a[88:89], v10 offset:12544
    v_mfma_f32_16x16x32_bf16 v[16:19], v[136:139], v[204:207], v[16:19]
    s_cbranch_vccnz L_re67
L_rb67:
    ds_read_b64_tr_b16 a[90:91], v10 offset:13056
    ds_read_b64_tr_b16 a[92:93], v15 offset:12544
    v_mfma_f32_16x16x32_bf16 v[48:51], v[140:143], v[208:211], v[48:51]
    buffer_load_dwordx4 v[136:139], v1, s[44:47], 0 offen offset:0 sc1
    s_waitcnt lgkmcnt(7)
    s_barrier
    ds_read_b128 v[64:67], v9 offset:9216
    v_mfma_f32_16x16x32_bf16 v[52:55], v[140:143], v[212:215], v[52:55]
    s_waitcnt vmcnt(11)
    v_max3_u32 v47, v144, v145, v146
    v_cmp_u_f32 vcc, v47, v147
    ds_read_b128 v[68:71], v9 offset:1024
    ds_read_b128 v[72:75], v9 offset:5120
    v_mfma_f32_16x16x32_bf16 v[56:59], v[140:143], v[216:219], v[56:59]
    ds_read_b64_tr_b16 a[94:95], v15 offset:13056
    v_mfma_f32_16x16x32_bf16 v[16:19], v[140:143], v[220:223], v[16:19]
    s_cbranch_vccnz L_re68
L_rb68:
    v_mfma_f32_16x16x32_bf16 v[48:51], v[144:147], v[224:227], v[48:51]
    buffer_load_dwordx4 v[140:143], v1, s[44:47], 0 offen offset:1024 sc1
    v_mfma_f32_16x16x32_bf16 v[52:55], v[144:147], v[228:231], v[52:55]
    s_waitcnt vmcnt(11)
    v_max3_u32 v47, v148, v149, v150
    v_cmp_u_f32 vcc, v47, v151
    v_mfma_f32_16x16x32_bf16 v[56:59], v[144:147], v[232:235], v[56:59]
    s_waitcnt lgkmcnt(1)
    v_add_f32 v76, v76, v64
    v_add_f32 v77, v77, v65
    v_add_f32 v78, v78, v66
    v_add_f32_e64 v79, v79, v67
    v_mfma_f32_16x16x32_bf16 v[16:19], v[144:147], v[236:239], v[16:19]
    s_cbranch_vccnz L_re69
L_rb69:
    v_add_f32 v76, v76, v68
    v_add_f32_e64 v77, v77, v69
    v_mfma_f32_16x16x32_bf16 v[48:51], v[148:151], v[240:243], v[48:51]
    buffer_load_dwordx4 v[144:147], v1, s[44:47], 0 offen offset:2048 sc1
    v_add_f32 v78, v78, v70
    v_add_f32 v79, v79, v71
    v_add_f32_e64 v76, v76, v72
    v_mfma_f32_16x16x32_bf16 v[52:55], v[148:151], v[244:247], v[52:55]
    s_waitcnt vmcnt(11)
    v_max3_u32 v47, v152, v153, v154
    v_cmp_u_f32 vcc, v47, v155
    v_add_f32 v77, v77, v73
    v_add_f32 v78, v78, v74
    v_mfma_f32_16x16x32_bf16 v[56:59], v[148:151], v[248:251], v[56:59]
    v_add_f32 v79, v79, v75
    v_mul_f32 v64, v76, v76
    v_mul_f32 v65, v77, v77
    v_mul_f32 v66, v78, v78
    v_mfma_f32_16x16x32_bf16 v[16:19], v[148:151], v[252:255], v[16:19]
    s_cbranch_vccnz L_re70
L_rb70:
    v_mul_f32 v67, v79, v79
    v_fma_f32 v64, v64, v4, v14
    v_mfma_f32_16x16x32_bf16 v[48:51], v[152:155], v[80:83], v[48:51]
    buffer_load_dwordx4 v[148:151], v1, s[44:47], 0 offen offset:3072 sc1
    v_fma_f32 v65, v65, v4, v14
    v_fma_f32 v66, v66, v4, v14
    v_fma_f32 v67, v67, v4, v14
    v_mfma_f32_16x16x32_bf16 v[52:55], v[152:155], v[84:87], v[52:55]
    s_waitcnt vmcnt(11)
    v_max3_u32 v47, v156, v157, v158
    v_cmp_u_f32 vcc, v47, v159
    v_mul_f32 v64, v64, v76
    v_mul_f32 v65, v65, v77
    v_mfma_f32_16x16x32_bf16 v[56:59], v[152:155], v[88:91], v[56:59]
    s_add_u32 s44, s44, 4096
    s_addc_u32 s45, s45, 0
    v_mul_f32 v66, v66, v78
    v_mul_f32_e64 v67, v67, v79
    v_mfma_f32_16x16x32_bf16 v[16:19], v[152:155], v[92:95], v[16:19]
    s_cbranch_vccnz L_re71
L_rb71:
    v_exp_f32 v64, v64
    v_mfma_f32_16x16x32_bf16 v[48:51], v[156:159], v[96:99], v[48:51]
    buffer_load_dwordx4 v[152:155], v1, s[44:47], 0 offen offset:0 sc1
    v_exp_f32_e64 v65, v65
    v_mfma_f32_16x16x32_bf16 v[52:55], v[156:159], v[100:103], v[52:55]
    s_waitcnt vmcnt(10)
    v_max3_u32 v47, v112, v113, v114
    v_cmp_u_f32 vcc, v47, v115
    v_exp_f32_e64 v66, v66
    v_mfma_f32_16x16x32_bf16 v[56:59], v[156:159], v[104:107], v[56:59]
    v_exp_f32 v67, v67
    v_add_f32 v64, 1.0, v64
    v_add_f32_e64 v65, 1.0, v65
    v_mfma_f32_16x16x32_bf16 v[16:19], v[156:159], v[108:111], v[16:19]
    s_cbranch_vccnz L_re72
L_rb72:
    v_add_f32 v66, 1.0, v66
    v_add_f32_e64 v67, 1.0, v67
    v_mfma_f32_16x16x32_bf16 v[48:51], v[112:115], a[0:3], v[48:51]
    buffer_load_dwordx4 v[156:159], v1, s[44:47], 0 offen offset:1024 sc1
    v_rcp_f32_e64 v64, v64
    v_mfma_f32_16x16x32_bf16 v[52:55], v[112:115], a[4:7], v[52:55]
    s_waitcnt vmcnt(10)
    v_max3_u32 v47, v116, v117, v118
    v_cmp_u_f32 vcc, v47, v119
    v_rcp_f32_e64 v65, v65
    v_mfma_f32_16x16x32_bf16 v[56:59], v[112:115], a[8:11], v[56:59]
    v_rcp_f32 v66, v66
    v_rcp_f32 v67, v67
    v_mfma_f32_16x16x32_bf16 v[16:19], v[112:115], a[12:15], v[16:19]
    s_cbranch_vccnz L_re73
L_rb73:
    v_mul_f32 v64, v64, v76
    v_mul_f32_e64 v65, v65, v77
    v_mfma_f32_16x16x32_bf16 v[48:51], v[116:119], a[16:19], v[48:51]
    buffer_load_dwordx4 v[112:115], v1, s[44:47], 0 offen offset:2048 sc1
    v_mul_f32 v66, v66, v78
    v_mul_f32 v67, v67, v79
    v_cvt_pk_bf16_f32 v68, v64, v65
    v_mfma_f32_16x16x32_bf16 v[52:55], v[116:119], a[20:23], v[52:55]
    s_waitcnt vmcnt(10)
    v_max3_u32 v47, v120, v121, v122
    v_cmp_u_f32 vcc, v47, v123
    v_cvt_pk_bf16_f32 v70, v64, v65
    v_cvt_pk_bf16_f32 v69, v66, v67
    v_mfma_f32_16x16x32_bf16 v[56:59], v[116:119], a[24:27], v[56:59]
    v_cvt_pk_bf16_f32 v71, v66, v67
    v_permlane16_swap_b32 v68, v70
    s_nop 0
    v_permlane16_swap_b32 v69, v71
    v_mfma_f32_16x16x32_bf16 v[16:19], v[116:119], a[28:31], v[16:19]
    s_cbranch_vccnz L_re74
L_rb74:
    buffer_store_dwordx4 v[68:71], v46, s[40:43], s39 offen sc1
    v_mfma_f32_16x16x32_bf16 v[48:51], v[120:123], a[32:35], v[48:51]
    buffer_load_dwordx4 v[116:119], v1, s[44:47], 0 offen offset:3072 sc1
    s_add_u32 s39, s39, 57344
    v_mfma_f32_16x16x32_bf16 v[52:55], v[120:123], a[36:39], v[52:55]
    s_waitcnt vmcnt(11)
    v_max3_u32 v47, v124, v125, v126
    v_cmp_u_f32 vcc, v47, v127
    v_mfma_f32_16x16x32_bf16 v[56:59], v[120:123], a[40:43], v[56:59]
    s_add_u32 s44, s44, 4096
    s_addc_u32 s45, s45, 0
    v_mfma_f32_16x16x32_bf16 v[16:19], v[120:123], a[44:47], v[16:19]
    s_cbranch_vccnz L_re75
L_rb75:
    v_mfma_f32_16x16x32_bf16 v[48:51], v[124:127], a[48:51], v[48:51]
    buffer_load_dwordx4 v[120:123], v1, s[44:47], 0 offen offset:0 sc1
    v_mfma_f32_16x16x32_bf16 v[52:55], v[124:127], a[52:55], v[52:55]
    s_waitcnt vmcnt(11)
    v_max3_u32 v47, v128, v129, v130
    v_cmp_u_f32 vcc, v47, v131
    v_mfma_f32_16x16x32_bf16 v[56:59], v[124:127], a[56:59], v[56:59]
    v_mfma_f32_16x16x32_bf16 v[16:19], v[124:127], a[60:63], v[16:19]
    s_cbranch_vccnz L_re76
L_rb76:
    v_mfma_f32_16x16x32_bf16 v[48:51], v[128:131], a[64:67], v[48:51]
    buffer_load_dwordx4 v[124:127], v1, s[44:47], 0 offen offset:1024 sc1
    v_mfma_f32_16x16x32_bf16 v[52:55], v[128:131], a[68:71], v[52:55]
    s_waitcnt vmcnt(11)
    v_max3_u32 v47, v132, v133, v134
    v_cmp_u_f32 vcc, v47, v135
    v_mfma_f32_16x16x32_bf16 v[56:59], v[128:131], a[72:75], v[56:59]
    v_mfma_f32_16x16x32_bf16 v[16:19], v[128:131], a[76:79], v[16:19]
    s_cbranch_vccnz L_re77
L_rb77:
    s_waitcnt lgkmcnt(0)
    v_mfma_f32_16x16x32_bf16 v[48:51], v[132:135], a[80:83], v[48:51]
    buffer_load_dwordx4 v[128:131], v1, s[44:47], 0 offen offset:2048 sc1
    v_mfma_f32_16x16x32_bf16 v[52:55], v[132:135], a[84:87], v[52:55]
    s_waitcnt vmcnt(11)
    v_max3_u32 v47, v136, v137, v138
    v_cmp_u_f32 vcc, v47, v139
    v_mfma_f32_16x16x32_bf16 v[56:59], v[132:135], a[88:91], v[56:59]
    v_mfma_f32_16x16x32_bf16 v[16:19], v[132:135], a[92:95], v[16:19]
    s_cbranch_vccnz L_re78
L_rb78:
    v_mfma_f32_16x16x32_bf16 v[64:67], v[136:139], v[160:163], 0
    buffer_load_dwordx4 v[132:135], v1, s[44:47], 0 offen offset:3072 sc1
    v_mfma_f32_16x16x32_bf16 v[68:71], v[136:139], v[164:167], 0
    s_waitcnt vmcnt(11)
    v_max3_u32 v47, v140, v141, v142
    v_cmp_u_f32 vcc, v47, v143
    v_mfma_f32_16x16x32_bf16 v[72:75], v[136:139], v[168:171], 0
    s_add_u32 s44, s44, 4096
    s_addc_u32 s45, s45, 0
    ds_write_b128 v8, v[48:51] offset:0
    v_mfma_f32_16x16x32_bf16 v[20:23], v[136:139], v[172:175], v[20:23]
    s_cbranch_vccnz L_re79
L_rb79:
    v_mfma_f32_16x16x32_bf16 v[64:67], v[140:143], v[176:179], v[64:67]
    buffer_load_dwordx4 v[136:139], v1, s[44:47], 0 offen offset:0 sc1
    v_mfma_f32_16x16x32_bf16 v[68:71], v[140:143], v[180:183], v[68:71]
    s_waitcnt vmcnt(11)
    v_max3_u32 v47, v144, v145, v146
    v_cmp_u_f32 vcc, v47, v147
    v_mfma_f32_16x16x32_bf16 v[72:75], v[140:143], v[184:187], v[72:75]
    ds_write_b128 v6, v[52:55] offset:0
    v_mfma_f32_16x16x32_bf16 v[20:23], v[140:143], v[188:191], v[20:23]
    s_cbranch_vccnz L_re80
L_rb80:
    v_mfma_f32_16x16x32_bf16 v[64:67], v[144:147], v[192:195], v[64:67]
    buffer_load_dwordx4 v[140:143], v1, s[44:47], 0 offen offset:1024 sc1
    v_mfma_f32_16x16x32_bf16 v[68:71], v[144:147], v[196:199], v[68:71]
    s_waitcnt vmcnt(11)
    v_max3_u32 v47, v148, v149, v150
    v_cmp_u_f32 vcc, v47, v151
    v_mfma_f32_16x16x32_bf16 v[72:75], v[144:147], v[200:203], v[72:75]
    s_add_u32 s44, s44, 45056
    s_addc_u32 s45, s45, 0
    ds_write_b128 v7, v[56:59] offset:0
    v_mfma_f32_16x16x32_bf16 v[20:23], v[144:147], v[204:207], v[20:23]
    s_cbranch_vccnz L_re81
L_rb81:
    v_mfma_f32_16x16x32_bf16 v[64:67], v[148:151], v[208:211], v[64:67]
    buffer_load_dwordx4 v[144:147], v1, s[44:47], 0 offen offset:0 sc1
    v_mfma_f32_16x16x32_bf16 v[68:71], v[148:151], v[212:215], v[68:71]
    s_waitcnt vmcnt(11)
    v_max3_u32 v47, v152, v153, v154
    v_cmp_u_f32 vcc, v47, v155
    v_mfma_f32_16x16x32_bf16 v[72:75], v[148:151], v[216:219], v[72:75]
    s_waitcnt lgkmcnt(0)
    s_barrier
    v_mfma_f32_16x16x32_bf16 v[20:23], v[148:151], v[220:223], v[20:23]
    s_cbranch_vccnz L_re82
L_rb82:
    v_mfma_f32_16x16x32_bf16 v[64:67], v[152:155], v[224:227], v[64:67]
    buffer_load_dwordx4 v[148:151], v1, s[44:47], 0 offen offset:1024 sc1
    ds_read_b128 v[48:51], v9 offset:8192
    v_mfma_f32_16x16x32_bf16 v[68:71], v[152:155], v[228:231], v[68:71]
    s_waitcnt vmcnt(11)
    v_max3_u32 v47, v156, v157, v158
    v_cmp_u_f32 vcc, v47, v159
    v_mfma_f32_16x16x32_bf16 v[72:75], v[152:155], v[232:235], v[72:75]
    ds_read_b128 v[52:55], v9 offset:0
    ds_read_b128 v[56:59], v9 offset:4096
    v_mfma_f32_16x16x32_bf16 v[20:23], v[152:155], v[236:239], v[20:23]
    s_cbranch_vccnz L_re83
L_rb83:
    v_mfma_f32_16x16x32_bf16 v[64:67], v[156:159], v[240:243], v[64:67]
    buffer_load_dwordx4 v[152:155], v1, s[44:47], 0 offen offset:2048 sc1
    v_mfma_f32_16x16x32_bf16 v[68:71], v[156:159], v[244:247], v[68:71]
    s_waitcnt vmcnt(11)
    v_max3_u32 v47, v112, v113, v114
    v_cmp_u_f32 vcc, v47, v115
    v_mfma_f32_16x16x32_bf16 v[72:75], v[156:159], v[248:251], v[72:75]
    v_mfma_f32_16x16x32_bf16 v[20:23], v[156:159], v[252:255], v[20:23]
    s_cbranch_vccnz L_re84
L_rb84:
    v_mfma_f32_16x16x32_bf16 v[64:67], v[112:115], v[80:83], v[64:67]
    buffer_load_dwordx4 v[156:159], v1, s[44:47], 0 offen offset:3072 sc1
    s_waitcnt lgkmcnt(0)
    v_mfma_f32_16x16x32_bf16 v[68:71], v[112:115], v[84:87], v[68:71]
    s_waitcnt vmcnt(10)
    v_max3_u32 v47, v116, v117, v118
    v_cmp_u_f32 vcc, v47, v119
    v_mfma_f32_16x16x32_bf16 v[72:75], v[112:115], v[88:91], v[72:75]
    s_add_u32 s44, s44, 4096
    s_addc_u32 s45, s45, 0
    v_add_f32_e64 v16, v16, v48
    v_mfma_f32_16x16x32_bf16 v[20:23], v[112:115], v[92:95], v[20:23]
    s_cbranch_vccnz L_re85
L_rb85:
    v_mfma_f32_16x16x32_bf16 v[64:67], v[116:119], v[96:99], v[64:67]
    buffer_load_dwordx4 v[112:115], v1, s[44:47], 0 offen offset:0 sc1
    v_add_f32 v17, v17, v49
    v_mfma_f32_16x16x32_bf16 v[68:71], v[116:119], v[100:103], v[68:71]
    s_waitcnt vmcnt(10)
    v_max3_u32 v47, v120, v121, v122
    v_cmp_u_f32 vcc, v47, v123
    v_mfma_f32_16x16x32_bf16 v[72:75], v[116:119], v[104:107], v[72:75]
    v_add_f32 v18, v18, v50
    v_add_f32 v19, v19, v51
    v_mfma_f32_16x16x32_bf16 v[20:23], v[116:119], v[108:111], v[20:23]
    s_cbranch_vccnz L_re86
L_rb86:
    v_mfma_f32_16x16x32_bf16 v[64:67], v[120:123], a[0:3], v[64:67]
    buffer_load_dwordx4 v[116:119], v1, s[44:47], 0 offen offset:1024 sc1
    v_add_f32 v16, v16, v52
    v_mfma_f32_16x16x32_bf16 v[68:71], v[120:123], a[4:7], v[68:71]
    s_waitcnt vmcnt(10)
    v_max3_u32 v47, v124, v125, v126
    v_cmp_u_f32 vcc, v47, v127
    v_mfma_f32_16x16x32_bf16 v[72:75], v[120:123], a[8:11], v[72:75]
    v_add_f32 v17, v17, v53
    v_add_f32 v18, v18, v54
    v_mfma_f32_16x16x32_bf16 v[20:23], v[120:123], a[12:15], v[20:23]
    s_cbranch_vccnz L_re87
L_rb87:
    v_mfma_f32_16x16x32_bf16 v[64:67], v[124:127], a[16:19], v[64:67]
    buffer_load_dwordx4 v[120:123], v1, s[44:47], 0 offen offset:2048 sc1
    v_add_f32 v19, v19, v55
    v_mfma_f32_16x16x32_bf16 v[68:71], v[124:127], a[20:23], v[68:71]
    s_waitcnt vmcnt(10)
    v_max3_u32 v47, v128, v129, v130
    v_cmp_u_f32 vcc, v47, v131
    v_mfma_f32_16x16x32_bf16 v[72:75], v[124:127], a[24:27], v[72:75]
    v_add_f32 v16, v16, v56
    v_add_f32 v17, v17, v57
    v_mfma_f32_16x16x32_bf16 v[20:23], v[124:127], a[28:31], v[20:23]
    s_cbranch_vccnz L_re88
L_rb88:
    v_mfma_f32_16x16x32_bf16 v[64:67], v[128:131], a[32:35], v[64:67]
    buffer_load_dwordx4 v[124:127], v1, s[44:47], 0 offen offset:3072 sc1
    v_add_f32 v18, v18, v58
    v_mfma_f32_16x16x32_bf16 v[68:71], v[128:131], a[36:39], v[68:71]
    s_waitcnt vmcnt(10)
    v_max3_u32 v47, v132, v133, v134
    v_cmp_u_f32 vcc, v47, v135
    v_mfma_f32_16x16x32_bf16 v[72:75], v[128:131], a[40:43], v[72:75]
    s_add_u32 s44, s44, 4096
    s_addc_u32 s45, s45, 0
    v_add_f32 v19, v19, v59
    v_mfma_f32_16x16x32_bf16 v[20:23], v[128:131], a[44:47], v[20:23]
    s_cbranch_vccnz L_re89
L_rb89:
    v_mfma_f32_16x16x32_bf16 v[64:67], v[132:135], a[48:51], v[64:67]
    buffer_load_dwordx4 v[128:131], v1, s[44:47], 0 offen offset:0 sc1
    v_cvt_pk_bf16_f32 v16, v16, v17
    v_mfma_f32_16x16x32_bf16 v[68:71], v[132:135], a[52:55], v[68:71]
    s_waitcnt vmcnt(10)
    v_max3_u32 v47, v136, v137, v138
    v_cmp_u_f32 vcc, v47, v139
    v_mfma_f32_16x16x32_bf16 v[72:75], v[132:135], a[56:59], v[72:75]
    v_cvt_pk_bf16_f32 v17, v18, v19
    v_mfma_f32_16x16x32_bf16 v[20:23], v[132:135], a[60:63], v[20:23]
    s_cbranch_vccnz L_re90
L_rb90:
    v_mfma_f32_16x16x32_bf16 v[64:67], v[136:139], a[64:67], v[64:67]
    buffer_load_dwordx4 v[132:135], v1, s[44:47], 0 offen offset:1024 sc1
    ds_write_b64 v40, v[16:17]
    v_mfma_f32_16x16x32_bf16 v[68:71], v[136:139], a[68:71], v[68:71]
    s_waitcnt vmcnt(10)
    v_max3_u32 v47, v140, v141, v142
    v_cmp_u_f32 vcc, v47, v143
    v_mfma_f32_16x16x32_bf16 v[72:75], v[136:139], a[72:75], v[72:75]
    v_mfma_f32_16x16x32_bf16 v[20:23], v[136:139], a[76:79], v[20:23]
    s_cbranch_vccnz L_re91
L_rb91:
    v_mfma_f32_16x16x32_bf16 v[64:67], v[140:143], a[80:83], v[64:67]
    buffer_load_dwordx4 v[136:139], v1, s[44:47], 0 offen offset:2048 sc1
    v_mfma_f32_16x16x32_bf16 v[68:71], v[140:143], a[84:87], v[68:71]
    s_waitcnt vmcnt(10)
    v_max3_u32 v47, v144, v145, v146
    v_cmp_u_f32 vcc, v47, v147
    v_mfma_f32_16x16x32_bf16 v[72:75], v[140:143], a[88:91], v[72:75]
    v_mfma_f32_16x16x32_bf16 v[20:23], v[140:143], a[92:95], v[20:23]
    s_cbranch_vccnz L_re92
L_rb92:
    v_mfma_f32_16x16x32_bf16 v[48:51], v[144:147], v[160:163], 0
    buffer_load_dwordx4 v[140:143], v1, s[44:47], 0 offen offset:3072 sc1
    v_mfma_f32_16x16x32_bf16 v[52:55], v[144:147], v[164:167], 0
    s_waitcnt vmcnt(10)
    v_max3_u32 v47, v148, v149, v150
    v_cmp_u_f32 vcc, v47, v151
    v_mfma_f32_16x16x32_bf16 v[56:59], v[144:147], v[168:171], 0
    s_add_u32 s44, s44, 4096
    s_addc_u32 s45, s45, 0
    ds_write_b128 v8, v[64:67] offset:1024
    v_mfma_f32_16x16x32_bf16 v[24:27], v[144:147], v[172:175], v[24:27]
    s_cbranch_vccnz L_re93
L_rb93:
    v_mfma_f32_16x16x32_bf16 v[48:51], v[148:151], v[176:179], v[48:51]
    buffer_load_dwordx4 v[144:147], v1, s[44:47], 0 offen offset:0 sc1
    v_mfma_f32_16x16x32_bf16 v[52:55], v[148:151], v[180:183], v[52:55]
    s_waitcnt vmcnt(10)
    v_max3_u32 v47, v152, v153, v154
    v_cmp_u_f32 vcc, v47, v155
    v_mfma_f32_16x16x32_bf16 v[56:59], v[148:151], v[184:187], v[56:59]
    ds_write_b128 v6, v[68:71] offset:1024
    v_mfma_f32_16x16x32_bf16 v[24:27], v[148:151], v[188:191], v[24:27]
    s_cbranch_vccnz L_re94
L_rb94:
    v_mfma_f32_16x16x32_bf16 v[48:51], v[152:155], v[192:195], v[48:51]
    buffer_load_dwordx4 v[148:151], v1, s[44:47], 0 offen offset:1024 sc1
    v_mfma_f32_16x16x32_bf16 v[52:55], v[152:155], v[196:199], v[52:55]
    s_waitcnt vmcnt(10)
    v_max3_u32 v47, v156, v157, v158
    v_cmp_u_f32 vcc, v47, v159
    v_mfma_f32_16x16x32_bf16 v[56:59], v[152:155], v[200:203], v[56:59]
    s_add_u32 s44, s44, 45056
    s_addc_u32 s45, s45, 0
    ds_write_b128 v7, v[72:75] offset:1024
    v_mfma_f32_16x16x32_bf16 v[24:27], v[152:155], v[204:207], v[24:27]
    s_cbranch_vccnz L_re95
L_rb95:
    v_mfma_f32_16x16x32_bf16 v[48:51], v[156:159], v[208:211], v[48:51]
    buffer_load_dwordx4 v[152:155], v1, s[44:47], 0 offen offset:0 sc1
    v_mfma_f32_16x16x32_bf16 v[52:55], v[156:159], v[212:215], v[52:55]
    s_waitcnt vmcnt(10)
    v_max3_u32 v47, v112, v113, v114
    v_cmp_u_f32 vcc, v47, v115
    v_mfma_f32_16x16x32_bf16 v[56:59], v[156:159], v[216:219], v[56:59]
L_ws1_5:
    s_cbranch_execz L_wr1
    s_waitcnt lgkmcnt(0)
    s_barrier
    v_mfma_f32_16x16x32_bf16 v[24:27], v[156:159], v[220:223], v[24:27]
    s_cbranch_vccnz L_re96
L_rb96:
    v_mfma_f32_16x16x32_bf16 v[48:51], v[112:115], v[224:227], v[48:51]
    buffer_load_dwordx4 v[156:159], v1, s[44:47], 0 offen offset:1024 sc1
    ds_read_b128 v[64:67], v9 offset:9216
    v_mfma_f32_16x16x32_bf16 v[52:55], v[112:115], v[228:231], v[52:55]
    s_waitcnt vmcnt(10)
    v_max3_u32 v47, v116, v117, v118
    v_cmp_u_f32 vcc, v47, v119
    v_mfma_f32_16x16x32_bf16 v[56:59], v[112:115], v[232:235], v[56:59]
    ds_read_b128 v[68:71], v9 offset:1024
    ds_read_b128 v[72:75], v9 offset:5120
    v_mfma_f32_16x16x32_bf16 v[24:27], v[112:115], v[236:239], v[24:27]
    s_cbranch_vccnz L_re97
L_rb97:
    v_mfma_f32_16x16x32_bf16 v[48:51], v[116:119], v[240:243], v[48:51]
    buffer_load_dwordx4 v[112:115], v1, s[44:47], 0 offen offset:2048 sc1
    v_mfma_f32_16x16x32_bf16 v[52:55], v[116:119], v[244:247], v[52:55]
    s_waitcnt vmcnt(10)
    v_max3_u32 v47, v120, v121, v122
    v_cmp_u_f32 vcc, v47, v123
    v_mfma_f32_16x16x32_bf16 v[56:59], v[116:119], v[248:251], v[56:59]
    v_mfma_f32_16x16x32_bf16 v[24:27], v[116:119], v[252:255], v[24:27]
    s_cbranch_vccnz L_re98
L_rb98:
    v_mfma_f32_16x16x32_bf16 v[48:51], v[120:123], v[80:83], v[48:51]
    buffer_load_dwordx4 v[116:119], v1, s[44:47], 0 offen offset:3072 sc1
    s_waitcnt lgkmcnt(0)
    v_mfma_f32_16x16x32_bf16 v[52:55], v[120:123], v[84:87], v[52:55]
    s_waitcnt vmcnt(10)
    v_max3_u32 v47, v124, v125, v126
    v_cmp_u_f32 vcc, v47, v127
    v_mfma_f32_16x16x32_bf16 v[56:59], v[120:123], v[88:91], v[56:59]
    s_add_u32 s44, s44, 4096
    s_addc_u32 s45, s45, 0
    v_add_f32 v20, v20, v64
    v_mfma_f32_16x16x32_bf16 v[24:27], v[120:123], v[92:95], v[24:27]
    s_cbranch_vccnz L_re99
L_rb99:
    v_mfma_f32_16x16x32_bf16 v[48:51], v[124:127], v[96:99], v[48:51]
    buffer_load_dwordx4 v[120:123], v1, s[44:47], 0 offen offset:0 sc1
    v_add_f32 v21, v21, v65
    v_mfma_f32_16x16x32_bf16 v[52:55], v[124:127], v[100:103], v[52:55]
    s_waitcnt vmcnt(10)
    v_max3_u32 v47, v128, v129, v130
    v_cmp_u_f32 vcc, v47, v131
    v_mfma_f32_16x16x32_bf16 v[56:59], v[124:127], v[104:107], v[56:59]
    v_add_f32 v22, v22, v66
    v_add_f32 v23, v23, v67
    v_mfma_f32_16x16x32_bf16 v[24:27], v[124:127], v[108:111], v[24:27]
    s_cbranch_vccnz L_re100
L_rb100:
    v_mfma_f32_16x16x32_bf16 v[48:51], v[128:131], a[0:3], v[48:51]
    buffer_load_dwordx4 v[124:127], v1, s[44:47], 0 offen offset:1024 sc1
    v_add_f32 v20, v20, v68
    v_mfma_f32_16x16x32_bf16 v[52:55], v[128:131], a[4:7], v[52:55]
    s_waitcnt vmcnt(10)
    v_max3_u32 v47, v132, v133, v134
    v_cmp_u_f32 vcc, v47, v135
    v_mfma_f32_16x16x32_bf16 v[56:59], v[128:131], a[8:11], v[56:59]
    v_add_f32 v21, v21, v69
    v_add_f32 v22, v22, v70
    v_mfma_f32_16x16x32_bf16 v[24:27], v[128:131], a[12:15], v[24:27]
    s_cbranch_vccnz L_re101
L_rb101:
    v_mfma_f32_16x16x32_bf16 v[48:51], v[132:135], a[16:19], v[48:51]
    buffer_load_dwordx4 v[128:131], v1, s[44:47], 0 offen offset:2048 sc1
    v_add_f32 v23, v23, v71
    v_mfma_f32_16x16x32_bf16 v[52:55], v[132:135], a[20:23], v[52:55]
    s_waitcnt vmcnt(10)
    v_max3_u32 v47, v136, v137, v138
    v_cmp_u_f32 vcc, v47, v139
    v_mfma_f32_16x16x32_bf16 v[56:59], v[132:135], a[24:27], v[56:59]
    v_add_f32 v20, v20, v72
    v_add_f32 v21, v21, v73
    v_mfma_f32_16x16x32_bf16 v[24:27], v[132:135], a[28:31], v[24:27]
    s_cbranch_vccnz L_re102
L_rb102:
    v_mfma_f32_16x16x32_bf16 v[48:51], v[136:139], a[32:35], v[48:51]
    buffer_load_dwordx4 v[132:135], v1, s[44:47], 0 offen offset:3072 sc1
    v_add_f32 v22, v22, v74
    v_mfma_f32_16x16x32_bf16 v[52:55], v[136:139], a[36:39], v[52:55]
    s_waitcnt vmcnt(10)
    v_max3_u32 v47, v140, v141, v142
    v_cmp_u_f32 vcc, v47, v143
    v_mfma_f32_16x16x32_bf16 v[56:59], v[136:139], a[40:43], v[56:59]
    s_add_u32 s44, s44, 4096
    s_addc_u32 s45, s45, 0
    v_add_f32 v23, v23, v75
    v_mfma_f32_16x16x32_bf16 v[24:27], v[136:139], a[44:47], v[24:27]
    s_cbranch_vccnz L_re103
L_rb103:
    v_mfma_f32_16x16x32_bf16 v[48:51], v[140:143], a[48:51], v[48:51]
    buffer_load_dwordx4 v[136:139], v1, s[44:47], 0 offen offset:0 sc1
    v_cvt_pk_bf16_f32 v20, v20, v21
    v_mfma_f32_16x16x32_bf16 v[52:55], v[140:143], a[52:55], v[52:55]
    s_waitcnt vmcnt(10)
    v_max3_u32 v47, v144, v145, v146
    v_cmp_u_f32 vcc, v47, v147
    v_mfma_f32_16x16x32_bf16 v[56:59], v[140:143], a[56:59], v[56:59]
    v_cvt_pk_bf16_f32 v21, v22, v23
    v_mfma_f32_16x16x32_bf16 v[24:27], v[140:143], a[60:63], v[24:27]
    s_cbranch_vccnz L_re104
L_rb104:
    v_mfma_f32_16x16x32_bf16 v[48:51], v[144:147], a[64:67], v[48:51]
    buffer_load_dwordx4 v[140:143], v1, s[44:47], 0 offen offset:1024 sc1
    ds_write_b64 v41, v[20:21]
    v_mfma_f32_16x16x32_bf16 v[52:55], v[144:147], a[68:71], v[52:55]
    s_waitcnt vmcnt(10)
    v_max3_u32 v47, v148, v149, v150
    v_cmp_u_f32 vcc, v47, v151
    v_mfma_f32_16x16x32_bf16 v[56:59], v[144:147], a[72:75], v[56:59]
    v_mfma_f32_16x16x32_bf16 v[24:27], v[144:147], a[76:79], v[24:27]
    s_cbranch_vccnz L_re105
L_rb105:
    v_mfma_f32_16x16x32_bf16 v[48:51], v[148:151], a[80:83], v[48:51]
    buffer_load_dwordx4 v[144:147], v1, s[44:47], 0 offen offset:2048 sc1
    v_mfma_f32_16x16x32_bf16 v[52:55], v[148:151], a[84:87], v[52:55]
    s_waitcnt vmcnt(10)
    v_max3_u32 v47, v152, v153, v154
    v_cmp_u_f32 vcc, v47, v155
    v_mfma_f32_16x16x32_bf16 v[56:59], v[148:151], a[88:91], v[56:59]
    v_mfma_f32_16x16x32_bf16 v[24:27], v[148:151], a[92:95], v[24:27]
    s_cbranch_vccnz L_re106
L_rb106:
    v_mfma_f32_16x16x32_bf16 v[64:67], v[152:155], v[160:163], 0
    buffer_load_dwordx4 v[148:151], v1, s[44:47], 0 offen offset:3072 sc1
    v_mfma_f32_16x16x32_bf16 v[68:71], v[152:155], v[164:167], 0
    s_waitcnt vmcnt(10)
    v_max3_u32 v47, v156, v157, v158
    v_cmp_u_f32 vcc, v47, v159
    v_mfma_f32_16x16x32_bf16 v[72:75], v[152:155], v[168:171], 0
    s_add_u32 s44, s44, 4096
    s_addc_u32 s45, s45, 0
    ds_write_b128 v8, v[48:51] offset:2048
    v_mfma_f32_16x16x32_bf16 v[28:31], v[152:155], v[172:175], v[28:31]
    s_cbranch_vccnz L_re107
L_rb107:
    v_mfma_f32_16x16x32_bf16 v[64:67], v[156:159], v[176:179], v[64:67]
    buffer_load_dwordx4 v[152:155], v1, s[44:47], 0 offen offset:0 sc1
    v_mfma_f32_16x16x32_bf16 v[68:71], v[156:159], v[180:183], v[68:71]
    s_waitcnt vmcnt(10)
    v_max3_u32 v47, v112, v113, v114
    v_cmp_u_f32 vcc, v47, v115
    v_mfma_f32_16x16x32_bf16 v[72:75], v[156:159], v[184:187], v[72:75]
    ds_write_b128 v6, v[52:55] offset:2048
    v_mfma_f32_16x16x32_bf16 v[28:31], v[156:159], v[188:191], v[28:31]
    s_cbranch_vccnz L_re108
L_rb108:
    v_mfma_f32_16x16x32_bf16 v[64:67], v[112:115], v[192:195], v[64:67]
    buffer_load_dwordx4 v[156:159], v1, s[44:47], 0 offen offset:1024 sc1
    v_mfma_f32_16x16x32_bf16 v[68:71], v[112:115], v[196:199], v[68:71]
    s_waitcnt vmcnt(10)
    v_max3_u32 v47, v116, v117, v118
    v_cmp_u_f32 vcc, v47, v119
    v_mfma_f32_16x16x32_bf16 v[72:75], v[112:115], v[200:203], v[72:75]
    ds_write_b128 v7, v[56:59] offset:2048
    v_mfma_f32_16x16x32_bf16 v[28:31], v[112:115], v[204:207], v[28:31]
    s_cbranch_vccnz L_re109
L_rb109:
    v_mfma_f32_16x16x32_bf16 v[64:67], v[116:119], v[208:211], v[64:67]
    v_mfma_f32_16x16x32_bf16 v[68:71], v[116:119], v[212:215], v[68:71]
    s_waitcnt vmcnt(9)
    v_max3_u32 v47, v120, v121, v122
    v_cmp_u_f32 vcc, v47, v123
    v_mfma_f32_16x16x32_bf16 v[72:75], v[116:119], v[216:219], v[72:75]
    s_waitcnt lgkmcnt(0)
    s_barrier
    v_mfma_f32_16x16x32_bf16 v[28:31], v[116:119], v[220:223], v[28:31]
    s_cbranch_vccnz L_re110
L_rb110:
    v_mfma_f32_16x16x32_bf16 v[64:67], v[120:123], v[224:227], v[64:67]
    ds_read_b128 v[48:51], v9 offset:10240
    ds_read_b128 v[52:55], v9 offset:2048
    v_mfma_f32_16x16x32_bf16 v[68:71], v[120:123], v[228:231], v[68:71]
    s_waitcnt vmcnt(8)
    v_max3_u32 v47, v124, v125, v126
    v_cmp_u_f32 vcc, v47, v127
    v_mfma_f32_16x16x32_bf16 v[72:75], v[120:123], v[232:235], v[72:75]
    ds_read_b128 v[56:59], v9 offset:6144
    v_mfma_f32_16x16x32_bf16 v[28:31], v[120:123], v[236:239], v[28:31]
    s_cbranch_vccnz L_re111
L_rb111:
    v_mfma_f32_16x16x32_bf16 v[64:67], v[124:127], v[240:243], v[64:67]
    v_mfma_f32_16x16x32_bf16 v[68:71], v[124:127], v[244:247], v[68:71]
    s_waitcnt vmcnt(7)
    v_max3_u32 v47, v128, v129, v130
    v_cmp_u_f32 vcc, v47, v131
    v_mfma_f32_16x16x32_bf16 v[72:75], v[124:127], v[248:251], v[72:75]
    v_mfma_f32_16x16x32_bf16 v[28:31], v[124:127], v[252:255], v[28:31]
    s_cbranch_vccnz L_re112
L_rb112:
    v_mfma_f32_16x16x32_bf16 v[64:67], v[128:131], v[80:83], v[64:67]
    s_waitcnt lgkmcnt(0)
    v_add_f32 v24, v24, v48
    v_add_f32 v25, v25, v49
    v_mfma_f32_16x16x32_bf16 v[68:71], v[128:131], v[84:87], v[68:71]
    s_waitcnt vmcnt(6)
    v_max3_u32 v47, v132, v133, v134
    v_cmp_u_f32 vcc, v47, v135
    v_mfma_f32_16x16x32_bf16 v[72:75], v[128:131], v[88:91], v[72:75]
    v_add_f32 v26, v26, v50
    v_add_f32 v27, v27, v51
    v_mfma_f32_16x16x32_bf16 v[28:31], v[128:131], v[92:95], v[28:31]
    s_cbranch_vccnz L_re113
L_rb113:
    v_mfma_f32_16x16x32_bf16 v[64:67], v[132:135], v[96:99], v[64:67]
    v_add_f32 v24, v24, v52
    v_add_f32_e64 v25, v25, v53
    v_mfma_f32_16x16x32_bf16 v[68:71], v[132:135], v[100:103], v[68:71]
    s_waitcnt vmcnt(5)
    v_max3_u32 v47, v136, v137, v138
    v_cmp_u_f32 vcc, v47, v139
    v_mfma_f32_16x16x32_bf16 v[72:75], v[132:135], v[104:107], v[72:75]
    v_add_f32 v26, v26, v54
    v_add_f32 v27, v27, v55
    v_mfma_f32_16x16x32_bf16 v[28:31], v[132:135], v[108:111], v[28:31]
    s_cbranch_vccnz L_re114
L_rb114:
    v_mfma_f32_16x16x32_bf16 v[64:67], v[136:139], a[0:3], v[64:67]
    v_add_f32 v24, v24, v56
    v_add_f32_e64 v25, v25, v57
    v_mfma_f32_16x16x32_bf16 v[68:71], v[136:139], a[4:7], v[68:71]
    s_waitcnt vmcnt(4)
    v_max3_u32 v47, v140, v141, v142
    v_cmp_u_f32 vcc, v47, v143
    v_mfma_f32_16x16x32_bf16 v[72:75], v[136:139], a[8:11], v[72:75]
    v_add_f32 v26, v26, v58
    v_add_f32 v27, v27, v59
    v_mfma_f32_16x16x32_bf16 v[28:31], v[136:139], a[12:15], v[28:31]
    s_cbranch_vccnz L_re115
L_rb115:
    v_mfma_f32_16x16x32_bf16 v[64:67], v[140:143], a[16:19], v[64:67]
    v_cvt_pk_bf16_f32 v24, v24, v25
    v_cvt_pk_bf16_f32 v25, v26, v27
    v_mfma_f32_16x16x32_bf16 v[68:71], v[140:143], a[20:23], v[68:71]
    s_waitcnt vmcnt(3)
    v_max3_u32 v47, v144, v145, v146
    v_cmp_u_f32 vcc, v47, v147
    v_mfma_f32_16x16x32_bf16 v[72:75], v[140:143], a[24:27], v[72:75]
    ds_write_b64 v42, v[24:25]
    v_mfma_f32_16x16x32_bf16 v[28:31], v[140:143], a[28:31], v[28:31]
    s_cbranch_vccnz L_re116
L_rb116:
    v_mfma_f32_16x16x32_bf16 v[64:67], v[144:147], a[32:35], v[64:67]
    v_mfma_f32_16x16x32_bf16 v[68:71], v[144:147], a[36:39], v[68:71]
    s_waitcnt vmcnt(2)
    v_max3_u32 v47, v148, v149, v150
    v_cmp_u_f32 vcc, v47, v151
    v_mfma_f32_16x16x32_bf16 v[72:75], v[144:147], a[40:43], v[72:75]
    v_mfma_f32_16x16x32_bf16 v[28:31], v[144:147], a[44:47], v[28:31]
    s_cbranch_vccnz L_re117
L_rb117:
    v_mfma_f32_16x16x32_bf16 v[64:67], v[148:151], a[48:51], v[64:67]
    v_mfma_f32_16x16x32_bf16 v[68:71], v[148:151], a[52:55], v[68:71]
    s_waitcnt vmcnt(1)
    v_max3_u32 v47, v152, v153, v154
    v_cmp_u_f32 vcc, v47, v155
    v_mfma_f32_16x16x32_bf16 v[72:75], v[148:151], a[56:59], v[72:75]
    v_mfma_f32_16x16x32_bf16 v[28:31], v[148:151], a[60:63], v[28:31]
    s_cbranch_vccnz L_re118
L_rb118:
    v_mfma_f32_16x16x32_bf16 v[64:67], v[152:155], a[64:67], v[64:67]
    v_mfma_f32_16x16x32_bf16 v[68:71], v[152:155], a[68:71], v[68:71]
    s_waitcnt vmcnt(0)
    v_max3_u32 v47, v156, v157, v158
    v_cmp_u_f32 vcc, v47, v159
    v_mfma_f32_16x16x32_bf16 v[72:75], v[152:155], a[72:75], v[72:75]
    v_mfma_f32_16x16x32_bf16 v[28:31], v[152:155], a[76:79], v[28:31]
    s_cbranch_vccnz L_re119
L_rb119:
    v_mfma_f32_16x16x32_bf16 v[64:67], v[156:159], a[80:83], v[64:67]
    v_mfma_f32_16x16x32_bf16 v[68:71], v[156:159], a[84:87], v[68:71]
    v_mfma_f32_16x16x32_bf16 v[72:75], v[156:159], a[88:91], v[72:75]
    v_mfma_f32_16x16x32_bf16 v[28:31], v[156:159], a[92:95], v[28:31]
    s_nop 4
    ds_write_b128 v8, v[64:67] offset:3072
    ds_write_b128 v6, v[68:71] offset:3072
    ds_write_b128 v7, v[72:75] offset:3072
    s_waitcnt lgkmcnt(0)
    s_barrier
    ds_read_b128 v[64:67], v9 offset:11264
    ds_read_b128 v[68:71], v9 offset:3072
    ds_read_b128 v[72:75], v9 offset:7168
    s_waitcnt lgkmcnt(2)
    v_pk_add_f32 v[28:29], v[28:29], v[64:65]
    v_pk_add_f32 v[30:31], v[30:31], v[66:67]
    s_waitcnt lgkmcnt(1)
    v_pk_add_f32 v[28:29], v[28:29], v[68:69]
    v_pk_add_f32 v[30:31], v[30:31], v[70:71]
    s_waitcnt lgkmcnt(0)
    v_pk_add_f32 v[28:29], v[28:29], v[72:73]
    v_pk_add_f32 v[30:31], v[30:31], v[74:75]
    v_cvt_pk_bf16_f32 v28, v28, v29
    v_cvt_pk_bf16_f32 v29, v30, v31
    ds_write_b64 v43, v[28:29]
    ds_read_b128 v[112:115], v44 offset:0
    ds_read_b128 v[116:119], v44 offset:1024
    s_waitcnt lgkmcnt(1)
    buffer_store_dwordx4 v[112:115], v45, s[24:27], s73 offen sc1
    s_waitcnt lgkmcnt(0)
    buffer_store_dwordx4 v[116:119], v45, s[24:27], s38 offen sc1
L_fin:
L_end:
    s_endpgm
L_idle:
    s_getpc_b64 s[28:29]
    s_sub_u32 s28, s28, 12288
    s_subb_u32 s29, s29, 0
    s_mov_b32 s30, 0x4000
    s_and_b32 s58, s52, 3
    s_lshl2_add_u32 s58, s58, s48
    s_lshl_b32 s58, s58, 10
    buffer_load_dwordx4 v[48:51], v1, s[28:31], s58 offen
    s_mul_i32 s58, s48, 1835008
    s_and_b32 s59, s52, 3
    s_lshl_b32 s59, s59, 16
    s_add_u32 s58, s58, s59
    s_lshr_b32 s59, s52, 2
    s_lshl_b32 s59, s59, 9
    s_add_u32 s58, s58, s59
    v_lshrrev_b32 v4, 2, v0
    v_and_b32_e64 v5, 3, v0
    v_lshl_add_u32 v4, v4, 5, v5
    v_lshl_add_u32 v4, v4, 7, s58
    s_mov_b32 s59, 786432
    buffer_load_dword v5, v4, s[20:23], s59 offen
    s_mov_b32 s59, 1048576
    buffer_load_dword v5, v4, s[20:23], s59 offen
    s_mov_b32 s59, 1310720
    buffer_load_dword v5, v4, s[20:23], s59 offen
    s_mov_b32 s59, 1572864
    buffer_load_dword v5, v4, s[20:23], s59 offen
    s_waitcnt vmcnt(0)
    s_branch L_fin
L_rare_16:
    s_mov_b32 s66, 0
L_poll_26:
    buffer_load_dword v2, v205, s[40:43], 0 offen sc1
    s_add_u32 s66, s66, 1
    s_cmp_gt_u32 s66, 0x100000
    s_cbranch_scc1 L_polld_27
    s_waitcnt vmcnt(0)
    v_cmp_gt_u32 vcc, 1, v2
    s_cbranch_vccnz L_poll_26
L_polld_27:
    s_waitcnt vmcnt(0)
    s_branch L_back_17
L_rare_18:
    v_mov_b32_e64 v5, 1
    ds_write_b32 v13, v5
    s_branch L_back_19
L_late3:
    s_mov_b64 s[70:71], vcc
    s_mov_b32 s66, 0
L_poll_28:
    buffer_load_dword v2, v3, s[40:43], s72 offen sc1
    s_add_u32 s66, s66, 1
    s_cmp_gt_u32 s66, 0x100000
    s_cbranch_scc1 L_polld_29
    s_waitcnt vmcnt(0)
    v_cmp_gt_u32 vcc, 1, v2
    s_cbranch_vccnz L_poll_28
L_polld_29:
    s_waitcnt vmcnt(0)
    s_mov_b64 vcc, s[70:71]
    s_branch L_have3
L_rl0:
    s_add_u32 s65, s62, 0
    buffer_load_dwordx4 v[112:115], v1, s[40:43], s65 offen sc1
    s_sub_u32 s64, s64, 1
    s_cbranch_scc1 L_rlend
L_rl1:
    s_add_u32 s65, s62, 1024
    buffer_load_dwordx4 v[116:119], v1, s[40:43], s65 offen sc1
    s_sub_u32 s64, s64, 1
    s_cbranch_scc1 L_rlend
L_rl2:
    s_add_u32 s65, s62, 2048
    buffer_load_dwordx4 v[120:123], v1, s[40:43], s65 offen sc1
    s_sub_u32 s64, s64, 1
    s_cbranch_scc1 L_rlend
L_rl3:
    s_add_u32 s65, s62, 3072
    buffer_load_dwordx4 v[124:127], v1, s[40:43], s65 offen sc1
    s_sub_u32 s64, s64, 1
    s_cbranch_scc1 L_rlend
L_rl4:
    s_add_u32 s65, s62, 4096
    buffer_load_dwordx4 v[128:131], v1, s[40:43], s65 offen sc1
    s_sub_u32 s64, s64, 1
    s_cbranch_scc1 L_rlend
L_rl5:
    s_add_u32 s65, s62, 5120
    buffer_load_dwordx4 v[132:135], v1, s[40:43], s65 offen sc1
    s_sub_u32 s64, s64, 1
    s_cbranch_scc1 L_rlend
L_rl6:
    s_add_u32 s65, s62, 6144
    buffer_load_dwordx4 v[136:139], v1, s[40:43], s65 offen sc1
    s_sub_u32 s64, s64, 1
    s_cbranch_scc1 L_rlend
L_rl7:
    s_add_u32 s65, s62, 7168
    buffer_load_dwordx4 v[140:143], v1, s[40:43], s65 offen sc1
    s_sub_u32 s64, s64, 1
    s_cbranch_scc1 L_rlend
L_rl8:
    s_add_u32 s65, s62, 8192
    buffer_load_dwordx4 v[144:147], v1, s[40:43], s65 offen sc1
    s_sub_u32 s64, s64, 1
    s_cbranch_scc1 L_rlend
L_rl9:
    s_add_u32 s65, s62, 9216
    buffer_load_dwordx4 v[148:151], v1, s[40:43], s65 offen sc1
    s_sub_u32 s64, s64, 1
    s_cbranch_scc1 L_rlend
L_rl10:
    s_add_u32 s65, s62, 10240
    buffer_load_dwordx4 v[152:155], v1, s[40:43], s65 offen sc1
    s_sub_u32 s64, s64, 1
    s_cbranch_scc1 L_rlend
L_rl11:
    s_add_u32 s65, s62, 11264
    buffer_load_dwordx4 v[156:159], v1, s[40:43], s65 offen sc1
    s_sub_u32 s64, s64, 1
    s_cbranch_scc1 L_rlend
L_rl12:
    s_add_u32 s65, s62, 12288
    buffer_load_dwordx4 v[112:115], v1, s[40:43], s65 offen sc1
    s_sub_u32 s64, s64, 1
    s_cbranch_scc1 L_rlend
L_rl13:
    s_add_u32 s65, s62, 13312
    buffer_load_dwordx4 v[116:119], v1, s[40:43], s65 offen sc1
    s_sub_u32 s64, s64, 1
    s_cbranch_scc1 L_rlend
L_rl14:
    s_add_u32 s65, s62, 14336
    buffer_load_dwordx4 v[120:123], v1, s[40:43], s65 offen sc1
    s_sub_u32 s64, s64, 1
    s_cbranch_scc1 L_rlend
L_rl15:
    s_add_u32 s65, s62, 15360
    buffer_load_dwordx4 v[124:127], v1, s[40:43], s65 offen sc1
    s_sub_u32 s64, s64, 1
    s_cbranch_scc1 L_rlend
L_rl16:
    s_add_u32 s65, s62, 65536
    buffer_load_dwordx4 v[128:131], v1, s[40:43], s65 offen sc1
    s_sub_u32 s64, s64, 1
    s_cbranch_scc1 L_rlend
L_rl17:
    s_add_u32 s65, s62, 66560
    buffer_load_dwordx4 v[132:135], v1, s[40:43], s65 offen sc1
    s_sub_u32 s64, s64, 1
    s_cbranch_scc1 L_rlend
L_rl18:
    s_add_u32 s65, s62, 67584
    buffer_load_dwordx4 v[136:139], v1, s[40:43], s65 offen sc1
    s_sub_u32 s64, s64, 1
    s_cbranch_scc1 L_rlend
L_rl19:
    s_add_u32 s65, s62, 68608
    buffer_load_dwordx4 v[140:143], v1, s[40:43], s65 offen sc1
    s_sub_u32 s64, s64, 1
    s_cbranch_scc1 L_rlend
L_rl20:
    s_add_u32 s65, s62, 69632
    buffer_load_dwordx4 v[144:147], v1, s[40:43], s65 offen sc1
    s_sub_u32 s64, s64, 1
    s_cbranch_scc1 L_rlend
L_rl21:
    s_add_u32 s65, s62, 70656
    buffer_load_dwordx4 v[148:151], v1, s[40:43], s65 offen sc1
    s_sub_u32 s64, s64, 1
    s_cbranch_scc1 L_rlend
L_rl22:
    s_add_u32 s65, s62, 71680
    buffer_load_dwordx4 v[152:155], v1, s[40:43], s65 offen sc1
    s_sub_u32 s64, s64, 1
    s_cbranch_scc1 L_rlend
L_rl23:
    s_add_u32 s65, s62, 72704
    buffer_load_dwordx4 v[156:159], v1, s[40:43], s65 offen sc1
    s_sub_u32 s64, s64, 1
    s_cbranch_scc1 L_rlend
L_rl24:
    s_add_u32 s65, s62, 73728
    buffer_load_dwordx4 v[112:115], v1, s[40:43], s65 offen sc1
    s_sub_u32 s64, s64, 1
    s_cbranch_scc1 L_rlend
L_rl25:
    s_add_u32 s65, s62, 74752
    buffer_load_dwordx4 v[116:119], v1, s[40:43], s65 offen sc1
    s_sub_u32 s64, s64, 1
    s_cbranch_scc1 L_rlend
L_rl26:
    s_add_u32 s65, s62, 75776
    buffer_load_dwordx4 v[120:123], v1, s[40:43], s65 offen sc1
    s_sub_u32 s64, s64, 1
    s_cbranch_scc1 L_rlend
L_rl27:
    s_add_u32 s65, s62, 76800
    buffer_load_dwordx4 v[124:127], v1, s[40:43], s65 offen sc1
    s_sub_u32 s64, s64, 1
    s_cbranch_scc1 L_rlend
L_rl28:
    s_add_u32 s65, s62, 77824
    buffer_load_dwordx4 v[128:131], v1, s[40:43], s65 offen sc1
    s_sub_u32 s64, s64, 1
    s_cbranch_scc1 L_rlend
L_rl29:
    s_add_u32 s65, s62, 78848
    buffer_load_dwordx4 v[132:135], v1, s[40:43], s65 offen sc1
    s_sub_u32 s64, s64, 1
    s_cbranch_scc1 L_rlend
L_rl30:
    s_add_u32 s65, s62, 79872
    buffer_load_dwordx4 v[136:139], v1, s[40:43], s65 offen sc1
    s_sub_u32 s64, s64, 1
    s_cbranch_scc1 L_rlend
L_rl31:
    s_add_u32 s65, s62, 80896
    buffer_load_dwordx4 v[140:143], v1, s[40:43], s65 offen sc1
    s_sub_u32 s64, s64, 1
    s_cbranch_scc1 L_rlend
L_rl64:
    s_add_u32 s65, s60, 0
    buffer_load_dwordx4 v[128:131], v1, s[40:43], s65 offen sc1
    s_sub_u32 s64, s64, 1
    s_cbranch_scc1 L_rlend
L_rl65:
    s_add_u32 s65, s60, 1024
    buffer_load_dwordx4 v[132:135], v1, s[40:43], s65 offen sc1
    s_sub_u32 s64, s64, 1
    s_cbranch_scc1 L_rlend
L_rl66:
    s_add_u32 s65, s60, 2048
    buffer_load_dwordx4 v[136:139], v1, s[40:43], s65 offen sc1
    s_sub_u32 s64, s64, 1
    s_cbranch_scc1 L_rlend
L_rl67:
    s_add_u32 s65, s60, 3072
    buffer_load_dwordx4 v[140:143], v1, s[40:43], s65 offen sc1
    s_sub_u32 s64, s64, 1
    s_cbranch_scc1 L_rlend
L_rl68:
    s_add_u32 s65, s60, 4096
    buffer_load_dwordx4 v[144:147], v1, s[40:43], s65 offen sc1
    s_sub_u32 s64, s64, 1
    s_cbranch_scc1 L_rlend
L_rl69:
    s_add_u32 s65, s60, 5120
    buffer_load_dwordx4 v[148:151], v1, s[40:43], s65 offen sc1
    s_sub_u32 s64, s64, 1
    s_cbranch_scc1 L_rlend
L_rl70:
    s_add_u32 s65, s60, 6144
    buffer_load_dwordx4 v[152:155], v1, s[40:43], s65 offen sc1
    s_sub_u32 s64, s64, 1
    s_cbranch_scc1 L_rlend
L_rl71:
    s_add_u32 s65, s60, 7168
    buffer_load_dwordx4 v[156:159], v1, s[40:43], s65 offen sc1
    s_sub_u32 s64, s64, 1
    s_cbranch_scc1 L_rlend
L_rl72:
    s_add_u32 s65, s60, 8192
    buffer_load_dwordx4 v[112:115], v1, s[40:43], s65 offen sc1
    s_sub_u32 s64, s64, 1
    s_cbranch_scc1 L_rlend
L_rl73:
    s_add_u32 s65, s60, 9216
    buffer_load_dwordx4 v[116:119], v1, s[40:43], s65 offen sc1
    s_sub_u32 s64, s64, 1
    s_cbranch_scc1 L_rlend
L_rl74:
    s_add_u32 s65, s60, 10240
    buffer_load_dwordx4 v[120:123], v1, s[40:43], s65 offen sc1
    s_sub_u32 s64, s64, 1
    s_cbranch_scc1 L_rlend
L_rl75:
    s_add_u32 s65, s60, 11264
    buffer_load_dwordx4 v[124:127], v1, s[40:43], s65 offen sc1
    s_sub_u32 s64, s64, 1
    s_cbranch_scc1 L_rlend
L_rl76:
    s_add_u32 s65, s60, 12288
    buffer_load_dwordx4 v[128:131], v1, s[40:43], s65 offen sc1
    s_sub_u32 s64, s64, 1
    s_cbranch_scc1 L_rlend
L_rl77:
    s_add_u32 s65, s60, 13312
    buffer_load_dwordx4 v[132:135], v1, s[40:43], s65 offen sc1
    s_sub_u32 s64, s64, 1
    s_cbranch_scc1 L_rlend
L_rl78:
    s_add_u32 s65, s60, 57344
    buffer_load_dwordx4 v[136:139], v1, s[40:43], s65 offen sc1
    s_sub_u32 s64, s64, 1
    s_cbranch_scc1 L_rlend
L_rl79:
    s_add_u32 s65, s60, 58368
    buffer_load_dwordx4 v[140:143], v1, s[40:43], s65 offen sc1
    s_sub_u32 s64, s64, 1
    s_cbranch_scc1 L_rlend
L_rl80:
    s_add_u32 s65, s60, 59392
    buffer_load_dwordx4 v[144:147], v1, s[40:43], s65 offen sc1
    s_sub_u32 s64, s64, 1
    s_cbranch_scc1 L_rlend
L_rl81:
    s_add_u32 s65, s60, 60416
    buffer_load_dwordx4 v[148:151], v1, s[40:43], s65 offen sc1
    s_sub_u32 s64, s64, 1
    s_cbranch_scc1 L_rlend
L_rl82:
    s_add_u32 s65, s60, 61440
    buffer_load_dwordx4 v[152:155], v1, s[40:43], s65 offen sc1
    s_sub_u32 s64, s64, 1
    s_cbranch_scc1 L_rlend
L_rl83:
    s_add_u32 s65, s60, 62464
    buffer_load_dwordx4 v[156:159], v1, s[40:43], s65 offen sc1
    s_sub_u32 s64, s64, 1
    s_cbranch_scc1 L_rlend
L_rl84:
    s_add_u32 s65, s60, 63488
    buffer_load_dwordx4 v[112:115], v1, s[40:43], s65 offen sc1
    s_sub_u32 s64, s64, 1
    s_cbranch_scc1 L_rlend
L_rl85:
    s_add_u32 s65, s60, 64512
    buffer_load_dwordx4 v[116:119], v1, s[40:43], s65 offen sc1
    s_sub_u32 s64, s64, 1
    s_cbranch_scc1 L_rlend
L_rl86:
    s_add_u32 s65, s60, 65536
    buffer_load_dwordx4 v[120:123], v1, s[40:43], s65 offen sc1
    s_sub_u32 s64, s64, 1
    s_cbranch_scc1 L_rlend
L_rl87:
    s_add_u32 s65, s60, 66560
    buffer_load_dwordx4 v[124:127], v1, s[40:43], s65 offen sc1
    s_sub_u32 s64, s64, 1
    s_cbranch_scc1 L_rlend
L_rl88:
    s_add_u32 s65, s60, 67584
    buffer_load_dwordx4 v[128:131], v1, s[40:43], s65 offen sc1
    s_sub_u32 s64, s64, 1
    s_cbranch_scc1 L_rlend
L_rl89:
    s_add_u32 s65, s60, 68608
    buffer_load_dwordx4 v[132:135], v1, s[40:43], s65 offen sc1
    s_sub_u32 s64, s64, 1
    s_cbranch_scc1 L_rlend
L_rl90:
    s_add_u32 s65, s60, 69632
    buffer_load_dwordx4 v[136:139], v1, s[40:43], s65 offen sc1
    s_sub_u32 s64, s64, 1
    s_cbranch_scc1 L_rlend
L_rl91:
    s_add_u32 s65, s60, 70656
    buffer_load_dwordx4 v[140:143], v1, s[40:43], s65 offen sc1
    s_sub_u32 s64, s64, 1
    s_cbranch_scc1 L_rlend
L_rl92:
    s_add_u32 s65, s60, 114688
    buffer_load_dwordx4 v[144:147], v1, s[40:43], s65 offen sc1
    s_sub_u32 s64, s64, 1
    s_cbranch_scc1 L_rlend
L_rl93:
    s_add_u32 s65, s60, 115712
    buffer_load_dwordx4 v[148:151], v1, s[40:43], s65 offen sc1
    s_sub_u32 s64, s64, 1
    s_cbranch_scc1 L_rlend
L_rl94:
    s_add_u32 s65, s60, 116736
    buffer_load_dwordx4 v[152:155], v1, s[40:43], s65 offen sc1
    s_sub_u32 s64, s64, 1
    s_cbranch_scc1 L_rlend
L_rl95:
    s_add_u32 s65, s60, 117760
    buffer_load_dwordx4 v[156:159], v1, s[40:43], s65 offen sc1
    s_sub_u32 s64, s64, 1
    s_cbranch_scc1 L_rlend
L_rl96:
    s_add_u32 s65, s60, 118784
    buffer_load_dwordx4 v[112:115], v1, s[40:43], s65 offen sc1
    s_sub_u32 s64, s64, 1
    s_cbranch_scc1 L_rlend
L_rl97:
    s_add_u32 s65, s60, 119808
    buffer_load_dwordx4 v[116:119], v1, s[40:43], s65 offen sc1
    s_sub_u32 s64, s64, 1
    s_cbranch_scc1 L_rlend
L_rl98:
    s_add_u32 s65, s60, 120832
    buffer_load_dwordx4 v[120:123], v1, s[40:43], s65 offen sc1
    s_sub_u32 s64, s64, 1
    s_cbranch_scc1 L_rlend
L_rl99:
    s_add_u32 s65, s60, 121856
    buffer_load_dwordx4 v[124:127], v1, s[40:43], s65 offen sc1
    s_sub_u32 s64, s64, 1
    s_cbranch_scc1 L_rlend
L_rl100:
    s_add_u32 s65, s60, 122880
    buffer_load_dwordx4 v[128:131], v1, s[40:43], s65 offen sc1
    s_sub_u32 s64, s64, 1
    s_cbranch_scc1 L_rlend
L_rl101:
    s_add_u32 s65, s60, 123904
    buffer_load_dwordx4 v[132:135], v1, s[40:43], s65 offen sc1
    s_sub_u32 s64, s64, 1
    s_cbranch_scc1 L_rlend
L_rl102:
    s_add_u32 s65, s60, 124928
    buffer_load_dwordx4 v[136:139], v1, s[40:43], s65 offen sc1
    s_sub_u32 s64, s64, 1
    s_cbranch_scc1 L_rlend
L_rl103:
    s_add_u32 s65, s60, 125952
    buffer_load_dwordx4 v[140:143], v1, s[40:43], s65 offen sc1
    s_sub_u32 s64, s64, 1
    s_cbranch_scc1 L_rlend
L_rl104:
    s_add_u32 s65, s60, 126976
    buffer_load_dwordx4 v[144:147], v1, s[40:43], s65 offen sc1
    s_sub_u32 s64, s64, 1
    s_cbranch_scc1 L_rlend
L_rl105:
    s_add_u32 s65, s60, 128000
    buffer_load_dwordx4 v[148:151], v1, s[40:43], s65 offen sc1
    s_sub_u32 s64, s64, 1
    s_cbranch_scc1 L_rlend
L_rl106:
    s_add_u32 s65, s60, 172032
    buffer_load_dwordx4 v[152:155], v1, s[40:43], s65 offen sc1
    s_sub_u32 s64, s64, 1
    s_cbranch_scc1 L_rlend
L_rl107:
    s_add_u32 s65, s60, 173056
    buffer_load_dwordx4 v[156:159], v1, s[40:43], s65 offen sc1
    s_sub_u32 s64, s64, 1
    s_cbranch_scc1 L_rlend
L_rl108:
    s_add_u32 s65, s60, 174080
    buffer_load_dwordx4 v[112:115], v1, s[40:43], s65 offen sc1
    s_sub_u32 s64, s64, 1
    s_cbranch_scc1 L_rlend
L_rl109:
    s_add_u32 s65, s60, 175104
    buffer_load_dwordx4 v[116:119], v1, s[40:43], s65 offen sc1
    s_sub_u32 s64, s64, 1
    s_cbranch_scc1 L_rlend
L_rl110:
    s_add_u32 s65, s60, 176128
    buffer_load_dwordx4 v[120:123], v1, s[40:43], s65 offen sc1
    s_sub_u32 s64, s64, 1
    s_cbranch_scc1 L_rlend
L_rl111:
    s_add_u32 s65, s60, 177152
    buffer_load_dwordx4 v[124:127], v1, s[40:43], s65 offen sc1
    s_sub_u32 s64, s64, 1
    s_cbranch_scc1 L_rlend
L_rl112:
    s_add_u32 s65, s60, 178176
    buffer_load_dwordx4 v[128:131], v1, s[40:43], s65 offen sc1
    s_sub_u32 s64, s64, 1
    s_cbranch_scc1 L_rlend
L_rl113:
    s_add_u32 s65, s60, 179200
    buffer_load_dwordx4 v[132:135], v1, s[40:43], s65 offen sc1
    s_sub_u32 s64, s64, 1
    s_cbranch_scc1 L_rlend
L_rl114:
    s_add_u32 s65, s60, 180224
    buffer_load_dwordx4 v[136:139], v1, s[40:43], s65 offen sc1
    s_sub_u32 s64, s64, 1
    s_cbranch_scc1 L_rlend
L_rl115:
    s_add_u32 s65, s60, 181248
    buffer_load_dwordx4 v[140:143], v1, s[40:43], s65 offen sc1
    s_sub_u32 s64, s64, 1
    s_cbranch_scc1 L_rlend
L_rl116:
    s_add_u32 s65, s60, 182272
    buffer_load_dwordx4 v[144:147], v1, s[40:43], s65 offen sc1
    s_sub_u32 s64, s64, 1
    s_cbranch_scc1 L_rlend
L_rl117:
    s_add_u32 s65, s60, 183296
    buffer_load_dwordx4 v[148:151], v1, s[40:43], s65 offen sc1
    s_sub_u32 s64, s64, 1
    s_cbranch_scc1 L_rlend
L_rl118:
    s_add_u32 s65, s60, 184320
    buffer_load_dwordx4 v[152:155], v1, s[40:43], s65 offen sc1
    s_sub_u32 s64, s64, 1
    s_cbranch_scc1 L_rlend
L_rl119:
    s_add_u32 s65, s60, 185344
    buffer_load_dwordx4 v[156:159], v1, s[40:43], s65 offen sc1
    s_sub_u32 s64, s64, 1
    s_cbranch_scc1 L_rlend
L_rlend:
    s_waitcnt vmcnt(0)
    s_add_u32 s66, s66, 1
    s_cmp_gt_u32 s66, 0x100000
    s_setpc_b64 s[68:69]
L_re0:
    s_mov_b32 s64, 3
    s_call_b64 s[68:69], L_rl0
    s_cbranch_scc1 L_rb0
    v_max3_u32 v47, v112, v113, v114
    v_max_u32 v47, v47, v115
    v_cmp_eq_u32 vcc, -1, v47
    s_cbranch_vccnz L_re0
    s_branch L_rb0
L_re1:
    s_mov_b32 s64, 3
    s_call_b64 s[68:69], L_rl1
    s_cbranch_scc1 L_rb1
    v_max3_u32 v47, v116, v117, v118
    v_max_u32 v47, v47, v119
    v_cmp_eq_u32 vcc, -1, v47
    s_cbranch_vccnz L_re1
    s_branch L_rb1
L_re2:
    s_mov_b32 s64, 3
    s_call_b64 s[68:69], L_rl2
    s_cbranch_scc1 L_rb2
    v_max3_u32 v47, v120, v121, v122
    v_max_u32 v47, v47, v123
    v_cmp_eq_u32 vcc, -1, v47
    s_cbranch_vccnz L_re2
    s_branch L_rb2
L_re3:
    s_mov_b32 s64, 3
    s_call_b64 s[68:69], L_rl3
    s_cbranch_scc1 L_rb3
    v_max3_u32 v47, v124, v125, v126
    v_max_u32 v47, v47, v127
    v_cmp_eq_u32 vcc, -1, v47
    s_cbranch_vccnz L_re3
    s_branch L_rb3
L_re4:
    s_mov_b32 s64, 3
    s_call_b64 s[68:69], L_rl4
    s_cbranch_scc1 L_rb4
    v_max3_u32 v47, v128, v129, v130
    v_max_u32 v47, v47, v131
    v_cmp_eq_u32 vcc, -1, v47
    s_cbranch_vccnz L_re4
    s_branch L_rb4
L_re5:
    s_mov_b32 s64, 3
    s_call_b64 s[68:69], L_rl5
    s_cbranch_scc1 L_rb5
    v_max3_u32 v47, v132, v133, v134
    v_max_u32 v47, v47, v135
    v_cmp_eq_u32 vcc, -1, v47
    s_cbranch_vccnz L_re5
    s_branch L_rb5
L_re6:
    s_mov_b32 s64, 3
    s_call_b64 s[68:69], L_rl6
    s_cbranch_scc1 L_rb6
    v_max3_u32 v47, v136, v137, v138
    v_max_u32 v47, v47, v139
    v_cmp_eq_u32 vcc, -1, v47
    s_cbranch_vccnz L_re6
    s_branch L_rb6
L_re7:
    s_mov_b32 s64, 3
    s_call_b64 s[68:69], L_rl7
    s_cbranch_scc1 L_rb7
    v_max3_u32 v47, v140, v141, v142
    v_max_u32 v47, v47, v143
    v_cmp_eq_u32 vcc, -1, v47
    s_cbranch_vccnz L_re7
    s_branch L_rb7
L_re8:
    s_mov_b32 s64, 3
    s_call_b64 s[68:69], L_rl8
    s_cbranch_scc1 L_rb8
    v_max3_u32 v47, v144, v145, v146
    v_max_u32 v47, v47, v147
    v_cmp_eq_u32 vcc, -1, v47
    s_cbranch_vccnz L_re8
    s_branch L_rb8
L_re9:
    s_mov_b32 s64, 3
    s_call_b64 s[68:69], L_rl9
    s_cbranch_scc1 L_rb9
    v_max3_u32 v47, v148, v149, v150
    v_max_u32 v47, v47, v151
    v_cmp_eq_u32 vcc, -1, v47
    s_cbranch_vccnz L_re9
    s_branch L_rb9
L_re10:
    s_mov_b32 s64, 3
    s_call_b64 s[68:69], L_rl10
    s_cbranch_scc1 L_rb10
    v_max3_u32 v47, v152, v153, v154
    v_max_u32 v47, v47, v155
    v_cmp_eq_u32 vcc, -1, v47
    s_cbranch_vccnz L_re10
    s_branch L_rb10
L_re11:
    s_mov_b32 s64, 3
    s_call_b64 s[68:69], L_rl11
    s_cbranch_scc1 L_rb11
    v_max3_u32 v47, v156, v157, v158
    v_max_u32 v47, v47, v159
    v_cmp_eq_u32 vcc, -1, v47
    s_cbranch_vccnz L_re11
    s_branch L_rb11
L_re12:
    s_mov_b32 s64, 3
    s_call_b64 s[68:69], L_rl12
    s_cbranch_scc1 L_rb12
    v_max3_u32 v47, v112, v113, v114
    v_max_u32 v47, v47, v115
    v_cmp_eq_u32 vcc, -1, v47
    s_cbranch_vccnz L_re12
    s_branch L_rb12
L_re13:
    s_mov_b32 s64, 3
    s_call_b64 s[68:69], L_rl13
    s_cbranch_scc1 L_rb13
    v_max3_u32 v47, v116, v117, v118
    v_max_u32 v47, v47, v119
    v_cmp_eq_u32 vcc, -1, v47
    s_cbranch_vccnz L_re13
    s_branch L_rb13
L_re14:
    s_mov_b32 s64, 3
    s_call_b64 s[68:69], L_rl14
    s_cbranch_scc1 L_rb14
    v_max3_u32 v47, v120, v121, v122
    v_max_u32 v47, v47, v123
    v_cmp_eq_u32 vcc, -1, v47
    s_cbranch_vccnz L_re14
    s_branch L_rb14
L_re15:
    s_mov_b32 s64, 3
    s_call_b64 s[68:69], L_rl15
    s_cbranch_scc1 L_rb15
    v_max3_u32 v47, v124, v125, v126
    v_max_u32 v47, v47, v127
    v_cmp_eq_u32 vcc, -1, v47
    s_cbranch_vccnz L_re15
    s_branch L_rb15
L_re16:
    s_mov_b32 s64, 3
    s_call_b64 s[68:69], L_rl16
    s_cbranch_scc1 L_rb16
    v_max3_u32 v47, v128, v129, v130
    v_max_u32 v47, v47, v131
    v_cmp_eq_u32 vcc, -1, v47
    s_cbranch_vccnz L_re16
    s_branch L_rb16
L_re17:
    s_mov_b32 s64, 3
    s_call_b64 s[68:69], L_rl17
    s_cbranch_scc1 L_rb17
    v_max3_u32 v47, v132, v133, v134
    v_max_u32 v47, v47, v135
    v_cmp_eq_u32 vcc, -1, v47
    s_cbranch_vccnz L_re17
    s_branch L_rb17
L_re18:
    s_mov_b32 s64, 3
    s_call_b64 s[68:69], L_rl18
    s_cbranch_scc1 L_rb18
    v_max3_u32 v47, v136, v137, v138
    v_max_u32 v47, v47, v139
    v_cmp_eq_u32 vcc, -1, v47
    s_cbranch_vccnz L_re18
    s_branch L_rb18
L_re19:
    s_mov_b32 s64, 3
    s_call_b64 s[68:69], L_rl19
    s_cbranch_scc1 L_rb19
    v_max3_u32 v47, v140, v141, v142
    v_max_u32 v47, v47, v143
    v_cmp_eq_u32 vcc, -1, v47
    s_cbranch_vccnz L_re19
    s_branch L_rb19
L_re20:
    s_mov_b32 s64, 3
    s_call_b64 s[68:69], L_rl20
    s_cbranch_scc1 L_rb20
    v_max3_u32 v47, v144, v145, v146
    v_max_u32 v47, v47, v147
    v_cmp_eq_u32 vcc, -1, v47
    s_cbranch_vccnz L_re20
    s_branch L_rb20
L_re21:
    s_mov_b32 s64, 3
    s_call_b64 s[68:69], L_rl21
    s_cbranch_scc1 L_rb21
    v_max3_u32 v47, v148, v149, v150
    v_max_u32 v47, v47, v151
    v_cmp_eq_u32 vcc, -1, v47
    s_cbranch_vccnz L_re21
    s_branch L_rb21
L_re22:
    s_mov_b32 s64, 3
    s_call_b64 s[68:69], L_rl22
    s_cbranch_scc1 L_rb22
    v_max3_u32 v47, v152, v153, v154
    v_max_u32 v47, v47, v155
    v_cmp_eq_u32 vcc, -1, v47
    s_cbranch_vccnz L_re22
    s_branch L_rb22
L_re23:
    s_mov_b32 s64, 3
    s_call_b64 s[68:69], L_rl23
    s_cbranch_scc1 L_rb23
    v_max3_u32 v47, v156, v157, v158
    v_max_u32 v47, v47, v159
    v_cmp_eq_u32 vcc, -1, v47
    s_cbranch_vccnz L_re23
    s_branch L_rb23
L_re24:
    s_mov_b32 s64, 3
    s_call_b64 s[68:69], L_rl24
    s_cbranch_scc1 L_rb24
    v_max3_u32 v47, v112, v113, v114
    v_max_u32 v47, v47, v115
    v_cmp_eq_u32 vcc, -1, v47
    s_cbranch_vccnz L_re24
    s_branch L_rb24
L_re25:
    s_mov_b32 s64, 3
    s_call_b64 s[68:69], L_rl25
    s_cbranch_scc1 L_rb25
    v_max3_u32 v47, v116, v117, v118
    v_max_u32 v47, v47, v119
    v_cmp_eq_u32 vcc, -1, v47
    s_cbranch_vccnz L_re25
    s_branch L_rb25
L_re26:
    s_mov_b32 s64, 3
    s_call_b64 s[68:69], L_rl26
    s_cbranch_scc1 L_rb26
    v_max3_u32 v47, v120, v121, v122
    v_max_u32 v47, v47, v123
    v_cmp_eq_u32 vcc, -1, v47
    s_cbranch_vccnz L_re26
    s_branch L_rb26
L_re27:
    s_mov_b32 s64, 3
    s_call_b64 s[68:69], L_rl27
    s_cbranch_scc1 L_rb27
    v_max3_u32 v47, v124, v125, v126
    v_max_u32 v47, v47, v127
    v_cmp_eq_u32 vcc, -1, v47
    s_cbranch_vccnz L_re27
    s_branch L_rb27
L_re28:
    s_mov_b32 s64, 3
    s_call_b64 s[68:69], L_rl28
    s_cbranch_scc1 L_rb28
    v_max3_u32 v47, v128, v129, v130
    v_max_u32 v47, v47, v131
    v_cmp_eq_u32 vcc, -1, v47
    s_cbranch_vccnz L_re28
    s_branch L_rb28
L_re29:
    s_mov_b32 s64, 2
    s_call_b64 s[68:69], L_rl29
    s_cbranch_scc1 L_rb29
    v_max3_u32 v47, v132, v133, v134
    v_max_u32 v47, v47, v135
    v_cmp_eq_u32 vcc, -1, v47
    s_cbranch_vccnz L_re29
    s_branch L_rb29
L_re30:
    s_mov_b32 s64, 1
    s_call_b64 s[68:69], L_rl30
    s_cbranch_scc1 L_rb30
    v_max3_u32 v47, v136, v137, v138
    v_max_u32 v47, v47, v139
    v_cmp_eq_u32 vcc, -1, v47
    s_cbranch_vccnz L_re30
    s_branch L_rb30
L_re31:
    s_mov_b32 s64, 0
    s_call_b64 s[68:69], L_rl31
    s_cbranch_scc1 L_rb31
    v_max3_u32 v47, v140, v141, v142
    v_max_u32 v47, v47, v143
    v_cmp_eq_u32 vcc, -1, v47
    s_cbranch_vccnz L_re31
    s_branch L_rb31
L_re64:
    s_mov_b32 s64, 3
    s_call_b64 s[68:69], L_rl64
    s_cbranch_scc1 L_rb64
    v_max3_u32 v47, v128, v129, v130
    v_max_u32 v47, v47, v131
    v_cmp_eq_u32 vcc, -1, v47
    s_cbranch_vccnz L_re64
    s_branch L_rb64
L_re65:
    s_mov_b32 s64, 3
    s_call_b64 s[68:69], L_rl65
    s_cbranch_scc1 L_rb65
    v_max3_u32 v47, v132, v133, v134
    v_max_u32 v47, v47, v135
    v_cmp_eq_u32 vcc, -1, v47
    s_cbranch_vccnz L_re65
    s_branch L_rb65
L_re66:
    s_mov_b32 s64, 3
    s_call_b64 s[68:69], L_rl66
    s_cbranch_scc1 L_rb66
    v_max3_u32 v47, v136, v137, v138
    v_max_u32 v47, v47, v139
    v_cmp_eq_u32 vcc, -1, v47
    s_cbranch_vccnz L_re66
    s_branch L_rb66
L_re67:
    s_mov_b32 s64, 3
    s_call_b64 s[68:69], L_rl67
    s_cbranch_scc1 L_rb67
    v_max3_u32 v47, v140, v141, v142
    v_max_u32 v47, v47, v143
    v_cmp_eq_u32 vcc, -1, v47
    s_cbranch_vccnz L_re67
    s_branch L_rb67
L_re68:
    s_mov_b32 s64, 3
    s_call_b64 s[68:69], L_rl68
    s_cbranch_scc1 L_rb68
    v_max3_u32 v47, v144, v145, v146
    v_max_u32 v47, v47, v147
    v_cmp_eq_u32 vcc, -1, v47
    s_cbranch_vccnz L_re68
    s_branch L_rb68
L_re69:
    s_mov_b32 s64, 3
    s_call_b64 s[68:69], L_rl69
    s_cbranch_scc1 L_rb69
    v_max3_u32 v47, v148, v149, v150
    v_max_u32 v47, v47, v151
    v_cmp_eq_u32 vcc, -1, v47
    s_cbranch_vccnz L_re69
    s_branch L_rb69
L_re70:
    s_mov_b32 s64, 3
    s_call_b64 s[68:69], L_rl70
    s_cbranch_scc1 L_rb70
    v_max3_u32 v47, v152, v153, v154
    v_max_u32 v47, v47, v155
    v_cmp_eq_u32 vcc, -1, v47
    s_cbranch_vccnz L_re70
    s_branch L_rb70
L_re71:
    s_mov_b32 s64, 3
    s_call_b64 s[68:69], L_rl71
    s_cbranch_scc1 L_rb71
    v_max3_u32 v47, v156, v157, v158
    v_max_u32 v47, v47, v159
    v_cmp_eq_u32 vcc, -1, v47
    s_cbranch_vccnz L_re71
    s_branch L_rb71
L_re72:
    s_mov_b32 s64, 3
    s_call_b64 s[68:69], L_rl72
    s_cbranch_scc1 L_rb72
    v_max3_u32 v47, v112, v113, v114
    v_max_u32 v47, v47, v115
    v_cmp_eq_u32 vcc, -1, v47
    s_cbranch_vccnz L_re72
    s_branch L_rb72
L_re73:
    s_mov_b32 s64, 3
    s_call_b64 s[68:69], L_rl73
    s_cbranch_scc1 L_rb73
    v_max3_u32 v47, v116, v117, v118
    v_max_u32 v47, v47, v119
    v_cmp_eq_u32 vcc, -1, v47
    s_cbranch_vccnz L_re73
    s_branch L_rb73
L_re74:
    s_mov_b32 s64, 3
    s_call_b64 s[68:69], L_rl74
    s_cbranch_scc1 L_rb74
    v_max3_u32 v47, v120, v121, v122
    v_max_u32 v47, v47, v123
    v_cmp_eq_u32 vcc, -1, v47
    s_cbranch_vccnz L_re74
    s_branch L_rb74
L_re75:
    s_mov_b32 s64, 3
    s_call_b64 s[68:69], L_rl75
    s_cbranch_scc1 L_rb75
    v_max3_u32 v47, v124, v125, v126
    v_max_u32 v47, v47, v127
    v_cmp_eq_u32 vcc, -1, v47
    s_cbranch_vccnz L_re75
    s_branch L_rb75
L_re76:
    s_mov_b32 s64, 3
    s_call_b64 s[68:69], L_rl76
    s_cbranch_scc1 L_rb76
    v_max3_u32 v47, v128, v129, v130
    v_max_u32 v47, v47, v131
    v_cmp_eq_u32 vcc, -1, v47
    s_cbranch_vccnz L_re76
    s_branch L_rb76
L_re77:
    s_mov_b32 s64, 3
    s_call_b64 s[68:69], L_rl77
    s_cbranch_scc1 L_rb77
    v_max3_u32 v47, v132, v133, v134
    v_max_u32 v47, v47, v135
    v_cmp_eq_u32 vcc, -1, v47
    s_cbranch_vccnz L_re77
    s_branch L_rb77
L_re78:
    s_mov_b32 s64, 3
    s_call_b64 s[68:69], L_rl78
    s_cbranch_scc1 L_rb78
    v_max3_u32 v47, v136, v137, v138
    v_max_u32 v47, v47, v139
    v_cmp_eq_u32 vcc, -1, v47
    s_cbranch_vccnz L_re78
    s_branch L_rb78
L_re79:
    s_mov_b32 s64, 3
    s_call_b64 s[68:69], L_rl79
    s_cbranch_scc1 L_rb79
    v_max3_u32 v47, v140, v141, v142
    v_max_u32 v47, v47, v143
    v_cmp_eq_u32 vcc, -1, v47
    s_cbranch_vccnz L_re79
    s_branch L_rb79
L_re80:
    s_mov_b32 s64, 3
    s_call_b64 s[68:69], L_rl80
    s_cbranch_scc1 L_rb80
    v_max3_u32 v47, v144, v145, v146
    v_max_u32 v47, v47, v147
    v_cmp_eq_u32 vcc, -1, v47
    s_cbranch_vccnz L_re80
    s_branch L_rb80
L_re81:
    s_mov_b32 s64, 3
    s_call_b64 s[68:69], L_rl81
    s_cbranch_scc1 L_rb81
    v_max3_u32 v47, v148, v149, v150
    v_max_u32 v47, v47, v151
    v_cmp_eq_u32 vcc, -1, v47
    s_cbranch_vccnz L_re81
    s_branch L_rb81
L_re82:
    s_mov_b32 s64, 3
    s_call_b64 s[68:69], L_rl82
    s_cbranch_scc1 L_rb82
    v_max3_u32 v47, v152, v153, v154
    v_max_u32 v47, v47, v155
    v_cmp_eq_u32 vcc, -1, v47
    s_cbranch_vccnz L_re82
    s_branch L_rb82
L_re83:
    s_mov_b32 s64, 3
    s_call_b64 s[68:69], L_rl83
    s_cbranch_scc1 L_rb83
    v_max3_u32 v47, v156, v157, v158
    v_max_u32 v47, v47, v159
    v_cmp_eq_u32 vcc, -1, v47
    s_cbranch_vccnz L_re83
    s_branch L_rb83
L_re84:
    s_mov_b32 s64, 3
    s_call_b64 s[68:69], L_rl84
    s_cbranch_scc1 L_rb84
    v_max3_u32 v47, v112, v113, v114
    v_max_u32 v47, v47, v115
    v_cmp_eq_u32 vcc, -1, v47
    s_cbranch_vccnz L_re84
    s_branch L_rb84
L_re85:
    s_mov_b32 s64, 3
    s_call_b64 s[68:69], L_rl85
    s_cbranch_scc1 L_rb85
    v_max3_u32 v47, v116, v117, v118
    v_max_u32 v47, v47, v119
    v_cmp_eq_u32 vcc, -1, v47
    s_cbranch_vccnz L_re85
    s_branch L_rb85
L_re86:
    s_mov_b32 s64, 3
    s_call_b64 s[68:69], L_rl86
    s_cbranch_scc1 L_rb86
    v_max3_u32 v47, v120, v121, v122
    v_max_u32 v47, v47, v123
    v_cmp_eq_u32 vcc, -1, v47
    s_cbranch_vccnz L_re86
    s_branch L_rb86
L_re87:
    s_mov_b32 s64, 3
    s_call_b64 s[68:69], L_rl87
    s_cbranch_scc1 L_rb87
    v_max3_u32 v47, v124, v125, v126
    v_max_u32 v47, v47, v127
    v_cmp_eq_u32 vcc, -1, v47
    s_cbranch_vccnz L_re87
    s_branch L_rb87
L_re88:
    s_mov_b32 s64, 3
    s_call_b64 s[68:69], L_rl88
    s_cbranch_scc1 L_rb88
    v_max3_u32 v47, v128, v129, v130
    v_max_u32 v47, v47, v131
    v_cmp_eq_u32 vcc, -1, v47
    s_cbranch_vccnz L_re88
    s_branch L_rb88
L_re89:
    s_mov_b32 s64, 3
    s_call_b64 s[68:69], L_rl89
    s_cbranch_scc1 L_rb89
    v_max3_u32 v47, v132, v133, v134
    v_max_u32 v47, v47, v135
    v_cmp_eq_u32 vcc, -1, v47
    s_cbranch_vccnz L_re89
    s_branch L_rb89
L_re90:
    s_mov_b32 s64, 3
    s_call_b64 s[68:69], L_rl90
    s_cbranch_scc1 L_rb90
    v_max3_u32 v47, v136, v137, v138
    v_max_u32 v47, v47, v139
    v_cmp_eq_u32 vcc, -1, v47
    s_cbranch_vccnz L_re90
    s_branch L_rb90
L_re91:
    s_mov_b32 s64, 3
    s_call_b64 s[68:69], L_rl91
    s_cbranch_scc1 L_rb91
    v_max3_u32 v47, v140, v141, v142
    v_max_u32 v47, v47, v143
    v_cmp_eq_u32 vcc, -1, v47
    s_cbranch_vccnz L_re91
    s_branch L_rb91
L_re92:
    s_mov_b32 s64, 3
    s_call_b64 s[68:69], L_rl92
    s_cbranch_scc1 L_rb92
    v_max3_u32 v47, v144, v145, v146
    v_max_u32 v47, v47, v147
    v_cmp_eq_u32 vcc, -1, v47
    s_cbranch_vccnz L_re92
    s_branch L_rb92
L_re93:
    s_mov_b32 s64, 3
    s_call_b64 s[68:69], L_rl93
    s_cbranch_scc1 L_rb93
    v_max3_u32 v47, v148, v149, v150
    v_max_u32 v47, v47, v151
    v_cmp_eq_u32 vcc, -1, v47
    s_cbranch_vccnz L_re93
    s_branch L_rb93
L_re94:
    s_mov_b32 s64, 3
    s_call_b64 s[68:69], L_rl94
    s_cbranch_scc1 L_rb94
    v_max3_u32 v47, v152, v153, v154
    v_max_u32 v47, v47, v155
    v_cmp_eq_u32 vcc, -1, v47
    s_cbranch_vccnz L_re94
    s_branch L_rb94
L_re95:
    s_mov_b32 s64, 3
    s_call_b64 s[68:69], L_rl95
    s_cbranch_scc1 L_rb95
    v_max3_u32 v47, v156, v157, v158
    v_max_u32 v47, v47, v159
    v_cmp_eq_u32 vcc, -1, v47
    s_cbranch_vccnz L_re95
    s_branch L_rb95
L_re96:
    s_mov_b32 s64, 3
    s_call_b64 s[68:69], L_rl96
    s_cbranch_scc1 L_rb96
    v_max3_u32 v47, v112, v113, v114
    v_max_u32 v47, v47, v115
    v_cmp_eq_u32 vcc, -1, v47
    s_cbranch_vccnz L_re96
    s_branch L_rb96
L_re97:
    s_mov_b32 s64, 3
    s_call_b64 s[68:69], L_rl97
    s_cbranch_scc1 L_rb97
    v_max3_u32 v47, v116, v117, v118
    v_max_u32 v47, v47, v119
    v_cmp_eq_u32 vcc, -1, v47
    s_cbranch_vccnz L_re97
    s_branch L_rb97
L_re98:
    s_mov_b32 s64, 3
    s_call_b64 s[68:69], L_rl98
    s_cbranch_scc1 L_rb98
    v_max3_u32 v47, v120, v121, v122
    v_max_u32 v47, v47, v123
    v_cmp_eq_u32 vcc, -1, v47
    s_cbranch_vccnz L_re98
    s_branch L_rb98
L_re99:
    s_mov_b32 s64, 3
    s_call_b64 s[68:69], L_rl99
    s_cbranch_scc1 L_rb99
    v_max3_u32 v47, v124, v125, v126
    v_max_u32 v47, v47, v127
    v_cmp_eq_u32 vcc, -1, v47
    s_cbranch_vccnz L_re99
    s_branch L_rb99
L_re100:
    s_mov_b32 s64, 3
    s_call_b64 s[68:69], L_rl100
    s_cbranch_scc1 L_rb100
    v_max3_u32 v47, v128, v129, v130
    v_max_u32 v47, v47, v131
    v_cmp_eq_u32 vcc, -1, v47
    s_cbranch_vccnz L_re100
    s_branch L_rb100
L_re101:
    s_mov_b32 s64, 3
    s_call_b64 s[68:69], L_rl101
    s_cbranch_scc1 L_rb101
    v_max3_u32 v47, v132, v133, v134
    v_max_u32 v47, v47, v135
    v_cmp_eq_u32 vcc, -1, v47
    s_cbranch_vccnz L_re101
    s_branch L_rb101
L_re102:
    s_mov_b32 s64, 3
    s_call_b64 s[68:69], L_rl102
    s_cbranch_scc1 L_rb102
    v_max3_u32 v47, v136, v137, v138
    v_max_u32 v47, v47, v139
    v_cmp_eq_u32 vcc, -1, v47
    s_cbranch_vccnz L_re102
    s_branch L_rb102
L_re103:
    s_mov_b32 s64, 3
    s_call_b64 s[68:69], L_rl103
    s_cbranch_scc1 L_rb103
    v_max3_u32 v47, v140, v141, v142
    v_max_u32 v47, v47, v143
    v_cmp_eq_u32 vcc, -1, v47
    s_cbranch_vccnz L_re103
    s_branch L_rb103
L_re104:
    s_mov_b32 s64, 3
    s_call_b64 s[68:69], L_rl104
    s_cbranch_scc1 L_rb104
    v_max3_u32 v47, v144, v145, v146
    v_max_u32 v47, v47, v147
    v_cmp_eq_u32 vcc, -1, v47
    s_cbranch_vccnz L_re104
    s_branch L_rb104
L_re105:
    s_mov_b32 s64, 3
    s_call_b64 s[68:69], L_rl105
    s_cbranch_scc1 L_rb105
    v_max3_u32 v47, v148, v149, v150
    v_max_u32 v47, v47, v151
    v_cmp_eq_u32 vcc, -1, v47
    s_cbranch_vccnz L_re105
    s_branch L_rb105
L_re106:
    s_mov_b32 s64, 3
    s_call_b64 s[68:69], L_rl106
    s_cbranch_scc1 L_rb106
    v_max3_u32 v47, v152, v153, v154
    v_max_u32 v47, v47, v155
    v_cmp_eq_u32 vcc, -1, v47
    s_cbranch_vccnz L_re106
    s_branch L_rb106
L_re107:
    s_mov_b32 s64, 3
    s_call_b64 s[68:69], L_rl107
    s_cbranch_scc1 L_rb107
    v_max3_u32 v47, v156, v157, v158
    v_max_u32 v47, v47, v159
    v_cmp_eq_u32 vcc, -1, v47
    s_cbranch_vccnz L_re107
    s_branch L_rb107
L_re108:
    s_mov_b32 s64, 3
    s_call_b64 s[68:69], L_rl108
    s_cbranch_scc1 L_rb108
    v_max3_u32 v47, v112, v113, v114
    v_max_u32 v47, v47, v115
    v_cmp_eq_u32 vcc, -1, v47
    s_cbranch_vccnz L_re108
    s_branch L_rb108
L_re109:
    s_mov_b32 s64, 3
    s_call_b64 s[68:69], L_rl109
    s_cbranch_scc1 L_rb109
    v_max3_u32 v47, v116, v117, v118
    v_max_u32 v47, v47, v119
    v_cmp_eq_u32 vcc, -1, v47
    s_cbranch_vccnz L_re109
    s_branch L_rb109
L_re110:
    s_mov_b32 s64, 3
    s_call_b64 s[68:69], L_rl110
    s_cbranch_scc1 L_rb110
    v_max3_u32 v47, v120, v121, v122
    v_max_u32 v47, v47, v123
    v_cmp_eq_u32 vcc, -1, v47
    s_cbranch_vccnz L_re110
    s_branch L_rb110
L_re111:
    s_mov_b32 s64, 3
    s_call_b64 s[68:69], L_rl111
    s_cbranch_scc1 L_rb111
    v_max3_u32 v47, v124, v125, v126
    v_max_u32 v47, v47, v127
    v_cmp_eq_u32 vcc, -1, v47
    s_cbranch_vccnz L_re111
    s_branch L_rb111
L_re112:
    s_mov_b32 s64, 3
    s_call_b64 s[68:69], L_rl112
    s_cbranch_scc1 L_rb112
    v_max3_u32 v47, v128, v129, v130
    v_max_u32 v47, v47, v131
    v_cmp_eq_u32 vcc, -1, v47
    s_cbranch_vccnz L_re112
    s_branch L_rb112
L_re113:
    s_mov_b32 s64, 3
    s_call_b64 s[68:69], L_rl113
    s_cbranch_scc1 L_rb113
    v_max3_u32 v47, v132, v133, v134
    v_max_u32 v47, v47, v135
    v_cmp_eq_u32 vcc, -1, v47
    s_cbranch_vccnz L_re113
    s_branch L_rb113
L_re114:
    s_mov_b32 s64, 3
    s_call_b64 s[68:69], L_rl114
    s_cbranch_scc1 L_rb114
    v_max3_u32 v47, v136, v137, v138
    v_max_u32 v47, v47, v139
    v_cmp_eq_u32 vcc, -1, v47
    s_cbranch_vccnz L_re114
    s_branch L_rb114
L_re115:
    s_mov_b32 s64, 3
    s_call_b64 s[68:69], L_rl115
    s_cbranch_scc1 L_rb115
    v_max3_u32 v47, v140, v141, v142
    v_max_u32 v47, v47, v143
    v_cmp_eq_u32 vcc, -1, v47
    s_cbranch_vccnz L_re115
    s_branch L_rb115
L_re116:
    s_mov_b32 s64, 3
    s_call_b64 s[68:69], L_rl116
    s_cbranch_scc1 L_rb116
    v_max3_u32 v47, v144, v145, v146
    v_max_u32 v47, v47, v147
    v_cmp_eq_u32 vcc, -1, v47
    s_cbranch_vccnz L_re116
    s_branch L_rb116
L_re117:
    s_mov_b32 s64, 2
    s_call_b64 s[68:69], L_rl117
    s_cbranch_scc1 L_rb117
    v_max3_u32 v47, v148, v149, v150
    v_max_u32 v47, v47, v151
    v_cmp_eq_u32 vcc, -1, v47
    s_cbranch_vccnz L_re117
    s_branch L_rb117
L_re118:
    s_mov_b32 s64, 1
    s_call_b64 s[68:69], L_rl118
    s_cbranch_scc1 L_rb118
    v_max3_u32 v47, v152, v153, v154
    v_max_u32 v47, v47, v155
    v_cmp_eq_u32 vcc, -1, v47
    s_cbranch_vccnz L_re118
    s_branch L_rb118
L_re119:
    s_mov_b32 s64, 0
    s_call_b64 s[68:69], L_rl119
    s_cbranch_scc1 L_rb119
    v_max3_u32 v47, v156, v157, v158
    v_max_u32 v47, v47, v159
    v_cmp_eq_u32 vcc, -1, v47
    s_cbranch_vccnz L_re119
    s_branch L_rb119
L_slow:
    s_waitcnt vmcnt(0) lgkmcnt(0)
    s_mov_b32 s55, 1
    v_mov_b32 v152, 0xff800000
    v_mov_b32 v153, 0xff800000
    v_mov_b32 v154, 0xff800000
    v_mov_b32 v155, 0xff800000
    s_mov_b32 s60, 0
L_slow_loop:
    buffer_load_dwordx4 v[240:243], v213, s[40:43], s60 offen offset:0 sc1
    buffer_load_dwordx4 v[244:247], v213, s[40:43], s60 offen offset:1024 sc1
    s_waitcnt vmcnt(0)
    v_mfma_f32_32x32x16_bf16 v[112:127], v[240:243], v[16:19], 0
    v_mfma_f32_32x32x16_bf16 v[112:127], v[244:247], v[20:23], v[112:127]
    s_nop 11
    v_max3_f32 v152, v112, v113, v152
    v_max3_f32 v152, v114, v115, v152
    v_max3_f32 v152, v116, v117, v152
    v_max3_f32 v152, v118, v119, v152
    v_max3_f32 v152, v120, v121, v152
    v_max3_f32 v152, v122, v123, v152
    v_max3_f32 v152, v124, v125, v152
    v_max3_f32 v152, v126, v127, v152
    v_mfma_f32_32x32x16_bf16 v[112:127], v[240:243], v[24:27], 0
    v_mfma_f32_32x32x16_bf16 v[112:127], v[244:247], v[28:31], v[112:127]
    s_nop 11
    v_max3_f32 v153, v112, v113, v153
    v_max3_f32 v153, v114, v115, v153
    v_max3_f32 v153, v116, v117, v153
    v_max3_f32 v153, v118, v119, v153
    v_max3_f32 v153, v120, v121, v153
    v_max3_f32 v153, v122, v123, v153
    v_max3_f32 v153, v124, v125, v153
    v_max3_f32 v153, v126, v127, v153
    v_mfma_f32_32x32x16_bf16 v[112:127], v[240:243], v[32:35], 0
    v_mfma_f32_32x32x16_bf16 v[112:127], v[244:247], v[36:39], v[112:127]
    s_nop 11
    v_max3_f32 v154, v112, v113, v154
    v_max3_f32 v154, v114, v115, v154
    v_max3_f32 v154, v116, v117, v154
    v_max3_f32 v154, v118, v119, v154
    v_max3_f32 v154, v120, v121, v154
    v_max3_f32 v154, v122, v123, v154
    v_max3_f32 v154, v124, v125, v154
    v_max3_f32 v154, v126, v127, v154
    v_mfma_f32_32x32x16_bf16 v[112:127], v[240:243], v[40:43], 0
    v_mfma_f32_32x32x16_bf16 v[112:127], v[244:247], v[44:47], v[112:127]
    s_nop 11
    v_max3_f32 v155, v112, v113, v155
    v_max3_f32 v155, v114, v115, v155
    v_max3_f32 v155, v116, v117, v155
    v_max3_f32 v155, v118, v119, v155
    v_max3_f32 v155, v120, v121, v155
    v_max3_f32 v155, v122, v123, v155
    v_max3_f32 v155, v124, v125, v155
    v_max3_f32 v155, v126, v127, v155
    s_add_u32 s60, s60, 0x40000
    s_cmp_lt_u32 s60, 0x400000
    s_cbranch_scc1 L_slow_loop
    s_barrier
    v_lshlrev_b32_e64 v4, 2, v0
    s_mul_i32 s60, s48, 1280
    v_add_u32_e64 v5, s60, v4
    v_xor_b32 v13, 3072, v5
    ds_write_b32 v13, v152
    v_xor_b32 v13, 2048, v5
    ds_write_b32 v13, v153
    v_xor_b32 v13, 1024, v5
    ds_write_b32 v13, v154
    v_xor_b32_e64 v13, 0, v5
    ds_write_b32 v13, v155
    s_waitcnt lgkmcnt(0)
    s_barrier
    v_and_b32 v4, 31, v0
    v_lshlrev_b32 v4, 2, v4
    s_lshl_b32 s60, s48, 10
    v_add_u32 v5, s60, v4
    v_xor_b32 v13, 3072, v5
    ds_read_b32 v112, v13 offset:0
    ds_read_b32 v113, v13 offset:128
    ds_read_b32 v114, v13 offset:256
    ds_read_b32 v115, v13 offset:384
    ds_read_b32 v116, v13 offset:512
    ds_read_b32 v117, v13 offset:640
    ds_read_b32 v118, v13 offset:768
    ds_read_b32 v119, v13 offset:896
    s_waitcnt lgkmcnt(0)
    v_max3_f32 v14, v112, v113, v114
    v_max3_f32 v14, v14, v115, v116
    v_max3_f32 v14, v14, v117, v118
    v_max_f32 v14, v14, v119
    v_mov_b32_e64 v152, v14
    v_xor_b32 v13, 2048, v5
    ds_read_b32 v112, v13 offset:0
    ds_read_b32 v113, v13 offset:128
    ds_read_b32 v114, v13 offset:256
    ds_read_b32 v115, v13 offset:384
    ds_read_b32 v116, v13 offset:512
    ds_read_b32 v117, v13 offset:640
    ds_read_b32 v118, v13 offset:768
    ds_read_b32 v119, v13 offset:896
    s_waitcnt lgkmcnt(0)
    v_max3_f32 v14, v112, v113, v114
    v_max3_f32 v14, v14, v115, v116
    v_max3_f32 v14, v14, v117, v118
    v_max_f32 v14, v14, v119
    v_mov_b32_e64 v153, v14
    v_xor_b32 v13, 1024, v5
    ds_read_b32 v112, v13 offset:0
    ds_read_b32 v113, v13 offset:128
    ds_read_b32 v114, v13 offset:256
    ds_read_b32 v115, v13 offset:384
    ds_read_b32 v116, v13 offset:512
    ds_read_b32 v117, v13 offset:640
    ds_read_b32 v118, v13 offset:768
    ds_read_b32 v119, v13 offset:896
    s_waitcnt lgkmcnt(0)
    v_max3_f32 v14, v112, v113, v114
    v_max3_f32 v14, v14, v115, v116
    v_max3_f32 v14, v14, v117, v118
    v_max_f32 v14, v14, v119
    v_mov_b32 v154, v14
    v_xor_b32 v13, 0, v5
    ds_read_b32 v112, v13 offset:0
    ds_read_b32 v113, v13 offset:128
    ds_read_b32 v114, v13 offset:256
    ds_read_b32 v115, v13 offset:384
    ds_read_b32 v116, v13 offset:512
    ds_read_b32 v117, v13 offset:640
    ds_read_b32 v118, v13 offset:768
    ds_read_b32 v119, v13 offset:896
    s_waitcnt lgkmcnt(0)
    v_max3_f32 v14, v112, v113, v114
    v_max3_f32 v14, v14, v115, v116
    v_max3_f32 v14, v14, v117, v118
    v_max_f32 v14, v14, v119
    v_mov_b32 v155, v14
    v_mov_b32 v48, 0
    v_mov_b32 v49, 0
    v_mov_b32 v50, 0
    v_mov_b32 v51, 0
    v_mov_b32 v52, 0
    v_mov_b32 v53, 0
    v_mov_b32 v54, 0
    v_mov_b32 v55, 0
    v_mov_b32 v56, 0
    v_mov_b32 v57, 0
    v_mov_b32 v58, 0
    v_mov_b32 v59, 0
    v_mov_b32 v60, 0
    v_mov_b32 v61, 0
    v_mov_b32 v62, 0
    v_mov_b32 v63, 0
    v_mov_b32 v64, 0
    v_mov_b32 v65, 0
    v_mov_b32 v66, 0
    v_mov_b32 v67, 0
    v_mov_b32 v68, 0
    v_mov_b32 v69, 0
    v_mov_b32 v70, 0
    v_mov_b32 v71, 0
    v_mov_b32 v72, 0
    v_mov_b32 v73, 0
    v_mov_b32 v74, 0
    v_mov_b32 v75, 0
    v_mov_b32 v76, 0
    v_mov_b32 v77, 0
    v_mov_b32 v78, 0
    v_mov_b32 v79, 0
    v_mov_b32 v80, 0
    v_mov_b32 v81, 0
    v_mov_b32 v82, 0
    v_mov_b32 v83, 0
    v_mov_b32 v84, 0
    v_mov_b32 v85, 0
    v_mov_b32 v86, 0
    v_mov_b32 v87, 0
    v_mov_b32 v88, 0
    v_mov_b32 v89, 0
    v_mov_b32 v90, 0
    v_mov_b32 v91, 0
    v_mov_b32 v92, 0
    v_mov_b32 v93, 0
    v_mov_b32 v94, 0
    v_mov_b32 v95, 0
    v_mov_b32 v96, 0
    v_mov_b32 v97, 0
    v_mov_b32 v98, 0
    v_mov_b32 v99, 0
    v_mov_b32 v100, 0
    v_mov_b32 v101, 0
    v_mov_b32 v102, 0
    v_mov_b32 v103, 0
    v_mov_b32 v104, 0
    v_mov_b32 v105, 0
    v_mov_b32 v106, 0
    v_mov_b32 v107, 0
    v_mov_b32 v108, 0
    v_mov_b32 v109, 0
    v_mov_b32 v110, 0
    v_mov_b32_e64 v111, 0
    s_barrier
    s_mov_b32 s60, 0
L_slow_loop2:
    buffer_load_dwordx4 v[240:243], v213, s[40:43], s60 offen offset:0 sc1
    buffer_load_dwordx4 v[248:251], v215, s[40:43], s60 offen sc1
    buffer_load_dwordx4 v[244:247], v213, s[40:43], s60 offen offset:1024 sc1
    buffer_load_dwordx4 v[252:255], v216, s[40:43], s60 offen sc1
    s_waitcnt vmcnt(0)
    v_mfma_f32_32x32x16_bf16 v[112:127], v[240:243], v[16:19], 0
    v_mfma_f32_32x32x16_bf16 v[112:127], v[244:247], v[20:23], v[112:127]
    s_nop 11
    v_sub_f32 v112, v112, v152
    v_sub_f32 v113, v113, v152
    v_sub_f32 v114, v114, v152
    v_sub_f32 v115, v115, v152
    v_sub_f32 v116, v116, v152
    v_sub_f32 v117, v117, v152
    v_sub_f32 v118, v118, v152
    v_sub_f32 v119, v119, v152
    v_sub_f32 v120, v120, v152
    v_sub_f32 v121, v121, v152
    v_sub_f32 v122, v122, v152
    v_sub_f32 v123, v123, v152
    v_sub_f32 v124, v124, v152
    v_sub_f32 v125, v125, v152
    v_sub_f32 v126, v126, v152
    v_sub_f32 v127, v127, v152
    v_exp_f32 v112, v112
    v_exp_f32 v113, v113
    v_exp_f32 v114, v114
    v_exp_f32 v115, v115
    v_exp_f32 v116, v116
    v_exp_f32 v117, v117
    v_exp_f32 v118, v118
    v_exp_f32 v119, v119
    v_exp_f32 v120, v120
    v_exp_f32 v121, v121
    v_exp_f32 v122, v122
    v_exp_f32 v123, v123
    v_exp_f32 v124, v124
    v_exp_f32 v125, v125
    v_exp_f32 v126, v126
    v_exp_f32 v127, v127
    v_cvt_pk_bf16_f32 v144, v112, v113
    v_cvt_pk_bf16_f32 v145, v114, v115
    v_cvt_pk_bf16_f32 v146, v116, v117
    v_cvt_pk_bf16_f32 v147, v118, v119
    v_cvt_pk_bf16_f32 v148, v120, v121
    v_cvt_pk_bf16_f32 v149, v122, v123
    v_cvt_pk_bf16_f32 v150, v124, v125
    v_cvt_pk_bf16_f32 v151, v126, v127
    v_mfma_f32_32x32x16_bf16 v[48:63], v[248:251], v[144:147], v[48:63]
    s_nop 0
    v_mfma_f32_32x32x16_bf16 v[48:63], v[252:255], v[148:151], v[48:63]
    v_mfma_f32_32x32x16_bf16 v[112:127], v[240:243], v[24:27], 0
    v_mfma_f32_32x32x16_bf16 v[112:127], v[244:247], v[28:31], v[112:127]
    s_nop 11
    v_sub_f32 v112, v112, v153
    v_sub_f32 v113, v113, v153
    v_sub_f32 v114, v114, v153
    v_sub_f32 v115, v115, v153
    v_sub_f32 v116, v116, v153
    v_sub_f32 v117, v117, v153
    v_sub_f32 v118, v118, v153
    v_sub_f32 v119, v119, v153
    v_sub_f32 v120, v120, v153
    v_sub_f32 v121, v121, v153
    v_sub_f32 v122, v122, v153
    v_sub_f32 v123, v123, v153
    v_sub_f32 v124, v124, v153
    v_sub_f32 v125, v125, v153
    v_sub_f32 v126, v126, v153
    v_sub_f32 v127, v127, v153
    v_exp_f32 v112, v112
    v_exp_f32 v113, v113
    v_exp_f32 v114, v114
    v_exp_f32 v115, v115
    v_exp_f32 v116, v116
    v_exp_f32 v117, v117
    v_exp_f32 v118, v118
    v_exp_f32 v119, v119
    v_exp_f32 v120, v120
    v_exp_f32 v121, v121
    v_exp_f32 v122, v122
    v_exp_f32 v123, v123
    v_exp_f32 v124, v124
    v_exp_f32 v125, v125
    v_exp_f32 v126, v126
    v_exp_f32 v127, v127
    v_cvt_pk_bf16_f32 v144, v112, v113
    v_cvt_pk_bf16_f32 v145, v114, v115
    v_cvt_pk_bf16_f32 v146, v116, v117
    v_cvt_pk_bf16_f32 v147, v118, v119
    v_cvt_pk_bf16_f32 v148, v120, v121
    v_cvt_pk_bf16_f32 v149, v122, v123
    v_cvt_pk_bf16_f32 v150, v124, v125
    v_cvt_pk_bf16_f32 v151, v126, v127
    v_mfma_f32_32x32x16_bf16 v[64:79], v[248:251], v[144:147], v[64:79]
    s_nop 0
    v_mfma_f32_32x32x16_bf16 v[64:79], v[252:255], v[148:151], v[64:79]
    v_mfma_f32_32x32x16_bf16 v[112:127], v[240:243], v[32:35], 0
    v_mfma_f32_32x32x16_bf16 v[112:127], v[244:247], v[36:39], v[112:127]
    s_nop 11
    v_sub_f32 v112, v112, v154
    v_sub_f32 v113, v113, v154
    v_sub_f32 v114, v114, v154
    v_sub_f32 v115, v115, v154
    v_sub_f32 v116, v116, v154
    v_sub_f32 v117, v117, v154
    v_sub_f32 v118, v118, v154
    v_sub_f32 v119, v119, v154
    v_sub_f32 v120, v120, v154
    v_sub_f32 v121, v121, v154
    v_sub_f32 v122, v122, v154
    v_sub_f32 v123, v123, v154
    v_sub_f32 v124, v124, v154
    v_sub_f32 v125, v125, v154
    v_sub_f32 v126, v126, v154
    v_sub_f32 v127, v127, v154
    v_exp_f32 v112, v112
    v_exp_f32 v113, v113
    v_exp_f32 v114, v114
    v_exp_f32 v115, v115
    v_exp_f32 v116, v116
    v_exp_f32 v117, v117
    v_exp_f32 v118, v118
    v_exp_f32 v119, v119
    v_exp_f32 v120, v120
    v_exp_f32 v121, v121
    v_exp_f32 v122, v122
    v_exp_f32 v123, v123
    v_exp_f32 v124, v124
    v_exp_f32 v125, v125
    v_exp_f32 v126, v126
    v_exp_f32 v127, v127
    v_cvt_pk_bf16_f32 v144, v112, v113
    v_cvt_pk_bf16_f32 v145, v114, v115
    v_cvt_pk_bf16_f32 v146, v116, v117
    v_cvt_pk_bf16_f32 v147, v118, v119
    v_cvt_pk_bf16_f32 v148, v120, v121
    v_cvt_pk_bf16_f32 v149, v122, v123
    v_cvt_pk_bf16_f32 v150, v124, v125
    v_cvt_pk_bf16_f32 v151, v126, v127
    v_mfma_f32_32x32x16_bf16 v[80:95], v[248:251], v[144:147], v[80:95]
    s_nop 0
    v_mfma_f32_32x32x16_bf16 v[80:95], v[252:255], v[148:151], v[80:95]
    v_mfma_f32_32x32x16_bf16 v[112:127], v[240:243], v[40:43], 0
    v_mfma_f32_32x32x16_bf16 v[112:127], v[244:247], v[44:47], v[112:127]
    s_nop 11
    v_sub_f32 v112, v112, v155
    v_sub_f32 v113, v113, v155
    v_sub_f32 v114, v114, v155
    v_sub_f32 v115, v115, v155
    v_sub_f32 v116, v116, v155
    v_sub_f32 v117, v117, v155
    v_sub_f32 v118, v118, v155
    v_sub_f32 v119, v119, v155
    v_sub_f32 v120, v120, v155
    v_sub_f32 v121, v121, v155
    v_sub_f32 v122, v122, v155
    v_sub_f32 v123, v123, v155
    v_sub_f32 v124, v124, v155
    v_sub_f32 v125, v125, v155
    v_sub_f32 v126, v126, v155
    v_sub_f32 v127, v127, v155
    v_exp_f32 v112, v112
    v_exp_f32 v113, v113
    v_exp_f32 v114, v114
    v_exp_f32 v115, v115
    v_exp_f32 v116, v116
    v_exp_f32 v117, v117
    v_exp_f32 v118, v118
    v_exp_f32 v119, v119
    v_exp_f32 v120, v120
    v_exp_f32 v121, v121
    v_exp_f32 v122, v122
    v_exp_f32 v123, v123
    v_exp_f32 v124, v124
    v_exp_f32 v125, v125
    v_exp_f32 v126, v126
    v_exp_f32 v127, v127
    v_cvt_pk_bf16_f32 v144, v112, v113
    v_cvt_pk_bf16_f32 v145, v114, v115
    v_cvt_pk_bf16_f32 v146, v116, v117
    v_cvt_pk_bf16_f32 v147, v118, v119
    v_cvt_pk_bf16_f32 v148, v120, v121
    v_cvt_pk_bf16_f32 v149, v122, v123
    v_cvt_pk_bf16_f32 v150, v124, v125
    v_cvt_pk_bf16_f32 v151, v126, v127
    v_mfma_f32_32x32x16_bf16 v[96:111], v[248:251], v[144:147], v[96:111]
    s_nop 0
    v_mfma_f32_32x32x16_bf16 v[96:111], v[252:255], v[148:151], v[96:111]
    s_add_u32 s60, s60, 0x40000
    s_cmp_lt_u32 s60, 0x400000
    s_cbranch_scc1 L_slow_loop2
    ds_write_b128 v8, v[48:51] offset:0
    ds_write_b128 v8, v[52:55] offset:1024
    ds_write_b128 v8, v[56:59] offset:2048
    ds_write_b128 v8, v[60:63] offset:3072
    ds_write_b128 v7, v[64:67] offset:0
    ds_write_b128 v7, v[68:71] offset:1024
    ds_write_b128 v7, v[72:75] offset:2048
    ds_write_b128 v7, v[76:79] offset:3072
    ds_write_b128 v6, v[80:83] offset:0
    ds_write_b128 v6, v[84:87] offset:1024
    ds_write_b128 v6, v[88:91] offset:2048
    ds_write_b128 v6, v[92:95] offset:3072
    s_branch L_red

    .fill 64, 4, 0xbf800000
.section .rodata,"a"
.p2align 6
.amdhsa_kernel sequential_preLN__softmax_full_mha__mixer_token_mlp__prompt_kernel
  .amdhsa_next_free_vgpr 512
  .amdhsa_next_free_sgpr 102
  .amdhsa_accum_offset 256
  .amdhsa_group_segment_fixed_size 0
  .amdhsa_kernarg_size 88
  .amdhsa_user_sgpr_count 2
  .amdhsa_user_sgpr_kernarg_segment_ptr 1
  .amdhsa_system_sgpr_workgroup_id_x 1
.end_amdhsa_kernel
```
